```python
import torch

def _softmax(x, axis=-1):
    return torch.softmax(x, dim=axis)
def _gelu(x):
    return torch.nn.functional.gelu(x, approximate="tanh")
def _silu(x):
    return torch.nn.functional.silu(x)
def _sigmoid(x):
    return torch.sigmoid(x)
def _layernorm(x, axis=-1, eps=1e-5):
    m = x.mean(dim=axis, keepdim=True)
    v = x.var(dim=axis, keepdim=True, unbiased=False)
    return (x - m) / torch.sqrt(v + eps)
def _scatter_add(tgt, idx, src, axis=0):
    return tgt.clone().index_add_(axis, idx, src)
def _segment_sum(src, seg, n):
    out = torch.zeros((n,) + src.shape[1:], dtype=src.dtype)
    return out.index_add_(0, seg, src)
def _pad(x, pw):
    flat = tuple(v for pair in reversed(pw) for v in pair)
    return torch.nn.functional.pad(x, flat)

kernel_name = 'parallel_sum__grouped_kv_mqa__glu_gated_reglu__prompt'

def setup_inputs():

    _w = (lambda a: (lambda t: t.to(torch.bfloat16) if t.is_floating_point() else t)(torch.as_tensor(a)))
    def _A_setup():
        B, S, D, H = 1, 2048, 512, 32
        Dh = D // H
        return {
            "x": _w((lambda *s: torch.randn(*s, dtype=torch.bfloat16) * 0.05)(B, S, D)),
            "wq": _w((lambda *s: torch.randn(*s, dtype=torch.bfloat16) * 0.05)(D, H * Dh)),
            "wk": _w((lambda *s: torch.randn(*s, dtype=torch.bfloat16) * 0.05)(D, Dh)),
            "wv": _w((lambda *s: torch.randn(*s, dtype=torch.bfloat16) * 0.05)(D, Dh)),
            "wo": _w((lambda *s: torch.randn(*s, dtype=torch.bfloat16) * 0.05)(H * Dh, D)),
        }
    _A_in = _A_setup()

    def _B_setup():
        B, S, D, F = 1, 2048, 512, 1792
        return {
            "x": _w((lambda *s: torch.randn(*s, dtype=torch.bfloat16) * 0.05)(B, S, D)),
            "W_gate": _w((lambda *s: torch.randn(*s, dtype=torch.bfloat16) * 0.4)(D, F) * (2.0 / D) ** 0.5),
            "W_up": _w((lambda *s: torch.randn(*s, dtype=torch.bfloat16) * 0.4)(D, F) * (2.0 / D) ** 0.5),
            "W_down": _w((lambda *s: torch.randn(*s, dtype=torch.bfloat16) * 0.4)(F, D) * (1.0 / F) ** 0.5),
        }
    _B_in = _B_setup()

    return {
        "A_x": _A_in["x"],
        "A_wq": _A_in["wq"],
        "A_wk": _A_in["wk"],
        "A_wv": _A_in["wv"],
        "A_wo": _A_in["wo"],
        "B_x": _B_in["x"],
        "B_W_gate": _B_in["W_gate"],
        "B_W_up": _B_in["W_up"],
        "B_W_down": _B_in["W_down"],
    }

def reference(A_x, A_wq, A_wk, A_wv, A_wo, B_x, B_W_gate, B_W_up, B_W_down):
    def _A_ref(x, wq, wk, wv, wo):
        B, S, D = x.shape
        H = 32
        Dh = D // H
        q = (lambda x, *d: x.permute(*d))((x @ wq).reshape(B, S, H, Dh), 0, 2, 1, 3)
        k = x @ wk
        v = x @ wv
        scores = torch.einsum("bhqd,bkd->bhqk", q, k) * (Dh ** -0.5)
        p = _softmax(scores, axis=-1)
        o = torch.einsum("bhqk,bkd->bhqd", p, v)
        return (lambda x, *d: x.permute(*d))(o, 0, 2, 1, 3).reshape(B, S, H * Dh) @ wo

    def _B_ref(x, W_gate, W_up, W_down):
        gate = torch.einsum("bsd,df->bsf", x, W_gate)
        up = torch.einsum("bsd,df->bsf", x, W_up)
        gate = gate * (lambda x, dt: x.to(dt))(gate > 0, gate.dtype)
        h = gate * up
        return torch.einsum("bsf,fd->bsd", h, W_down)

    x = A_x
    xn = _layernorm(x, axis=-1)
    return x + _A_ref(xn, A_wq, A_wk, A_wv, A_wo) + _B_ref(xn, B_W_gate, B_W_up, B_W_down)
```

```asm
; @launch kernel=mega_kernel grid=(256,1,1) block=(768,1,1) lds=163840
.amdgcn_target "amdgcn-amd-amdhsa--gfx950"
.text
.globl mega_kernel
.p2align 8
.type mega_kernel,@function
mega_kernel:
    s_cmp_ge_u32 s2, 256
    s_cbranch_scc1 L_mega_kernel_done_1
    s_load_dwordx16 s[36:51], s[0:1], 0
    s_load_dwordx2 s[52:53], s[0:1], 64
    s_load_dwordx2 s[54:55], s[0:1], 72
    s_load_dwordx2 s[4:5], s[0:1], 88
    v_lshrrev_b32 v3, 6, v0
    v_and_b32 v1, 63, v0
    v_readfirstlane_b32 s20, v3
    v_lshlrev_b32 v2, 4, v1
    s_and_b32 s56, s2, 7
    s_lshr_b32 s57, s2, 3
    s_and_b32 s21, s56, 1
    s_lshl_b32 s21, s21, 3
    s_and_b32 s58, s57, 7
    s_add_u32 s21, s21, s58
    s_lshr_b32 s22, s56, 1
    s_lshl_b32 s22, s22, 2
    s_lshr_b32 s58, s57, 3
    s_add_u32 s22, s22, s58
    s_lshl_b32 s24, s21, 1
    s_lshr_b32 s58, s22, 3
    s_add_u32 s24, s24, s58
    s_and_b32 s25, s22, 7
    s_lshl_b32 s26, s21, 4
    s_add_u32 s26, s26, s22
    s_cmp_lg_u32 s20, 11
    s_cbranch_scc1 L_mega_kernel_ncpf_4
    s_getpc_b64 s[58:59]
L_mega_kernel_pfbase_5:
    s_mov_b32 s56, L_mega_kernel_done_1-L_mega_kernel_pfbase_5
    s_lshr_b32 s57, s2, 3
    v_lshlrev_b32 v4, 5, v1
    v_add_u32 v4, s57, v4
    v_lshlrev_b32 v4, 7, v4
    v_cmp_gt_u32 vcc, s56, v4
    s_mov_b64 s[60:61], vcc
    v_mov_b32 v5, s59
    v_add_co_u32 v4, vcc, s58, v4
    v_addc_co_u32 v5, vcc, 0, v5, vcc
    s_mov_b64 exec, s[60:61]
    global_load_dword v100, v[4:5], off
    s_mov_b64 exec, -1
L_mega_kernel_ncpf_4:
    s_cmp_ge_u32 s20, 8
    s_cbranch_scc1 L_mega_kernel_roleP_7
    s_cmp_ge_u32 s20, 4
    s_cbranch_scc1 L_mega_kernel_roleG_6
    s_and_b32 s28, s20, 1
    s_lshr_b32 s29, s20, 1
    v_mov_b32 v156, 149504
    s_lshl_b32 s56, s20, 2
    s_add_u32 s56, s56, 149584
    v_mov_b32 v157, s56
    s_barrier
    v_mov_b32 v96, 0
    v_mov_b32 v97, 0
    v_mov_b32 v98, 0
    v_mov_b32 v99, 0
    v_mov_b32 v100, 0
    v_mov_b32 v101, 0
    v_mov_b32 v102, 0
    v_mov_b32 v103, 0
    v_mov_b32 v104, 0
    v_mov_b32 v105, 0
    v_mov_b32 v106, 0
    v_mov_b32 v107, 0
    v_mov_b32 v108, 0
    v_mov_b32 v109, 0
    v_mov_b32 v110, 0
    v_mov_b32 v111, 0
    v_mov_b32 v112, 0
    v_mov_b32 v113, 0
    v_mov_b32 v114, 0
    v_mov_b32 v115, 0
    v_mov_b32 v116, 0
    v_mov_b32 v117, 0
    v_mov_b32 v118, 0
    v_mov_b32 v119, 0
    v_mov_b32 v120, 0
    v_mov_b32 v121, 0
    v_mov_b32 v122, 0
    v_mov_b32 v123, 0
    v_mov_b32 v124, 0
    v_mov_b32 v125, 0
    v_mov_b32 v126, 0
    v_mov_b32 v127, 0
    v_and_b32 v150, 31, v1
    v_lshrrev_b32 v151, 5, v1
    v_lshrrev_b32 v152, 1, v150
    v_and_b32 v152, 7, v152
    v_xor_b32 v152, v152, v151
    s_lshl_b32 s56, s28, 5
    v_add_u32 v150, s56, v150
    v_lshlrev_b32 v150, 7, v150
    s_lshl_b32 s57, s29, 2
    v_xor_b32 v152, s57, v152
    v_xor_b32 v153, 0, v152
    v_lshlrev_b32 v153, 4, v153
    v_add_u32 v8, v150, v153
    v_xor_b32 v153, 2, v152
    v_lshlrev_b32 v153, 4, v153
    v_add_u32 v9, v150, v153
    v_xor_b32 v153, 4, v152
    v_lshlrev_b32 v153, 4, v153
    v_add_u32 v10, v150, v153
    v_xor_b32 v153, 6, v152
    v_lshlrev_b32 v153, 4, v153
    v_add_u32 v11, v150, v153
    v_and_b32 v150, 15, v1
    v_lshrrev_b32 v152, 2, v150
    v_lshlrev_b32 v151, 3, v151
    v_add_u32 v151, v151, v152
    v_lshlrev_b32 v151, 7, v151
    v_lshrrev_b32 v152, 3, v150
    v_xor_b32 v152, s29, v152
    v_lshlrev_b32 v152, 6, v152
    v_add_u32 v151, v151, v152
    v_lshrrev_b32 v152, 4, v1
    v_and_b32 v152, 1, v152
    v_lshlrev_b32 v152, 5, v152
    v_add_u32 v151, v151, v152
    v_and_b32 v150, 3, v150
    v_lshlrev_b32 v150, 3, v150
    v_add_u32 v151, v151, v150
    v_add_u32 v151, 8192, v151
    s_lshl_b32 s56, s29, 12
    v_add_u32 v12, s56, v151
    s_sub_u32 s56, 4096, s56
    v_add_u32 v13, s56, v151
    v_mov_b32 v128, 0x3f803f80
    v_mov_b32 v129, 0x3f803f80
    v_mov_b32 v130, 0x3f803f80
    v_mov_b32 v131, 0x3f803f80
    v_and_b32 v150, 31, v1
    v_lshrrev_b32 v151, 4, v150
    v_lshlrev_b32 v151, 1, v151
    v_lshrrev_b32 v152, 2, v150
    v_and_b32 v152, 1, v152
    v_add_u32 v151, v151, v152
    v_lshlrev_b32 v160, 8, v151
    v_lshlrev_b32 v152, 3, v152
    v_lshrrev_b32 v151, 5, v1
    v_lshlrev_b32 v151, 3, v151
    v_add_u32 v152, v152, v151
    v_and_b32 v151, 3, v150
    v_add_u32 v152, v152, v151
    v_lshrrev_b32 v151, 3, v150
    v_and_b32 v151, 1, v151
    v_lshlrev_b32 v151, 2, v151
    v_add_u32 v152, v152, v151
    v_and_b32 v152, 15, v152
    v_lshlrev_b32 v152, 4, v152
    v_add_u32 v160, v160, v152
    v_min_u32 v163, 3, v1
    v_lshlrev_b32 v163, 2, v163
    v_add_u32 v163, 149584, v163
    s_lshl_b32 s56, s24, 1
    s_add_u32 s56, s56, s28
    s_lshl_b32 s56, s56, 5
    s_lshl_b32 s57, s25, 2
    s_add_u32 s56, s56, s57
    s_lshl_b32 s57, s29, 1
    s_add_u32 s56, s56, s57
    s_lshl_b32 s32, s56, 10
    v_add_u32 v148, 114688, v160
    v_and_b32 v3, 31, v1
    v_and_b32 v4, 11, v3
    v_min_u32 v4, 1, v4
    v_add_u32 v4, 16, v4
    v_min_u32 v3, v4, v3
    v_lshlrev_b32 v3, 4, v3
    v_lshrrev_b32 v4, 5, v1
    v_mul_u32_u24 v4, 288, v4
    v_add_u32 v3, v3, v4
    v_add_u32 v149, 115712, v3
    v_min_u32 v14, 3, v1
    v_lshlrev_b32 v14, 2, v14
    v_add_u32 v14, 149600, v14
    s_waitcnt lgkmcnt(0)
    s_mov_b32 s6, 268435456
    s_mov_b32 s7, 0x20000
    s_mov_b32 s8, s36
    s_mov_b32 s9, s37
    s_mov_b32 s10, 2097152
    s_mov_b32 s11, 0x20000
    s_lshl_b32 s35, s24, 1
    s_add_u32 s35, s35, s28
    s_lshl_b32 s35, s35, 9
    s_add_u32 s35, s35, 2392064
    s_mov_b32 s31, 0
    s_setprio 3
    s_cmp_ge_u32 s31, 1
    s_cbranch_scc1 L_mega_kernel_qrdy_8
    s_mov_b32 s57, 400000
L_mega_kernel_qlp_9:
    ds_read_b32 v159, v14
    s_waitcnt lgkmcnt(0)
    v_readlane_b32 s64, v159, 0
    v_readlane_b32 s65, v159, 1
    v_readlane_b32 s66, v159, 2
    v_readlane_b32 s67, v159, 3
    s_min_u32 s64, s64, s65
    s_min_u32 s66, s66, s67
    s_min_u32 s31, s64, s66
    s_sub_u32 s57, s57, 1
    s_cmp_ge_u32 s31, 1
    s_cbranch_scc1 L_mega_kernel_qrdy_8
    s_sleep 1
    s_cmp_lg_u32 s57, 0
    s_cbranch_scc1 L_mega_kernel_qlp_9
L_mega_kernel_qrdy_8:
    v_add_u32 v8, 81920, v8
    v_add_u32 v9, 81920, v9
    v_add_u32 v10, 81920, v10
    v_add_u32 v11, 81920, v11
    v_add_u32 v12, 81920, v12
    v_add_u32 v13, 81920, v13
    ds_read_b128 v[80:83], v8
    ds_read_b64_tr_b16 v[132:133], v12 offset:0
    ds_read_b64_tr_b16 v[134:135], v12 offset:512
    ds_read_b128 v[84:87], v9
    ds_read_b64_tr_b16 v[136:137], v12 offset:2048
    ds_read_b64_tr_b16 v[138:139], v12 offset:2560
    ds_read_b128 v[88:91], v10
    ds_read_b64_tr_b16 v[140:141], v13 offset:0
    ds_read_b64_tr_b16 v[142:143], v13 offset:512
    ds_read_b128 v[92:95], v11
    ds_read_b64_tr_b16 v[144:145], v13 offset:2048
    ds_read_b64_tr_b16 v[146:147], v13 offset:2560
    s_cmp_ge_u32 s31, 2
    s_cbranch_scc1 L_mega_kernel_qrdy_10
    s_mov_b32 s57, 400000
L_mega_kernel_qlp_11:
    ds_read_b32 v159, v14
    s_waitcnt lgkmcnt(0)
    v_readlane_b32 s64, v159, 0
    v_readlane_b32 s65, v159, 1
    v_readlane_b32 s66, v159, 2
    v_readlane_b32 s67, v159, 3
    s_min_u32 s64, s64, s65
    s_min_u32 s66, s66, s67
    s_min_u32 s31, s64, s66
    s_sub_u32 s57, s57, 1
    s_cmp_ge_u32 s31, 2
    s_cbranch_scc1 L_mega_kernel_qrdy_10
    s_sleep 1
    s_cmp_lg_u32 s57, 0
    s_cbranch_scc1 L_mega_kernel_qlp_11
L_mega_kernel_qrdy_10:
    s_waitcnt lgkmcnt(9)
    v_mfma_f32_32x32x16_bf16 v[48:63], v[132:135], v[80:83], 0
    v_subrev_u32 v8, 81920, v8
    v_subrev_u32 v9, 81920, v9
    v_subrev_u32 v10, 81920, v10
    v_mfma_f32_32x32x16_bf16 v[64:79], v[132:135], v[128:131], 0
    v_subrev_u32 v11, 81920, v11
    v_subrev_u32 v12, 81920, v12
    v_subrev_u32 v13, 81920, v13
    s_waitcnt lgkmcnt(6)
    v_mfma_f32_32x32x16_bf16 v[48:63], v[136:139], v[84:87], v[48:63]
    ds_read_b128 v[16:19], v8
    ds_read_b64_tr_b16 v[32:33], v12 offset:0
    ds_read_b64_tr_b16 v[34:35], v12 offset:512
    v_mfma_f32_32x32x16_bf16 v[64:79], v[136:139], v[128:131], v[64:79]
    ds_read_b128 v[20:23], v9
    ds_read_b64_tr_b16 v[36:37], v12 offset:2048
    ds_read_b64_tr_b16 v[38:39], v12 offset:2560
    s_waitcnt lgkmcnt(9)
    v_mfma_f32_32x32x16_bf16 v[48:63], v[140:143], v[88:91], v[48:63]
    ds_read_b128 v[24:27], v10
    ds_read_b64_tr_b16 v[40:41], v13 offset:0
    ds_read_b64_tr_b16 v[42:43], v13 offset:512
    v_mfma_f32_32x32x16_bf16 v[64:79], v[140:143], v[128:131], v[64:79]
    ds_read_b128 v[28:31], v11
    ds_read_b64_tr_b16 v[44:45], v13 offset:2048
    ds_read_b64_tr_b16 v[46:47], v13 offset:2560
    s_waitcnt lgkmcnt(12)
    v_mfma_f32_32x32x16_bf16 v[48:63], v[144:147], v[92:95], v[48:63]
    v_mfma_f32_32x32x16_bf16 v[64:79], v[144:147], v[128:131], v[64:79]
    s_mov_b64 exec, 2
    ds_add_u32 v157, v1
    s_mov_b64 exec, -1
    s_cmp_ge_u32 s31, 3
    s_cbranch_scc1 L_mega_kernel_qrdy_12
    s_mov_b32 s57, 400000
L_mega_kernel_qlp_13:
    ds_read_b32 v159, v14
    s_waitcnt lgkmcnt(0)
    v_readlane_b32 s64, v159, 0
    v_readlane_b32 s65, v159, 1
    v_readlane_b32 s66, v159, 2
    v_readlane_b32 s67, v159, 3
    s_min_u32 s64, s64, s65
    s_min_u32 s66, s66, s67
    s_min_u32 s31, s64, s66
    s_sub_u32 s57, s57, 1
    s_cmp_ge_u32 s31, 3
    s_cbranch_scc1 L_mega_kernel_qrdy_12
    s_sleep 1
    s_cmp_lg_u32 s57, 0
    s_cbranch_scc1 L_mega_kernel_qlp_13
L_mega_kernel_qrdy_12:
    s_waitcnt lgkmcnt(10)
    v_mfma_f32_32x32x16_bf16 v[48:63], v[32:35], v[16:19], v[48:63]
    v_add_u32 v8, 16384, v8
    v_add_u32 v9, 16384, v9
    v_add_u32 v10, 16384, v10
    v_mfma_f32_32x32x16_bf16 v[64:79], v[32:35], v[128:131], v[64:79]
    v_add_u32 v11, 16384, v11
    v_add_u32 v12, 16384, v12
    v_add_u32 v13, 16384, v13
    s_waitcnt lgkmcnt(7)
    v_mfma_f32_32x32x16_bf16 v[48:63], v[36:39], v[20:23], v[48:63]
    ds_read_b128 v[80:83], v8
    ds_read_b64_tr_b16 v[132:133], v12 offset:0
    ds_read_b64_tr_b16 v[134:135], v12 offset:512
    v_mfma_f32_32x32x16_bf16 v[64:79], v[36:39], v[128:131], v[64:79]
    ds_read_b128 v[84:87], v9
    ds_read_b64_tr_b16 v[136:137], v12 offset:2048
    ds_read_b64_tr_b16 v[138:139], v12 offset:2560
    s_waitcnt lgkmcnt(10)
    v_mfma_f32_32x32x16_bf16 v[48:63], v[40:43], v[24:27], v[48:63]
    ds_read_b128 v[88:91], v10
    ds_read_b64_tr_b16 v[140:141], v13 offset:0
    ds_read_b64_tr_b16 v[142:143], v13 offset:512
    v_mfma_f32_32x32x16_bf16 v[64:79], v[40:43], v[128:131], v[64:79]
    ds_read_b128 v[92:95], v11
    ds_read_b64_tr_b16 v[144:145], v13 offset:2048
    ds_read_b64_tr_b16 v[146:147], v13 offset:2560
    s_waitcnt lgkmcnt(13)
    v_mfma_f32_32x32x16_bf16 v[48:63], v[44:47], v[28:31], v[48:63]
    v_mfma_f32_32x32x16_bf16 v[64:79], v[44:47], v[128:131], v[64:79]
    s_cmp_ge_u32 s31, 4
    s_cbranch_scc1 L_mega_kernel_qrdy_14
    s_mov_b32 s57, 400000
L_mega_kernel_qlp_15:
    ds_read_b32 v159, v14
    s_waitcnt lgkmcnt(0)
    v_readlane_b32 s64, v159, 0
    v_readlane_b32 s65, v159, 1
    v_readlane_b32 s66, v159, 2
    v_readlane_b32 s67, v159, 3
    s_min_u32 s64, s64, s65
    s_min_u32 s66, s66, s67
    s_min_u32 s31, s64, s66
    s_sub_u32 s57, s57, 1
    s_cmp_ge_u32 s31, 4
    s_cbranch_scc1 L_mega_kernel_qrdy_14
    s_sleep 1
    s_cmp_lg_u32 s57, 0
    s_cbranch_scc1 L_mega_kernel_qlp_15
L_mega_kernel_qrdy_14:
    s_waitcnt lgkmcnt(9)
    v_mfma_f32_32x32x16_bf16 v[48:63], v[132:135], v[80:83], v[48:63]
    v_add_u32 v8, 81920, v8
    v_add_u32 v9, 81920, v9
    v_add_u32 v10, 81920, v10
    v_mfma_f32_32x32x16_bf16 v[64:79], v[132:135], v[128:131], v[64:79]
    v_add_u32 v11, 81920, v11
    v_add_u32 v12, 81920, v12
    v_add_u32 v13, 81920, v13
    s_waitcnt lgkmcnt(6)
    v_mfma_f32_32x32x16_bf16 v[48:63], v[136:139], v[84:87], v[48:63]
    ds_read_b128 v[16:19], v8
    ds_read_b64_tr_b16 v[32:33], v12 offset:0
    ds_read_b64_tr_b16 v[34:35], v12 offset:512
    v_mfma_f32_32x32x16_bf16 v[64:79], v[136:139], v[128:131], v[64:79]
    ds_read_b128 v[20:23], v9
    ds_read_b64_tr_b16 v[36:37], v12 offset:2048
    ds_read_b64_tr_b16 v[38:39], v12 offset:2560
    s_waitcnt lgkmcnt(9)
    v_mfma_f32_32x32x16_bf16 v[48:63], v[140:143], v[88:91], v[48:63]
    ds_read_b128 v[24:27], v10
    ds_read_b64_tr_b16 v[40:41], v13 offset:0
    ds_read_b64_tr_b16 v[42:43], v13 offset:512
    v_mfma_f32_32x32x16_bf16 v[64:79], v[140:143], v[128:131], v[64:79]
    ds_read_b128 v[28:31], v11
    ds_read_b64_tr_b16 v[44:45], v13 offset:2048
    ds_read_b64_tr_b16 v[46:47], v13 offset:2560
    s_waitcnt lgkmcnt(12)
    v_mfma_f32_32x32x16_bf16 v[48:63], v[144:147], v[92:95], v[48:63]
    v_mfma_f32_32x32x16_bf16 v[64:79], v[144:147], v[128:131], v[64:79]
    s_cmp_ge_u32 s31, 5
    s_cbranch_scc1 L_mega_kernel_qrdy_16
    s_mov_b32 s57, 400000
L_mega_kernel_qlp_17:
    ds_read_b32 v159, v14
    s_waitcnt lgkmcnt(0)
    v_readlane_b32 s64, v159, 0
    v_readlane_b32 s65, v159, 1
    v_readlane_b32 s66, v159, 2
    v_readlane_b32 s67, v159, 3
    s_min_u32 s64, s64, s65
    s_min_u32 s66, s66, s67
    s_min_u32 s31, s64, s66
    s_sub_u32 s57, s57, 1
    s_cmp_ge_u32 s31, 5
    s_cbranch_scc1 L_mega_kernel_qrdy_16
    s_sleep 1
    s_cmp_lg_u32 s57, 0
    s_cbranch_scc1 L_mega_kernel_qlp_17
L_mega_kernel_qrdy_16:
    s_waitcnt lgkmcnt(9)
    v_mfma_f32_32x32x16_bf16 v[48:63], v[32:35], v[16:19], v[48:63]
    v_subrev_u32 v8, 65536, v8
    v_subrev_u32 v9, 65536, v9
    v_subrev_u32 v10, 65536, v10
    v_mfma_f32_32x32x16_bf16 v[64:79], v[32:35], v[128:131], v[64:79]
    v_subrev_u32 v11, 65536, v11
    v_subrev_u32 v12, 65536, v12
    v_subrev_u32 v13, 65536, v13
    s_waitcnt lgkmcnt(6)
    v_mfma_f32_32x32x16_bf16 v[48:63], v[36:39], v[20:23], v[48:63]
    ds_read_b128 v[80:83], v8
    ds_read_b64_tr_b16 v[132:133], v12 offset:0
    ds_read_b64_tr_b16 v[134:135], v12 offset:512
    v_mfma_f32_32x32x16_bf16 v[64:79], v[36:39], v[128:131], v[64:79]
    ds_read_b128 v[84:87], v9
    ds_read_b64_tr_b16 v[136:137], v12 offset:2048
    ds_read_b64_tr_b16 v[138:139], v12 offset:2560
    s_waitcnt lgkmcnt(9)
    v_mfma_f32_32x32x16_bf16 v[48:63], v[40:43], v[24:27], v[48:63]
    ds_read_b128 v[88:91], v10
    ds_read_b64_tr_b16 v[140:141], v13 offset:0
    ds_read_b64_tr_b16 v[142:143], v13 offset:512
    v_mfma_f32_32x32x16_bf16 v[64:79], v[40:43], v[128:131], v[64:79]
    ds_read_b128 v[92:95], v11
    ds_read_b64_tr_b16 v[144:145], v13 offset:2048
    ds_read_b64_tr_b16 v[146:147], v13 offset:2560
    s_waitcnt lgkmcnt(12)
    v_mfma_f32_32x32x16_bf16 v[48:63], v[44:47], v[28:31], v[48:63]
    v_mfma_f32_32x32x16_bf16 v[64:79], v[44:47], v[128:131], v[64:79]
    s_mov_b64 exec, 8
    ds_add_u32 v157, v1
    s_mov_b64 exec, -1
    s_cmp_ge_u32 s31, 6
    s_cbranch_scc1 L_mega_kernel_qrdy_18
    s_mov_b32 s57, 400000
L_mega_kernel_qlp_19:
    ds_read_b32 v159, v14
    s_waitcnt lgkmcnt(0)
    v_readlane_b32 s64, v159, 0
    v_readlane_b32 s65, v159, 1
    v_readlane_b32 s66, v159, 2
    v_readlane_b32 s67, v159, 3
    s_min_u32 s64, s64, s65
    s_min_u32 s66, s66, s67
    s_min_u32 s31, s64, s66
    s_sub_u32 s57, s57, 1
    s_cmp_ge_u32 s31, 6
    s_cbranch_scc1 L_mega_kernel_qrdy_18
    s_sleep 1
    s_cmp_lg_u32 s57, 0
    s_cbranch_scc1 L_mega_kernel_qlp_19
L_mega_kernel_qrdy_18:
    s_waitcnt lgkmcnt(10)
    v_mfma_f32_32x32x16_bf16 v[48:63], v[132:135], v[80:83], v[48:63]
    v_add_u32 v8, 16384, v8
    v_add_u32 v9, 16384, v9
    v_add_u32 v10, 16384, v10
    v_mfma_f32_32x32x16_bf16 v[64:79], v[132:135], v[128:131], v[64:79]
    v_add_u32 v11, 16384, v11
    v_add_u32 v12, 16384, v12
    v_add_u32 v13, 16384, v13
    s_waitcnt lgkmcnt(7)
    v_mfma_f32_32x32x16_bf16 v[48:63], v[136:139], v[84:87], v[48:63]
    ds_read_b128 v[16:19], v8
    ds_read_b64_tr_b16 v[32:33], v12 offset:0
    ds_read_b64_tr_b16 v[34:35], v12 offset:512
    v_mfma_f32_32x32x16_bf16 v[64:79], v[136:139], v[128:131], v[64:79]
    ds_read_b128 v[20:23], v9
    ds_read_b64_tr_b16 v[36:37], v12 offset:2048
    ds_read_b64_tr_b16 v[38:39], v12 offset:2560
    s_waitcnt lgkmcnt(10)
    v_mfma_f32_32x32x16_bf16 v[48:63], v[140:143], v[88:91], v[48:63]
    ds_read_b128 v[24:27], v10
    ds_read_b64_tr_b16 v[40:41], v13 offset:0
    ds_read_b64_tr_b16 v[42:43], v13 offset:512
    v_mfma_f32_32x32x16_bf16 v[64:79], v[140:143], v[128:131], v[64:79]
    ds_read_b128 v[28:31], v11
    ds_read_b64_tr_b16 v[44:45], v13 offset:2048
    ds_read_b64_tr_b16 v[46:47], v13 offset:2560
    s_waitcnt lgkmcnt(13)
    v_mfma_f32_32x32x16_bf16 v[48:63], v[144:147], v[92:95], v[48:63]
    v_mfma_f32_32x32x16_bf16 v[64:79], v[144:147], v[128:131], v[64:79]
    s_cmp_ge_u32 s31, 7
    s_cbranch_scc1 L_mega_kernel_qrdy_20
    s_mov_b32 s57, 400000
L_mega_kernel_qlp_21:
    ds_read_b32 v159, v14
    s_waitcnt lgkmcnt(0)
    v_readlane_b32 s64, v159, 0
    v_readlane_b32 s65, v159, 1
    v_readlane_b32 s66, v159, 2
    v_readlane_b32 s67, v159, 3
    s_min_u32 s64, s64, s65
    s_min_u32 s66, s66, s67
    s_min_u32 s31, s64, s66
    s_sub_u32 s57, s57, 1
    s_cmp_ge_u32 s31, 7
    s_cbranch_scc1 L_mega_kernel_qrdy_20
    s_sleep 1
    s_cmp_lg_u32 s57, 0
    s_cbranch_scc1 L_mega_kernel_qlp_21
L_mega_kernel_qrdy_20:
    v_and_b32 v150, 31, v1
    v_lshlrev_b32 v150, 4, v150
    buffer_load_dwordx4 v[164:167], v150, s[4:7], s35 offen sc1
    s_waitcnt lgkmcnt(9)
    v_mfma_f32_32x32x16_bf16 v[48:63], v[32:35], v[16:19], v[48:63]
    v_add_u32 v8, 16384, v8
    v_add_u32 v9, 16384, v9
    v_add_u32 v10, 16384, v10
    v_mfma_f32_32x32x16_bf16 v[64:79], v[32:35], v[128:131], v[64:79]
    v_add_u32 v11, 16384, v11
    v_add_u32 v12, 16384, v12
    v_add_u32 v13, 16384, v13
    s_waitcnt lgkmcnt(6)
    v_mfma_f32_32x32x16_bf16 v[48:63], v[36:39], v[20:23], v[48:63]
    ds_read_b128 v[80:83], v8
    ds_read_b64_tr_b16 v[132:133], v12 offset:0
    ds_read_b64_tr_b16 v[134:135], v12 offset:512
    v_mfma_f32_32x32x16_bf16 v[64:79], v[36:39], v[128:131], v[64:79]
    ds_read_b128 v[84:87], v9
    ds_read_b64_tr_b16 v[136:137], v12 offset:2048
    ds_read_b64_tr_b16 v[138:139], v12 offset:2560
    s_waitcnt lgkmcnt(9)
    v_mfma_f32_32x32x16_bf16 v[48:63], v[40:43], v[24:27], v[48:63]
    ds_read_b128 v[88:91], v10
    ds_read_b64_tr_b16 v[140:141], v13 offset:0
    ds_read_b64_tr_b16 v[142:143], v13 offset:512
    v_mfma_f32_32x32x16_bf16 v[64:79], v[40:43], v[128:131], v[64:79]
    ds_read_b128 v[92:95], v11
    ds_read_b64_tr_b16 v[144:145], v13 offset:2048
    ds_read_b64_tr_b16 v[146:147], v13 offset:2560
    s_waitcnt lgkmcnt(12)
    v_mfma_f32_32x32x16_bf16 v[48:63], v[44:47], v[28:31], v[48:63]
    v_mfma_f32_32x32x16_bf16 v[64:79], v[44:47], v[128:131], v[64:79]
    s_cmp_ge_u32 s31, 8
    s_cbranch_scc1 L_mega_kernel_qrdy_22
    s_mov_b32 s57, 400000
L_mega_kernel_qlp_23:
    ds_read_b32 v159, v14
    s_waitcnt lgkmcnt(0)
    v_readlane_b32 s64, v159, 0
    v_readlane_b32 s65, v159, 1
    v_readlane_b32 s66, v159, 2
    v_readlane_b32 s67, v159, 3
    s_min_u32 s64, s64, s65
    s_min_u32 s66, s66, s67
    s_min_u32 s31, s64, s66
    s_sub_u32 s57, s57, 1
    s_cmp_ge_u32 s31, 8
    s_cbranch_scc1 L_mega_kernel_qrdy_22
    s_sleep 1
    s_cmp_lg_u32 s57, 0
    s_cbranch_scc1 L_mega_kernel_qlp_23
L_mega_kernel_qrdy_22:
    s_waitcnt lgkmcnt(9)
    v_mfma_f32_32x32x16_bf16 v[48:63], v[132:135], v[80:83], v[48:63]
    v_add_u32 v8, 16384, v8
    v_add_u32 v9, 16384, v9
    v_add_u32 v10, 16384, v10
    v_mfma_f32_32x32x16_bf16 v[64:79], v[132:135], v[128:131], v[64:79]
    v_add_u32 v11, 16384, v11
    v_add_u32 v12, 16384, v12
    v_add_u32 v13, 16384, v13
    s_waitcnt lgkmcnt(6)
    v_mfma_f32_32x32x16_bf16 v[48:63], v[136:139], v[84:87], v[48:63]
    ds_read_b128 v[16:19], v8
    ds_read_b64_tr_b16 v[32:33], v12 offset:0
    ds_read_b64_tr_b16 v[34:35], v12 offset:512
    v_mfma_f32_32x32x16_bf16 v[64:79], v[136:139], v[128:131], v[64:79]
    ds_read_b128 v[20:23], v9
    ds_read_b64_tr_b16 v[36:37], v12 offset:2048
    ds_read_b64_tr_b16 v[38:39], v12 offset:2560
    s_waitcnt lgkmcnt(9)
    v_mfma_f32_32x32x16_bf16 v[48:63], v[140:143], v[88:91], v[48:63]
    ds_read_b128 v[24:27], v10
    ds_read_b64_tr_b16 v[40:41], v13 offset:0
    ds_read_b64_tr_b16 v[42:43], v13 offset:512
    v_mfma_f32_32x32x16_bf16 v[64:79], v[140:143], v[128:131], v[64:79]
    ds_read_b128 v[28:31], v11
    ds_read_b64_tr_b16 v[44:45], v13 offset:2048
    ds_read_b64_tr_b16 v[46:47], v13 offset:2560
    s_waitcnt lgkmcnt(12)
    v_mfma_f32_32x32x16_bf16 v[48:63], v[144:147], v[92:95], v[48:63]
    v_mfma_f32_32x32x16_bf16 v[64:79], v[144:147], v[128:131], v[64:79]
    s_mov_b64 exec, 8
    ds_add_u32 v157, v1
    s_mov_b64 exec, -1
    s_waitcnt lgkmcnt(10)
    v_mfma_f32_32x32x16_bf16 v[48:63], v[32:35], v[16:19], v[48:63]
    ds_read_b32 v154, v156 offset:4
    ds_read_b32 v155, v156 offset:60
    v_mov_b32 v88, 0
    v_mfma_f32_32x32x16_bf16 v[64:79], v[32:35], v[128:131], v[64:79]
    v_mov_b32 v89, 0
    v_mov_b32 v90, 0
    v_mov_b32 v91, 0
    s_waitcnt lgkmcnt(9)
    v_mfma_f32_32x32x16_bf16 v[48:63], v[36:39], v[20:23], v[48:63]
    v_mov_b32 v92, 0
    v_mov_b32 v93, 0
    v_mov_b32 v94, 0
    v_mfma_f32_32x32x16_bf16 v[64:79], v[36:39], v[128:131], v[64:79]
    v_mov_b32 v95, 0
    v_mov_b32 v140, 0
    v_mov_b32 v141, 0
    s_waitcnt lgkmcnt(6)
    v_mfma_f32_32x32x16_bf16 v[48:63], v[40:43], v[24:27], v[48:63]
    v_mov_b32 v142, 0
    v_mov_b32 v143, 0
    v_mov_b32 v144, 0
    v_mfma_f32_32x32x16_bf16 v[64:79], v[40:43], v[128:131], v[64:79]
    v_mov_b32 v145, 0
    v_mov_b32 v146, 0
    v_mov_b32 v147, 0
    s_waitcnt lgkmcnt(3)
    v_mfma_f32_32x32x16_bf16 v[48:63], v[44:47], v[28:31], v[48:63]
    v_mfma_f32_32x32x16_bf16 v[64:79], v[44:47], v[128:131], v[64:79]
    s_mov_b64 exec, 2
    ds_add_u32 v157, v1
    s_mov_b64 exec, -1
    s_waitcnt lgkmcnt(1)
    v_readfirstlane_b32 s56, v154
    v_readfirstlane_b32 s23, v155
    s_cmp_ge_u32 s56, 2
    s_cbranch_scc1 L_mega_kernel_tlok_24
    s_mov_b32 s57, 400000
L_mega_kernel_lp_25:
    ds_read_b32 v159, v156 offset:4
    s_waitcnt lgkmcnt(0)
    v_readfirstlane_b32 s56, v159
    s_sub_u32 s57, s57, 1
    s_cmp_ge_u32 s56, 2
    s_cbranch_scc1 L_mega_kernel_ok_26
    s_cmp_lg_u32 s57, 0
    s_cbranch_scc1 L_mega_kernel_lp_25
L_mega_kernel_ok_26:
    ds_read_b32 v159, v156 offset:60
    s_waitcnt lgkmcnt(0)
    v_readfirstlane_b32 s23, v159
L_mega_kernel_tlok_24:
    s_add_u32 s34, s23, 1
    s_or_b32 s34, s34, 1
    s_mov_b32 s62, 100000
L_mega_kernel_stgr_27:
    s_waitcnt vmcnt(0)
    v_bitop3_b32 v150, v164, v166, s34 bitop3:0x96
    v_bitop3_b32 v151, v165, v167, s34 bitop3:0x96
    v_or_b32 v150, v150, v151
    v_cmp_ne_u32 vcc, 0, v150
    s_sub_u32 s62, s62, 1
    s_cmp_eq_u64 vcc, 0
    s_cbranch_scc1 L_mega_kernel_stgok_28
    s_cmp_eq_u32 s62, 0
    s_cbranch_scc1 L_mega_kernel_stgok_28
    v_and_b32 v150, 31, v1
    v_lshlrev_b32 v150, 4, v150
    buffer_load_dwordx4 v[164:167], v150, s[4:7], s35 offen sc1
    s_branch L_mega_kernel_stgr_27
L_mega_kernel_stgok_28:
    v_mul_f32 v165, 0x3eb8aa3b, v165
    s_nop 4
    v_pk_fma_f32 v[48:49], v[164:165], v[64:65], v[48:49] op_sel_hi:[0,1,1]
    v_pk_fma_f32 v[50:51], v[164:165], v[66:67], v[50:51] op_sel_hi:[0,1,1]
    v_pk_fma_f32 v[52:53], v[164:165], v[68:69], v[52:53] op_sel_hi:[0,1,1]
    v_pk_fma_f32 v[54:55], v[164:165], v[70:71], v[54:55] op_sel_hi:[0,1,1]
    v_pk_fma_f32 v[56:57], v[164:165], v[72:73], v[56:57] op_sel_hi:[0,1,1]
    v_pk_fma_f32 v[58:59], v[164:165], v[74:75], v[58:59] op_sel_hi:[0,1,1]
    v_pk_fma_f32 v[60:61], v[164:165], v[76:77], v[60:61] op_sel_hi:[0,1,1]
    v_pk_fma_f32 v[62:63], v[164:165], v[78:79], v[62:63] op_sel_hi:[0,1,1]
    v_pk_mul_f32 v[48:49], v[48:49], v[164:165] op_sel:[0,1] op_sel_hi:[1,1]
    v_pk_mul_f32 v[50:51], v[50:51], v[164:165] op_sel:[0,1] op_sel_hi:[1,1]
    v_pk_mul_f32 v[52:53], v[52:53], v[164:165] op_sel:[0,1] op_sel_hi:[1,1]
    v_pk_mul_f32 v[54:55], v[54:55], v[164:165] op_sel:[0,1] op_sel_hi:[1,1]
    v_pk_mul_f32 v[56:57], v[56:57], v[164:165] op_sel:[0,1] op_sel_hi:[1,1]
    v_pk_mul_f32 v[58:59], v[58:59], v[164:165] op_sel:[0,1] op_sel_hi:[1,1]
    v_pk_mul_f32 v[60:61], v[60:61], v[164:165] op_sel:[0,1] op_sel_hi:[1,1]
    v_pk_mul_f32 v[62:63], v[62:63], v[164:165] op_sel:[0,1] op_sel_hi:[1,1]
    v_cvt_pk_bf16_f32 v8, v48, v49
    v_cvt_pk_bf16_f32 v9, v50, v51
    v_cvt_pk_bf16_f32 v10, v52, v53
    v_cvt_pk_bf16_f32 v11, v54, v55
    v_cvt_pk_bf16_f32 v12, v56, v57
    v_cvt_pk_bf16_f32 v13, v58, v59
    v_cvt_pk_bf16_f32 v14, v60, v61
    v_cvt_pk_bf16_f32 v15, v62, v63
    v_pk_mul_f32 v[150:151], v[48:49], v[48:49]
    v_pk_mul_f32 v[152:153], v[56:57], v[56:57]
    v_pk_fma_f32 v[150:151], v[50:51], v[50:51], v[150:151]
    v_pk_fma_f32 v[152:153], v[58:59], v[58:59], v[152:153]
    v_pk_fma_f32 v[150:151], v[52:53], v[52:53], v[150:151]
    v_pk_fma_f32 v[152:153], v[60:61], v[60:61], v[152:153]
    v_pk_fma_f32 v[150:151], v[54:55], v[54:55], v[150:151]
    v_pk_fma_f32 v[152:153], v[62:63], v[62:63], v[152:153]
    v_add_f32 v161, v150, v151
    v_add_f32 v162, v152, v153
    v_mov_b32 v150, v161
    v_mov_b32 v151, v162
    s_nop 1
    v_permlane32_swap_b32 v161, v150
    v_permlane32_swap_b32 v162, v151
    s_nop 1
    v_add_f32 v161, v161, v150
    v_add_f32 v162, v162, v151
    s_mov_b32 s57, 400000
L_mega_kernel_lp_29:
    ds_read_b32 v159, v156 offset:12
    s_waitcnt lgkmcnt(0)
    v_readfirstlane_b32 s56, v159
    s_sub_u32 s57, s57, 1
    s_cmp_ge_u32 s56, 1
    s_cbranch_scc1 L_mega_kernel_ok_30
    s_cmp_lg_u32 s57, 0
    s_cbranch_scc1 L_mega_kernel_lp_29
L_mega_kernel_ok_30:
    ds_read_b128 v[128:131], v148
    s_waitcnt lgkmcnt(0)
    v_mfma_f32_32x32x16_bf16 v[48:63], v[128:131], v[8:11], 0
    s_nop 7
    s_nop 7
    s_setprio 0
    s_mov_b32 s62, 0
    s_mov_b32 s65, 1
    s_mov_b32 s72, 0
    .p2align 6
L_mega_kernel_attnloop_31:
    v_mfma_f32_32x32x16_bf16 v[64:79], v[128:131], v[12:15], 0
    ds_read_b128 v[128:131], v148 offset:2176
    ds_read_b128 v[132:135], v149 offset:0
    ds_read_b128 v[136:139], v149 offset:576
    v_exp_f32 v48, v48
    v_exp_f32 v49, v49
    v_exp_f32 v50, v50
    v_mfma_f32_32x32x16_bf16 v[112:127], v[140:143], v[88:91], v[112:127]
    v_exp_f32 v51, v51
    v_exp_f32 v52, v52
    v_exp_f32 v53, v53
    v_mfma_f32_32x32x16_bf16 v[112:127], v[144:147], v[92:95], v[112:127]
    v_exp_f32 v54, v54
    v_exp_f32 v55, v55
    v_cvt_pk_bf16_f32 v80, v48, v49
    v_exp_f32 v56, v56
    v_exp_f32 v57, v57
    v_cvt_pk_bf16_f32 v81, v50, v51
    v_exp_f32 v58, v58
    v_exp_f32 v59, v59
    v_cvt_pk_bf16_f32 v82, v52, v53
    v_exp_f32 v60, v60
    v_exp_f32 v61, v61
    v_cvt_pk_bf16_f32 v83, v54, v55
    v_exp_f32 v62, v62
    v_exp_f32 v63, v63
    v_cvt_pk_bf16_f32 v84, v56, v57
    v_cvt_pk_bf16_f32 v85, v58, v59
    v_cvt_pk_bf16_f32 v86, v60, v61
    v_cvt_pk_bf16_f32 v87, v62, v63
    s_waitcnt lgkmcnt(0)
    v_mfma_f32_32x32x16_bf16 v[48:63], v[128:131], v[8:11], 0
    v_exp_f32 v64, v64
    v_exp_f32 v65, v65
    v_exp_f32 v66, v66
    v_mfma_f32_32x32x16_bf16 v[96:111], v[132:135], v[80:83], v[96:111]
    v_exp_f32 v67, v67
    v_exp_f32 v68, v68
    v_exp_f32 v69, v69
    v_mfma_f32_32x32x16_bf16 v[96:111], v[136:139], v[84:87], v[96:111]
    v_exp_f32 v70, v70
    v_exp_f32 v71, v71
    v_cvt_pk_bf16_f32 v88, v64, v65
    v_exp_f32 v72, v72
    v_exp_f32 v73, v73
    v_cvt_pk_bf16_f32 v89, v66, v67
    v_exp_f32 v74, v74
    v_exp_f32 v75, v75
    v_cvt_pk_bf16_f32 v90, v68, v69
    v_exp_f32 v76, v76
    v_exp_f32 v77, v77
    v_cvt_pk_bf16_f32 v91, v70, v71
    v_exp_f32 v78, v78
    v_exp_f32 v79, v79
    v_cvt_pk_bf16_f32 v92, v72, v73
    v_cvt_pk_bf16_f32 v93, v74, v75
    v_cvt_pk_bf16_f32 v94, v76, v77
    v_cvt_pk_bf16_f32 v95, v78, v79
    v_mfma_f32_32x32x16_bf16 v[64:79], v[128:131], v[12:15], 0
    ds_read_b128 v[128:131], v148 offset:4352
    ds_read_b128 v[140:143], v149 offset:2176
    ds_read_b128 v[144:147], v149 offset:2752
    v_exp_f32 v48, v48
    v_exp_f32 v49, v49
    v_exp_f32 v50, v50
    v_mfma_f32_32x32x16_bf16 v[112:127], v[132:135], v[88:91], v[112:127]
    v_exp_f32 v51, v51
    v_exp_f32 v52, v52
    v_exp_f32 v53, v53
    v_mfma_f32_32x32x16_bf16 v[112:127], v[136:139], v[92:95], v[112:127]
    v_exp_f32 v54, v54
    v_exp_f32 v55, v55
    v_cvt_pk_bf16_f32 v80, v48, v49
    v_exp_f32 v56, v56
    v_exp_f32 v57, v57
    v_cvt_pk_bf16_f32 v81, v50, v51
    v_exp_f32 v58, v58
    v_exp_f32 v59, v59
    v_cvt_pk_bf16_f32 v82, v52, v53
    v_exp_f32 v60, v60
    v_exp_f32 v61, v61
    v_cvt_pk_bf16_f32 v83, v54, v55
    v_exp_f32 v62, v62
    v_exp_f32 v63, v63
    v_cvt_pk_bf16_f32 v84, v56, v57
    v_cvt_pk_bf16_f32 v85, v58, v59
    v_cvt_pk_bf16_f32 v86, v60, v61
    v_cvt_pk_bf16_f32 v87, v62, v63
    s_waitcnt lgkmcnt(0)
    v_mfma_f32_32x32x16_bf16 v[48:63], v[128:131], v[8:11], 0
    v_exp_f32 v64, v64
    v_exp_f32 v65, v65
    v_exp_f32 v66, v66
    v_mfma_f32_32x32x16_bf16 v[96:111], v[140:143], v[80:83], v[96:111]
    v_exp_f32 v67, v67
    v_exp_f32 v68, v68
    v_exp_f32 v69, v69
    v_mfma_f32_32x32x16_bf16 v[96:111], v[144:147], v[84:87], v[96:111]
    v_exp_f32 v70, v70
    v_exp_f32 v71, v71
    v_cvt_pk_bf16_f32 v88, v64, v65
    v_exp_f32 v72, v72
    v_exp_f32 v73, v73
    v_cvt_pk_bf16_f32 v89, v66, v67
    v_exp_f32 v74, v74
    v_exp_f32 v75, v75
    v_cvt_pk_bf16_f32 v90, v68, v69
    v_exp_f32 v76, v76
    v_exp_f32 v77, v77
    v_cvt_pk_bf16_f32 v91, v70, v71
    v_exp_f32 v78, v78
    v_exp_f32 v79, v79
    v_cvt_pk_bf16_f32 v92, v72, v73
    v_cvt_pk_bf16_f32 v93, v74, v75
    v_cvt_pk_bf16_f32 v94, v76, v77
    v_cvt_pk_bf16_f32 v95, v78, v79
    v_mfma_f32_32x32x16_bf16 v[64:79], v[128:131], v[12:15], 0
    ds_read_b128 v[128:131], v148 offset:6528
    ds_read_b128 v[132:135], v149 offset:4352
    ds_read_b128 v[136:139], v149 offset:4928
    v_exp_f32 v48, v48
    v_exp_f32 v49, v49
    v_exp_f32 v50, v50
    v_mfma_f32_32x32x16_bf16 v[112:127], v[140:143], v[88:91], v[112:127]
    v_exp_f32 v51, v51
    v_exp_f32 v52, v52
    v_exp_f32 v53, v53
    v_mfma_f32_32x32x16_bf16 v[112:127], v[144:147], v[92:95], v[112:127]
    v_exp_f32 v54, v54
    v_exp_f32 v55, v55
    v_cvt_pk_bf16_f32 v80, v48, v49
    v_exp_f32 v56, v56
    v_exp_f32 v57, v57
    v_cvt_pk_bf16_f32 v81, v50, v51
    v_exp_f32 v58, v58
    v_exp_f32 v59, v59
    v_cvt_pk_bf16_f32 v82, v52, v53
    v_exp_f32 v60, v60
    v_exp_f32 v61, v61
    v_cvt_pk_bf16_f32 v83, v54, v55
    v_exp_f32 v62, v62
    v_exp_f32 v63, v63
    v_cvt_pk_bf16_f32 v84, v56, v57
    v_cvt_pk_bf16_f32 v85, v58, v59
    v_cvt_pk_bf16_f32 v86, v60, v61
    v_cvt_pk_bf16_f32 v87, v62, v63
    s_waitcnt lgkmcnt(0)
    v_mfma_f32_32x32x16_bf16 v[48:63], v[128:131], v[8:11], 0
    v_exp_f32 v64, v64
    v_exp_f32 v65, v65
    v_exp_f32 v66, v66
    v_mfma_f32_32x32x16_bf16 v[96:111], v[132:135], v[80:83], v[96:111]
    v_exp_f32 v67, v67
    v_exp_f32 v68, v68
    v_exp_f32 v69, v69
    v_mfma_f32_32x32x16_bf16 v[96:111], v[136:139], v[84:87], v[96:111]
    v_exp_f32 v70, v70
    v_exp_f32 v71, v71
    v_cvt_pk_bf16_f32 v88, v64, v65
    v_exp_f32 v72, v72
    v_exp_f32 v73, v73
    v_cvt_pk_bf16_f32 v89, v66, v67
    v_exp_f32 v74, v74
    v_exp_f32 v75, v75
    v_cvt_pk_bf16_f32 v90, v68, v69
    v_exp_f32 v76, v76
    v_exp_f32 v77, v77
    v_cvt_pk_bf16_f32 v91, v70, v71
    v_exp_f32 v78, v78
    v_exp_f32 v79, v79
    v_cvt_pk_bf16_f32 v92, v72, v73
    v_cvt_pk_bf16_f32 v93, v74, v75
    v_cvt_pk_bf16_f32 v94, v76, v77
    v_cvt_pk_bf16_f32 v95, v78, v79
    s_cmp_lg_u32 s62, 0
    s_cbranch_scc1 L_mega_kernel_h2_32
    s_mov_b32 s67, 400000
L_mega_kernel_lp_33:
    ds_read_b32 v159, v156 offset:48
    s_waitcnt lgkmcnt(0)
    v_readfirstlane_b32 s66, v159
    s_sub_u32 s67, s67, 1
    s_cmp_ge_u32 s66, 1
    s_cbranch_scc1 L_mega_kernel_ok_34
    s_sleep 1
    s_cmp_lg_u32 s67, 0
    s_cbranch_scc1 L_mega_kernel_lp_33
L_mega_kernel_ok_34:
L_mega_kernel_h2_32:
    v_mfma_f32_32x32x16_bf16 v[64:79], v[128:131], v[12:15], 0
    ds_read_b128 v[128:131], v148 offset:8704
    ds_read_b128 v[140:143], v149 offset:6528
    ds_read_b128 v[144:147], v149 offset:7104
    v_exp_f32 v48, v48
    v_exp_f32 v49, v49
    v_exp_f32 v50, v50
    v_mfma_f32_32x32x16_bf16 v[112:127], v[132:135], v[88:91], v[112:127]
    v_exp_f32 v51, v51
    v_exp_f32 v52, v52
    v_exp_f32 v53, v53
    v_mfma_f32_32x32x16_bf16 v[112:127], v[136:139], v[92:95], v[112:127]
    v_exp_f32 v54, v54
    v_exp_f32 v55, v55
    v_cvt_pk_bf16_f32 v80, v48, v49
    v_exp_f32 v56, v56
    v_exp_f32 v57, v57
    v_cvt_pk_bf16_f32 v81, v50, v51
    v_exp_f32 v58, v58
    v_exp_f32 v59, v59
    v_cvt_pk_bf16_f32 v82, v52, v53
    v_exp_f32 v60, v60
    v_exp_f32 v61, v61
    v_cvt_pk_bf16_f32 v83, v54, v55
    v_exp_f32 v62, v62
    v_exp_f32 v63, v63
    v_cvt_pk_bf16_f32 v84, v56, v57
    v_cvt_pk_bf16_f32 v85, v58, v59
    v_cvt_pk_bf16_f32 v86, v60, v61
    v_cvt_pk_bf16_f32 v87, v62, v63
    s_waitcnt lgkmcnt(0)
    v_mfma_f32_32x32x16_bf16 v[48:63], v[128:131], v[8:11], 0
    v_exp_f32 v64, v64
    v_exp_f32 v65, v65
    v_exp_f32 v66, v66
    v_mfma_f32_32x32x16_bf16 v[96:111], v[140:143], v[80:83], v[96:111]
    v_exp_f32 v67, v67
    v_exp_f32 v68, v68
    v_exp_f32 v69, v69
    v_mfma_f32_32x32x16_bf16 v[96:111], v[144:147], v[84:87], v[96:111]
    v_exp_f32 v70, v70
    v_exp_f32 v71, v71
    v_cvt_pk_bf16_f32 v88, v64, v65
    v_exp_f32 v72, v72
    v_exp_f32 v73, v73
    v_cvt_pk_bf16_f32 v89, v66, v67
    v_exp_f32 v74, v74
    v_exp_f32 v75, v75
    v_cvt_pk_bf16_f32 v90, v68, v69
    v_exp_f32 v76, v76
    v_exp_f32 v77, v77
    v_cvt_pk_bf16_f32 v91, v70, v71
    v_exp_f32 v78, v78
    v_exp_f32 v79, v79
    v_cvt_pk_bf16_f32 v92, v72, v73
    v_cvt_pk_bf16_f32 v93, v74, v75
    v_cvt_pk_bf16_f32 v94, v76, v77
    v_cvt_pk_bf16_f32 v95, v78, v79
    v_mfma_f32_32x32x16_bf16 v[64:79], v[128:131], v[12:15], 0
    ds_read_b128 v[128:131], v148 offset:10880
    ds_read_b128 v[132:135], v149 offset:8704
    ds_read_b128 v[136:139], v149 offset:9280
    s_cmp_lg_u32 s62, 3
    s_cbranch_scc1 L_mega_kernel_kmi_35
    ds_read_b64 v[150:151], v156 offset:144
    ds_read_b32 v159, v156 offset:44
L_mega_kernel_kmi_35:
    v_exp_f32 v48, v48
    v_exp_f32 v49, v49
    v_exp_f32 v50, v50
    v_mfma_f32_32x32x16_bf16 v[112:127], v[140:143], v[88:91], v[112:127]
    v_exp_f32 v51, v51
    v_exp_f32 v52, v52
    v_exp_f32 v53, v53
    v_mfma_f32_32x32x16_bf16 v[112:127], v[144:147], v[92:95], v[112:127]
    v_exp_f32 v54, v54
    v_exp_f32 v55, v55
    v_cvt_pk_bf16_f32 v80, v48, v49
    v_exp_f32 v56, v56
    v_exp_f32 v57, v57
    v_cvt_pk_bf16_f32 v81, v50, v51
    v_exp_f32 v58, v58
    v_exp_f32 v59, v59
    v_cvt_pk_bf16_f32 v82, v52, v53
    v_exp_f32 v60, v60
    v_exp_f32 v61, v61
    v_cvt_pk_bf16_f32 v83, v54, v55
    v_exp_f32 v62, v62
    v_exp_f32 v63, v63
    v_cvt_pk_bf16_f32 v84, v56, v57
    v_cvt_pk_bf16_f32 v85, v58, v59
    v_cvt_pk_bf16_f32 v86, v60, v61
    v_cvt_pk_bf16_f32 v87, v62, v63
    s_waitcnt lgkmcnt(0)
    v_mfma_f32_32x32x16_bf16 v[48:63], v[128:131], v[8:11], 0
    v_exp_f32 v64, v64
    v_exp_f32 v65, v65
    v_exp_f32 v66, v66
    v_mfma_f32_32x32x16_bf16 v[96:111], v[132:135], v[80:83], v[96:111]
    v_exp_f32 v67, v67
    v_exp_f32 v68, v68
    v_exp_f32 v69, v69
    v_mfma_f32_32x32x16_bf16 v[96:111], v[136:139], v[84:87], v[96:111]
    v_exp_f32 v70, v70
    v_exp_f32 v71, v71
    v_cvt_pk_bf16_f32 v88, v64, v65
    v_exp_f32 v72, v72
    v_exp_f32 v73, v73
    v_cvt_pk_bf16_f32 v89, v66, v67
    v_exp_f32 v74, v74
    v_exp_f32 v75, v75
    v_cvt_pk_bf16_f32 v90, v68, v69
    v_exp_f32 v76, v76
    v_exp_f32 v77, v77
    v_cvt_pk_bf16_f32 v91, v70, v71
    v_exp_f32 v78, v78
    v_exp_f32 v79, v79
    v_cvt_pk_bf16_f32 v92, v72, v73
    v_cvt_pk_bf16_f32 v93, v74, v75
    v_cvt_pk_bf16_f32 v94, v76, v77
    v_cvt_pk_bf16_f32 v95, v78, v79
    s_cmp_lg_u32 s62, 3
    s_cbranch_scc1 L_mega_kernel_kmv_36
    v_readfirstlane_b32 s56, v151
    v_readfirstlane_b32 s58, v159
    v_mul_f32 v152, v161, v150
    v_mul_f32 v153, v162, v150
    s_mov_b32 s35, 0x450dbb77
    s_and_b32 s72, s56, s58
    v_cmp_nge_f32 vcc, s35, v152
    s_mov_b64 s[70:71], vcc
    v_cmp_nge_f32 vcc, s35, v153
    s_or_b64 s[70:71], s[70:71], vcc
L_mega_kernel_kmv_36:
    v_mfma_f32_32x32x16_bf16 v[64:79], v[128:131], v[12:15], 0
    ds_read_b128 v[128:131], v148 offset:13056
    ds_read_b128 v[140:143], v149 offset:10880
    ds_read_b128 v[144:147], v149 offset:11456
    v_exp_f32 v48, v48
    v_exp_f32 v49, v49
    v_exp_f32 v50, v50
    v_mfma_f32_32x32x16_bf16 v[112:127], v[132:135], v[88:91], v[112:127]
    v_exp_f32 v51, v51
    v_exp_f32 v52, v52
    v_exp_f32 v53, v53
    v_mfma_f32_32x32x16_bf16 v[112:127], v[136:139], v[92:95], v[112:127]
    v_exp_f32 v54, v54
    v_exp_f32 v55, v55
    v_cvt_pk_bf16_f32 v80, v48, v49
    v_exp_f32 v56, v56
    v_exp_f32 v57, v57
    v_cvt_pk_bf16_f32 v81, v50, v51
    v_exp_f32 v58, v58
    v_exp_f32 v59, v59
    v_cvt_pk_bf16_f32 v82, v52, v53
    v_exp_f32 v60, v60
    v_exp_f32 v61, v61
    v_cvt_pk_bf16_f32 v83, v54, v55
    v_exp_f32 v62, v62
    v_exp_f32 v63, v63
    v_cvt_pk_bf16_f32 v84, v56, v57
    v_cvt_pk_bf16_f32 v85, v58, v59
    v_cvt_pk_bf16_f32 v86, v60, v61
    v_cvt_pk_bf16_f32 v87, v62, v63
    s_waitcnt lgkmcnt(0)
    v_mfma_f32_32x32x16_bf16 v[48:63], v[128:131], v[8:11], 0
    v_exp_f32 v64, v64
    v_exp_f32 v65, v65
    v_exp_f32 v66, v66
    v_mfma_f32_32x32x16_bf16 v[96:111], v[140:143], v[80:83], v[96:111]
    v_exp_f32 v67, v67
    v_exp_f32 v68, v68
    v_exp_f32 v69, v69
    v_mfma_f32_32x32x16_bf16 v[96:111], v[144:147], v[84:87], v[96:111]
    v_exp_f32 v70, v70
    v_exp_f32 v71, v71
    v_cvt_pk_bf16_f32 v88, v64, v65
    v_exp_f32 v72, v72
    v_exp_f32 v73, v73
    v_cvt_pk_bf16_f32 v89, v66, v67
    v_exp_f32 v74, v74
    v_exp_f32 v75, v75
    v_cvt_pk_bf16_f32 v90, v68, v69
    v_exp_f32 v76, v76
    v_exp_f32 v77, v77
    v_cvt_pk_bf16_f32 v91, v70, v71
    v_exp_f32 v78, v78
    v_exp_f32 v79, v79
    v_cvt_pk_bf16_f32 v92, v72, v73
    v_cvt_pk_bf16_f32 v93, v74, v75
    v_cvt_pk_bf16_f32 v94, v76, v77
    v_cvt_pk_bf16_f32 v95, v78, v79
    v_mfma_f32_32x32x16_bf16 v[64:79], v[128:131], v[12:15], 0
    ds_read_b128 v[128:131], v148 offset:15232
    ds_read_b128 v[132:135], v149 offset:13056
    ds_read_b128 v[136:139], v149 offset:13632
    ds_read_b32 v159, v156 offset:160
    v_exp_f32 v48, v48
    v_exp_f32 v49, v49
    v_exp_f32 v50, v50
    v_mfma_f32_32x32x16_bf16 v[112:127], v[140:143], v[88:91], v[112:127]
    v_exp_f32 v51, v51
    v_exp_f32 v52, v52
    v_exp_f32 v53, v53
    v_mfma_f32_32x32x16_bf16 v[112:127], v[144:147], v[92:95], v[112:127]
    v_exp_f32 v54, v54
    v_exp_f32 v55, v55
    v_cvt_pk_bf16_f32 v80, v48, v49
    v_exp_f32 v56, v56
    v_exp_f32 v57, v57
    v_cvt_pk_bf16_f32 v81, v50, v51
    v_exp_f32 v58, v58
    v_exp_f32 v59, v59
    v_cvt_pk_bf16_f32 v82, v52, v53
    v_exp_f32 v60, v60
    v_exp_f32 v61, v61
    v_cvt_pk_bf16_f32 v83, v54, v55
    v_exp_f32 v62, v62
    v_exp_f32 v63, v63
    v_cvt_pk_bf16_f32 v84, v56, v57
    v_cvt_pk_bf16_f32 v85, v58, v59
    v_cvt_pk_bf16_f32 v86, v60, v61
    v_cvt_pk_bf16_f32 v87, v62, v63
    s_waitcnt lgkmcnt(0)
    v_mfma_f32_32x32x16_bf16 v[48:63], v[128:131], v[8:11], 0
    v_exp_f32 v64, v64
    v_exp_f32 v65, v65
    v_exp_f32 v66, v66
    v_mfma_f32_32x32x16_bf16 v[96:111], v[132:135], v[80:83], v[96:111]
    v_exp_f32 v67, v67
    v_exp_f32 v68, v68
    v_exp_f32 v69, v69
    v_mfma_f32_32x32x16_bf16 v[96:111], v[136:139], v[84:87], v[96:111]
    v_exp_f32 v70, v70
    v_exp_f32 v71, v71
    v_cvt_pk_bf16_f32 v88, v64, v65
    v_exp_f32 v72, v72
    v_exp_f32 v73, v73
    v_cvt_pk_bf16_f32 v89, v66, v67
    v_exp_f32 v74, v74
    v_exp_f32 v75, v75
    v_cvt_pk_bf16_f32 v90, v68, v69
    v_exp_f32 v76, v76
    v_exp_f32 v77, v77
    v_cvt_pk_bf16_f32 v91, v70, v71
    v_exp_f32 v78, v78
    v_exp_f32 v79, v79
    v_cvt_pk_bf16_f32 v92, v72, v73
    v_cvt_pk_bf16_f32 v93, v74, v75
    v_cvt_pk_bf16_f32 v94, v76, v77
    v_cvt_pk_bf16_f32 v95, v78, v79
    v_readfirstlane_b32 s66, v159
    s_add_u32 s65, s65, 1
    s_min_u32 s65, s65, 8
    s_cmp_ge_u32 s66, s65
    s_cbranch_scc1 L_mega_kernel_last_37
    s_mov_b32 s67, 400000
L_mega_kernel_lp_38:
    ds_read_b32 v159, v156 offset:160
    s_waitcnt lgkmcnt(0)
    v_readfirstlane_b32 s66, v159
    s_sub_u32 s67, s67, 1
    s_cmp_ge_u32 s66, s65
    s_cbranch_scc1 L_mega_kernel_ok_39
    s_sleep 1
    s_cmp_lg_u32 s67, 0
    s_cbranch_scc1 L_mega_kernel_lp_38
L_mega_kernel_ok_39:
L_mega_kernel_last_37:
    v_mfma_f32_32x32x16_bf16 v[64:79], v[128:131], v[12:15], 0
    ds_read_b128 v[128:131], v148 offset:17408
    ds_read_b128 v[140:143], v149 offset:15232
    ds_read_b128 v[144:147], v149 offset:15808
    v_exp_f32 v48, v48
    v_exp_f32 v49, v49
    v_exp_f32 v50, v50
    v_mfma_f32_32x32x16_bf16 v[112:127], v[132:135], v[88:91], v[112:127]
    v_exp_f32 v51, v51
    v_exp_f32 v52, v52
    v_exp_f32 v53, v53
    v_mfma_f32_32x32x16_bf16 v[112:127], v[136:139], v[92:95], v[112:127]
    v_exp_f32 v54, v54
    v_exp_f32 v55, v55
    v_cvt_pk_bf16_f32 v80, v48, v49
    v_exp_f32 v56, v56
    v_exp_f32 v57, v57
    v_cvt_pk_bf16_f32 v81, v50, v51
    v_exp_f32 v58, v58
    v_exp_f32 v59, v59
    v_cvt_pk_bf16_f32 v82, v52, v53
    v_exp_f32 v60, v60
    v_exp_f32 v61, v61
    v_cvt_pk_bf16_f32 v83, v54, v55
    v_exp_f32 v62, v62
    v_exp_f32 v63, v63
    v_cvt_pk_bf16_f32 v84, v56, v57
    v_cvt_pk_bf16_f32 v85, v58, v59
    v_cvt_pk_bf16_f32 v86, v60, v61
    v_cvt_pk_bf16_f32 v87, v62, v63
    s_waitcnt lgkmcnt(0)
    v_mfma_f32_32x32x16_bf16 v[48:63], v[128:131], v[8:11], 0
    s_mov_b64 exec, 2
    ds_add_u32 v157, v1 offset:0
    s_mov_b64 exec, -1
    v_exp_f32 v64, v64
    v_exp_f32 v65, v65
    v_exp_f32 v66, v66
    v_mfma_f32_32x32x16_bf16 v[96:111], v[140:143], v[80:83], v[96:111]
    v_exp_f32 v67, v67
    v_exp_f32 v68, v68
    v_exp_f32 v69, v69
    v_mfma_f32_32x32x16_bf16 v[96:111], v[144:147], v[84:87], v[96:111]
    v_exp_f32 v70, v70
    v_exp_f32 v71, v71
    v_cvt_pk_bf16_f32 v88, v64, v65
    v_exp_f32 v72, v72
    v_exp_f32 v73, v73
    v_cvt_pk_bf16_f32 v89, v66, v67
    v_exp_f32 v74, v74
    v_exp_f32 v75, v75
    v_cvt_pk_bf16_f32 v90, v68, v69
    v_exp_f32 v76, v76
    v_exp_f32 v77, v77
    v_cvt_pk_bf16_f32 v91, v70, v71
    v_exp_f32 v78, v78
    v_exp_f32 v79, v79
    v_cvt_pk_bf16_f32 v92, v72, v73
    v_cvt_pk_bf16_f32 v93, v74, v75
    v_cvt_pk_bf16_f32 v94, v76, v77
    v_cvt_pk_bf16_f32 v95, v78, v79
    v_mfma_f32_32x32x16_bf16 v[64:79], v[128:131], v[12:15], 0
    ds_read_b128 v[128:131], v148 offset:19584
    ds_read_b128 v[132:135], v149 offset:17408
    ds_read_b128 v[136:139], v149 offset:17984
    v_exp_f32 v48, v48
    v_exp_f32 v49, v49
    v_exp_f32 v50, v50
    v_mfma_f32_32x32x16_bf16 v[112:127], v[140:143], v[88:91], v[112:127]
    v_exp_f32 v51, v51
    v_exp_f32 v52, v52
    v_exp_f32 v53, v53
    v_mfma_f32_32x32x16_bf16 v[112:127], v[144:147], v[92:95], v[112:127]
    v_exp_f32 v54, v54
    v_exp_f32 v55, v55
    v_cvt_pk_bf16_f32 v80, v48, v49
    v_exp_f32 v56, v56
    v_exp_f32 v57, v57
    v_cvt_pk_bf16_f32 v81, v50, v51
    v_exp_f32 v58, v58
    v_exp_f32 v59, v59
    v_cvt_pk_bf16_f32 v82, v52, v53
    v_exp_f32 v60, v60
    v_exp_f32 v61, v61
    v_cvt_pk_bf16_f32 v83, v54, v55
    v_exp_f32 v62, v62
    v_exp_f32 v63, v63
    v_cvt_pk_bf16_f32 v84, v56, v57
    v_cvt_pk_bf16_f32 v85, v58, v59
    v_cvt_pk_bf16_f32 v86, v60, v61
    v_cvt_pk_bf16_f32 v87, v62, v63
    s_waitcnt lgkmcnt(0)
    v_mfma_f32_32x32x16_bf16 v[48:63], v[128:131], v[8:11], 0
    v_exp_f32 v64, v64
    v_exp_f32 v65, v65
    v_exp_f32 v66, v66
    v_mfma_f32_32x32x16_bf16 v[96:111], v[132:135], v[80:83], v[96:111]
    v_exp_f32 v67, v67
    v_exp_f32 v68, v68
    v_exp_f32 v69, v69
    v_mfma_f32_32x32x16_bf16 v[96:111], v[136:139], v[84:87], v[96:111]
    v_exp_f32 v70, v70
    v_exp_f32 v71, v71
    v_cvt_pk_bf16_f32 v88, v64, v65
    v_exp_f32 v72, v72
    v_exp_f32 v73, v73
    v_cvt_pk_bf16_f32 v89, v66, v67
    v_exp_f32 v74, v74
    v_exp_f32 v75, v75
    v_cvt_pk_bf16_f32 v90, v68, v69
    v_exp_f32 v76, v76
    v_exp_f32 v77, v77
    v_cvt_pk_bf16_f32 v91, v70, v71
    v_exp_f32 v78, v78
    v_exp_f32 v79, v79
    v_cvt_pk_bf16_f32 v92, v72, v73
    v_cvt_pk_bf16_f32 v93, v74, v75
    v_cvt_pk_bf16_f32 v94, v76, v77
    v_cvt_pk_bf16_f32 v95, v78, v79
    v_mfma_f32_32x32x16_bf16 v[64:79], v[128:131], v[12:15], 0
    ds_read_b128 v[128:131], v148 offset:21760
    ds_read_b128 v[140:143], v149 offset:19584
    ds_read_b128 v[144:147], v149 offset:20160
    v_exp_f32 v48, v48
    v_exp_f32 v49, v49
    v_exp_f32 v50, v50
    v_mfma_f32_32x32x16_bf16 v[112:127], v[132:135], v[88:91], v[112:127]
    v_exp_f32 v51, v51
    v_exp_f32 v52, v52
    v_exp_f32 v53, v53
    v_mfma_f32_32x32x16_bf16 v[112:127], v[136:139], v[92:95], v[112:127]
    v_exp_f32 v54, v54
    v_exp_f32 v55, v55
    v_cvt_pk_bf16_f32 v80, v48, v49
    v_exp_f32 v56, v56
    v_exp_f32 v57, v57
    v_cvt_pk_bf16_f32 v81, v50, v51
    v_exp_f32 v58, v58
    v_exp_f32 v59, v59
    v_cvt_pk_bf16_f32 v82, v52, v53
    v_exp_f32 v60, v60
    v_exp_f32 v61, v61
    v_cvt_pk_bf16_f32 v83, v54, v55
    v_exp_f32 v62, v62
    v_exp_f32 v63, v63
    v_cvt_pk_bf16_f32 v84, v56, v57
    v_cvt_pk_bf16_f32 v85, v58, v59
    v_cvt_pk_bf16_f32 v86, v60, v61
    v_cvt_pk_bf16_f32 v87, v62, v63
    s_waitcnt lgkmcnt(0)
    v_mfma_f32_32x32x16_bf16 v[48:63], v[128:131], v[8:11], 0
    v_exp_f32 v64, v64
    v_exp_f32 v65, v65
    v_exp_f32 v66, v66
    v_mfma_f32_32x32x16_bf16 v[96:111], v[140:143], v[80:83], v[96:111]
    v_exp_f32 v67, v67
    v_exp_f32 v68, v68
    v_exp_f32 v69, v69
    v_mfma_f32_32x32x16_bf16 v[96:111], v[144:147], v[84:87], v[96:111]
    v_exp_f32 v70, v70
    v_exp_f32 v71, v71
    v_cvt_pk_bf16_f32 v88, v64, v65
    v_exp_f32 v72, v72
    v_exp_f32 v73, v73
    v_cvt_pk_bf16_f32 v89, v66, v67
    v_exp_f32 v74, v74
    v_exp_f32 v75, v75
    v_cvt_pk_bf16_f32 v90, v68, v69
    v_exp_f32 v76, v76
    v_exp_f32 v77, v77
    v_cvt_pk_bf16_f32 v91, v70, v71
    v_exp_f32 v78, v78
    v_exp_f32 v79, v79
    v_cvt_pk_bf16_f32 v92, v72, v73
    v_cvt_pk_bf16_f32 v93, v74, v75
    v_cvt_pk_bf16_f32 v94, v76, v77
    v_cvt_pk_bf16_f32 v95, v78, v79
    v_mfma_f32_32x32x16_bf16 v[64:79], v[128:131], v[12:15], 0
    ds_read_b128 v[128:131], v148 offset:23936
    ds_read_b128 v[132:135], v149 offset:21760
    ds_read_b128 v[136:139], v149 offset:22336
    v_exp_f32 v48, v48
    v_exp_f32 v49, v49
    v_exp_f32 v50, v50
    v_mfma_f32_32x32x16_bf16 v[112:127], v[140:143], v[88:91], v[112:127]
    v_exp_f32 v51, v51
    v_exp_f32 v52, v52
    v_exp_f32 v53, v53
    v_mfma_f32_32x32x16_bf16 v[112:127], v[144:147], v[92:95], v[112:127]
    v_exp_f32 v54, v54
    v_exp_f32 v55, v55
    v_cvt_pk_bf16_f32 v80, v48, v49
    v_exp_f32 v56, v56
    v_exp_f32 v57, v57
    v_cvt_pk_bf16_f32 v81, v50, v51
    v_exp_f32 v58, v58
    v_exp_f32 v59, v59
    v_cvt_pk_bf16_f32 v82, v52, v53
    v_exp_f32 v60, v60
    v_exp_f32 v61, v61
    v_cvt_pk_bf16_f32 v83, v54, v55
    v_exp_f32 v62, v62
    v_exp_f32 v63, v63
    v_cvt_pk_bf16_f32 v84, v56, v57
    v_cvt_pk_bf16_f32 v85, v58, v59
    v_cvt_pk_bf16_f32 v86, v60, v61
    v_cvt_pk_bf16_f32 v87, v62, v63
    s_waitcnt lgkmcnt(0)
    v_mfma_f32_32x32x16_bf16 v[48:63], v[128:131], v[8:11], 0
    v_exp_f32 v64, v64
    v_exp_f32 v65, v65
    v_exp_f32 v66, v66
    v_mfma_f32_32x32x16_bf16 v[96:111], v[132:135], v[80:83], v[96:111]
    v_exp_f32 v67, v67
    v_exp_f32 v68, v68
    v_exp_f32 v69, v69
    v_mfma_f32_32x32x16_bf16 v[96:111], v[136:139], v[84:87], v[96:111]
    v_exp_f32 v70, v70
    v_exp_f32 v71, v71
    v_cvt_pk_bf16_f32 v88, v64, v65
    v_exp_f32 v72, v72
    v_exp_f32 v73, v73
    v_cvt_pk_bf16_f32 v89, v66, v67
    v_exp_f32 v74, v74
    v_exp_f32 v75, v75
    v_cvt_pk_bf16_f32 v90, v68, v69
    v_exp_f32 v76, v76
    v_exp_f32 v77, v77
    v_cvt_pk_bf16_f32 v91, v70, v71
    v_exp_f32 v78, v78
    v_exp_f32 v79, v79
    v_cvt_pk_bf16_f32 v92, v72, v73
    v_cvt_pk_bf16_f32 v93, v74, v75
    v_cvt_pk_bf16_f32 v94, v76, v77
    v_cvt_pk_bf16_f32 v95, v78, v79
    v_mfma_f32_32x32x16_bf16 v[64:79], v[128:131], v[12:15], 0
    ds_read_b128 v[128:131], v148 offset:26112
    ds_read_b128 v[140:143], v149 offset:23936
    ds_read_b128 v[144:147], v149 offset:24512
    v_exp_f32 v48, v48
    v_exp_f32 v49, v49
    v_exp_f32 v50, v50
    v_mfma_f32_32x32x16_bf16 v[112:127], v[132:135], v[88:91], v[112:127]
    v_exp_f32 v51, v51
    v_exp_f32 v52, v52
    v_exp_f32 v53, v53
    v_mfma_f32_32x32x16_bf16 v[112:127], v[136:139], v[92:95], v[112:127]
    v_exp_f32 v54, v54
    v_exp_f32 v55, v55
    v_cvt_pk_bf16_f32 v80, v48, v49
    v_exp_f32 v56, v56
    v_exp_f32 v57, v57
    v_cvt_pk_bf16_f32 v81, v50, v51
    v_exp_f32 v58, v58
    v_exp_f32 v59, v59
    v_cvt_pk_bf16_f32 v82, v52, v53
    v_exp_f32 v60, v60
    v_exp_f32 v61, v61
    v_cvt_pk_bf16_f32 v83, v54, v55
    v_exp_f32 v62, v62
    v_exp_f32 v63, v63
    v_cvt_pk_bf16_f32 v84, v56, v57
    v_cvt_pk_bf16_f32 v85, v58, v59
    v_cvt_pk_bf16_f32 v86, v60, v61
    v_cvt_pk_bf16_f32 v87, v62, v63
    s_waitcnt lgkmcnt(0)
    v_mfma_f32_32x32x16_bf16 v[48:63], v[128:131], v[8:11], 0
    v_exp_f32 v64, v64
    v_exp_f32 v65, v65
    v_exp_f32 v66, v66
    v_mfma_f32_32x32x16_bf16 v[96:111], v[140:143], v[80:83], v[96:111]
    v_exp_f32 v67, v67
    v_exp_f32 v68, v68
    v_exp_f32 v69, v69
    v_mfma_f32_32x32x16_bf16 v[96:111], v[144:147], v[84:87], v[96:111]
    v_exp_f32 v70, v70
    v_exp_f32 v71, v71
    v_cvt_pk_bf16_f32 v88, v64, v65
    v_exp_f32 v72, v72
    v_exp_f32 v73, v73
    v_cvt_pk_bf16_f32 v89, v66, v67
    v_exp_f32 v74, v74
    v_exp_f32 v75, v75
    v_cvt_pk_bf16_f32 v90, v68, v69
    v_exp_f32 v76, v76
    v_exp_f32 v77, v77
    v_cvt_pk_bf16_f32 v91, v70, v71
    v_exp_f32 v78, v78
    v_exp_f32 v79, v79
    v_cvt_pk_bf16_f32 v92, v72, v73
    v_cvt_pk_bf16_f32 v93, v74, v75
    v_cvt_pk_bf16_f32 v94, v76, v77
    v_cvt_pk_bf16_f32 v95, v78, v79
    v_mfma_f32_32x32x16_bf16 v[64:79], v[128:131], v[12:15], 0
    ds_read_b128 v[128:131], v148 offset:28288
    ds_read_b128 v[132:135], v149 offset:26112
    ds_read_b128 v[136:139], v149 offset:26688
    v_exp_f32 v48, v48
    v_exp_f32 v49, v49
    v_exp_f32 v50, v50
    v_mfma_f32_32x32x16_bf16 v[112:127], v[140:143], v[88:91], v[112:127]
    v_exp_f32 v51, v51
    v_exp_f32 v52, v52
    v_exp_f32 v53, v53
    v_mfma_f32_32x32x16_bf16 v[112:127], v[144:147], v[92:95], v[112:127]
    v_exp_f32 v54, v54
    v_exp_f32 v55, v55
    v_cvt_pk_bf16_f32 v80, v48, v49
    v_exp_f32 v56, v56
    v_exp_f32 v57, v57
    v_cvt_pk_bf16_f32 v81, v50, v51
    v_exp_f32 v58, v58
    v_exp_f32 v59, v59
    v_cvt_pk_bf16_f32 v82, v52, v53
    v_exp_f32 v60, v60
    v_exp_f32 v61, v61
    v_cvt_pk_bf16_f32 v83, v54, v55
    v_exp_f32 v62, v62
    v_exp_f32 v63, v63
    v_cvt_pk_bf16_f32 v84, v56, v57
    v_cvt_pk_bf16_f32 v85, v58, v59
    v_cvt_pk_bf16_f32 v86, v60, v61
    v_cvt_pk_bf16_f32 v87, v62, v63
    s_waitcnt lgkmcnt(0)
    v_mfma_f32_32x32x16_bf16 v[48:63], v[128:131], v[8:11], 0
    v_exp_f32 v64, v64
    v_exp_f32 v65, v65
    v_exp_f32 v66, v66
    v_mfma_f32_32x32x16_bf16 v[96:111], v[132:135], v[80:83], v[96:111]
    v_exp_f32 v67, v67
    v_exp_f32 v68, v68
    v_exp_f32 v69, v69
    v_mfma_f32_32x32x16_bf16 v[96:111], v[136:139], v[84:87], v[96:111]
    v_exp_f32 v70, v70
    v_exp_f32 v71, v71
    v_cvt_pk_bf16_f32 v88, v64, v65
    v_exp_f32 v72, v72
    v_exp_f32 v73, v73
    v_cvt_pk_bf16_f32 v89, v66, v67
    v_exp_f32 v74, v74
    v_exp_f32 v75, v75
    v_cvt_pk_bf16_f32 v90, v68, v69
    v_exp_f32 v76, v76
    v_exp_f32 v77, v77
    v_cvt_pk_bf16_f32 v91, v70, v71
    v_exp_f32 v78, v78
    v_exp_f32 v79, v79
    v_cvt_pk_bf16_f32 v92, v72, v73
    v_cvt_pk_bf16_f32 v93, v74, v75
    v_cvt_pk_bf16_f32 v94, v76, v77
    v_cvt_pk_bf16_f32 v95, v78, v79
    v_mfma_f32_32x32x16_bf16 v[64:79], v[128:131], v[12:15], 0
    ds_read_b128 v[128:131], v148 offset:30464
    ds_read_b128 v[140:143], v149 offset:28288
    ds_read_b128 v[144:147], v149 offset:28864
    v_exp_f32 v48, v48
    v_exp_f32 v49, v49
    v_exp_f32 v50, v50
    v_mfma_f32_32x32x16_bf16 v[112:127], v[132:135], v[88:91], v[112:127]
    v_exp_f32 v51, v51
    v_exp_f32 v52, v52
    v_exp_f32 v53, v53
    v_mfma_f32_32x32x16_bf16 v[112:127], v[136:139], v[92:95], v[112:127]
    v_exp_f32 v54, v54
    v_exp_f32 v55, v55
    v_cvt_pk_bf16_f32 v80, v48, v49
    v_exp_f32 v56, v56
    v_exp_f32 v57, v57
    v_cvt_pk_bf16_f32 v81, v50, v51
    v_exp_f32 v58, v58
    v_exp_f32 v59, v59
    v_cvt_pk_bf16_f32 v82, v52, v53
    v_exp_f32 v60, v60
    v_exp_f32 v61, v61
    v_cvt_pk_bf16_f32 v83, v54, v55
    v_exp_f32 v62, v62
    v_exp_f32 v63, v63
    v_cvt_pk_bf16_f32 v84, v56, v57
    v_cvt_pk_bf16_f32 v85, v58, v59
    v_cvt_pk_bf16_f32 v86, v60, v61
    v_cvt_pk_bf16_f32 v87, v62, v63
    s_waitcnt lgkmcnt(0)
    v_mfma_f32_32x32x16_bf16 v[48:63], v[128:131], v[8:11], 0
    v_exp_f32 v64, v64
    v_exp_f32 v65, v65
    v_exp_f32 v66, v66
    v_mfma_f32_32x32x16_bf16 v[96:111], v[140:143], v[80:83], v[96:111]
    v_exp_f32 v67, v67
    v_exp_f32 v68, v68
    v_exp_f32 v69, v69
    v_mfma_f32_32x32x16_bf16 v[96:111], v[144:147], v[84:87], v[96:111]
    v_exp_f32 v70, v70
    v_exp_f32 v71, v71
    v_cvt_pk_bf16_f32 v88, v64, v65
    v_exp_f32 v72, v72
    v_exp_f32 v73, v73
    v_cvt_pk_bf16_f32 v89, v66, v67
    v_exp_f32 v74, v74
    v_exp_f32 v75, v75
    v_cvt_pk_bf16_f32 v90, v68, v69
    v_exp_f32 v76, v76
    v_exp_f32 v77, v77
    v_cvt_pk_bf16_f32 v91, v70, v71
    v_exp_f32 v78, v78
    v_exp_f32 v79, v79
    v_cvt_pk_bf16_f32 v92, v72, v73
    v_cvt_pk_bf16_f32 v93, v74, v75
    v_cvt_pk_bf16_f32 v94, v76, v77
    v_cvt_pk_bf16_f32 v95, v78, v79
    v_mfma_f32_32x32x16_bf16 v[64:79], v[128:131], v[12:15], 0
    ds_read_b128 v[128:131], v148 offset:32640
    ds_read_b128 v[132:135], v149 offset:30464
    ds_read_b128 v[136:139], v149 offset:31040
    ds_read_b32 v159, v156 offset:160
    v_exp_f32 v48, v48
    v_exp_f32 v49, v49
    v_exp_f32 v50, v50
    v_mfma_f32_32x32x16_bf16 v[112:127], v[140:143], v[88:91], v[112:127]
    v_exp_f32 v51, v51
    v_exp_f32 v52, v52
    v_exp_f32 v53, v53
    v_mfma_f32_32x32x16_bf16 v[112:127], v[144:147], v[92:95], v[112:127]
    v_exp_f32 v54, v54
    v_exp_f32 v55, v55
    v_cvt_pk_bf16_f32 v80, v48, v49
    v_exp_f32 v56, v56
    v_exp_f32 v57, v57
    v_cvt_pk_bf16_f32 v81, v50, v51
    v_exp_f32 v58, v58
    v_exp_f32 v59, v59
    v_cvt_pk_bf16_f32 v82, v52, v53
    v_exp_f32 v60, v60
    v_exp_f32 v61, v61
    v_cvt_pk_bf16_f32 v83, v54, v55
    v_exp_f32 v62, v62
    v_exp_f32 v63, v63
    v_cvt_pk_bf16_f32 v84, v56, v57
    v_cvt_pk_bf16_f32 v85, v58, v59
    v_cvt_pk_bf16_f32 v86, v60, v61
    v_cvt_pk_bf16_f32 v87, v62, v63
    s_waitcnt lgkmcnt(0)
    v_mfma_f32_32x32x16_bf16 v[48:63], v[128:131], v[8:11], 0
    v_exp_f32 v64, v64
    v_exp_f32 v65, v65
    v_exp_f32 v66, v66
    v_mfma_f32_32x32x16_bf16 v[96:111], v[132:135], v[80:83], v[96:111]
    v_exp_f32 v67, v67
    v_exp_f32 v68, v68
    v_exp_f32 v69, v69
    v_mfma_f32_32x32x16_bf16 v[96:111], v[136:139], v[84:87], v[96:111]
    v_exp_f32 v70, v70
    v_exp_f32 v71, v71
    v_cvt_pk_bf16_f32 v88, v64, v65
    v_exp_f32 v72, v72
    v_exp_f32 v73, v73
    v_cvt_pk_bf16_f32 v89, v66, v67
    v_exp_f32 v74, v74
    v_exp_f32 v75, v75
    v_cvt_pk_bf16_f32 v90, v68, v69
    v_exp_f32 v76, v76
    v_exp_f32 v77, v77
    v_cvt_pk_bf16_f32 v91, v70, v71
    v_exp_f32 v78, v78
    v_exp_f32 v79, v79
    v_cvt_pk_bf16_f32 v92, v72, v73
    v_cvt_pk_bf16_f32 v93, v74, v75
    v_cvt_pk_bf16_f32 v94, v76, v77
    v_cvt_pk_bf16_f32 v95, v78, v79
    v_readfirstlane_b32 s66, v159
    s_add_u32 s65, s65, 1
    s_min_u32 s65, s65, 8
    s_cmp_ge_u32 s66, s65
    s_cbranch_scc1 L_mega_kernel_last_40
    s_mov_b32 s67, 400000
L_mega_kernel_lp_41:
    ds_read_b32 v159, v156 offset:160
    s_waitcnt lgkmcnt(0)
    v_readfirstlane_b32 s66, v159
    s_sub_u32 s67, s67, 1
    s_cmp_ge_u32 s66, s65
    s_cbranch_scc1 L_mega_kernel_ok_42
    s_sleep 1
    s_cmp_lg_u32 s67, 0
    s_cbranch_scc1 L_mega_kernel_lp_41
L_mega_kernel_ok_42:
L_mega_kernel_last_40:
    v_mfma_f32_32x32x16_bf16 v[64:79], v[128:131], v[12:15], 0
    ds_read_b128 v[128:131], v148 offset:0
    ds_read_b128 v[140:143], v149 offset:32640
    ds_read_b128 v[144:147], v149 offset:33216
    v_exp_f32 v48, v48
    v_exp_f32 v49, v49
    v_exp_f32 v50, v50
    v_mfma_f32_32x32x16_bf16 v[112:127], v[132:135], v[88:91], v[112:127]
    v_exp_f32 v51, v51
    v_exp_f32 v52, v52
    v_exp_f32 v53, v53
    v_mfma_f32_32x32x16_bf16 v[112:127], v[136:139], v[92:95], v[112:127]
    v_exp_f32 v54, v54
    v_exp_f32 v55, v55
    v_cvt_pk_bf16_f32 v80, v48, v49
    v_exp_f32 v56, v56
    v_exp_f32 v57, v57
    v_cvt_pk_bf16_f32 v81, v50, v51
    v_exp_f32 v58, v58
    v_exp_f32 v59, v59
    v_cvt_pk_bf16_f32 v82, v52, v53
    v_exp_f32 v60, v60
    v_exp_f32 v61, v61
    v_cvt_pk_bf16_f32 v83, v54, v55
    v_exp_f32 v62, v62
    v_exp_f32 v63, v63
    v_cvt_pk_bf16_f32 v84, v56, v57
    v_cvt_pk_bf16_f32 v85, v58, v59
    v_cvt_pk_bf16_f32 v86, v60, v61
    v_cvt_pk_bf16_f32 v87, v62, v63
    s_waitcnt lgkmcnt(0)
    v_mfma_f32_32x32x16_bf16 v[48:63], v[128:131], v[8:11], 0
    s_mov_b64 exec, 2
    ds_add_u32 v157, v1 offset:0
    s_mov_b64 exec, -1
    v_exp_f32 v64, v64
    v_exp_f32 v65, v65
    v_exp_f32 v66, v66
    v_mfma_f32_32x32x16_bf16 v[96:111], v[140:143], v[80:83], v[96:111]
    v_exp_f32 v67, v67
    v_exp_f32 v68, v68
    v_exp_f32 v69, v69
    v_mfma_f32_32x32x16_bf16 v[96:111], v[144:147], v[84:87], v[96:111]
    v_exp_f32 v70, v70
    v_exp_f32 v71, v71
    v_cvt_pk_bf16_f32 v88, v64, v65
    v_exp_f32 v72, v72
    v_exp_f32 v73, v73
    v_cvt_pk_bf16_f32 v89, v66, v67
    v_exp_f32 v74, v74
    v_exp_f32 v75, v75
    v_cvt_pk_bf16_f32 v90, v68, v69
    v_exp_f32 v76, v76
    v_exp_f32 v77, v77
    v_cvt_pk_bf16_f32 v91, v70, v71
    v_exp_f32 v78, v78
    v_exp_f32 v79, v79
    v_cvt_pk_bf16_f32 v92, v72, v73
    v_cvt_pk_bf16_f32 v93, v74, v75
    v_cvt_pk_bf16_f32 v94, v76, v77
    v_cvt_pk_bf16_f32 v95, v78, v79
    s_add_u32 s62, s62, 1
    s_cmp_lt_u32 s62, 4
    s_cbranch_scc1 L_mega_kernel_attnloop_31
    s_setprio 3
    v_mfma_f32_32x32x16_bf16 v[112:127], v[140:143], v[88:91], v[112:127]
    v_mfma_f32_32x32x16_bf16 v[112:127], v[144:147], v[92:95], v[112:127]
    s_cmp_eq_u32 s72, 0
    s_cbranch_scc1 L_mega_kernel_kmearly_47
    s_cmp_lg_u64 s[70:71], 0
    s_cbranch_scc1 L_mega_kernel_fallback_45
    s_branch L_mega_kernel_norm_46
L_mega_kernel_kmearly_47:
    s_mov_b32 s57, 400000
L_mega_kernel_kmx_43:
    ds_read_b64 v[150:151], v156 offset:144
    ds_read_b32 v159, v156 offset:44
    s_waitcnt lgkmcnt(0)
    v_readfirstlane_b32 s56, v151
    v_readfirstlane_b32 s58, v159
    s_sub_u32 s57, s57, 1
    s_and_b32 s56, s56, s58
    s_cmp_lg_u32 s56, 0
    s_cbranch_scc1 L_mega_kernel_kmxok_44
    s_cmp_lg_u32 s57, 0
    s_cbranch_scc1 L_mega_kernel_kmx_43
L_mega_kernel_kmxok_44:
    s_mov_b32 s35, 0x450dbb77
    v_mul_f32 v152, v161, v150
    v_mul_f32 v153, v162, v150
    v_cmp_nge_f32 vcc, s35, v152
    s_mov_b64 s[60:61], vcc
    v_cmp_nge_f32 vcc, s35, v153
    s_or_b64 s[60:61], s[60:61], vcc
    s_cmp_lg_u64 s[60:61], 0
    s_cbranch_scc1 L_mega_kernel_fallback_45
L_mega_kernel_norm_46:
    s_nop 7
    v_rcp_f32 v150, v104
    s_nop 0
    v_mul_f32 v96, v96, v150
    v_mul_f32 v97, v97, v150
    v_mul_f32 v98, v98, v150
    v_mul_f32 v99, v99, v150
    v_mul_f32 v100, v100, v150
    v_mul_f32 v101, v101, v150
    v_mul_f32 v102, v102, v150
    v_mul_f32 v103, v103, v150
    v_cvt_pk_bf16_f32 v96, v96, v97
    v_cvt_pk_bf16_f32 v97, v98, v99
    v_cvt_pk_bf16_f32 v98, v100, v101
    v_cvt_pk_bf16_f32 v99, v102, v103
    s_add_u32 s56, s32, 10485760
    buffer_store_dwordx4 v[96:99], v2, s[4:7], s56 offen sc1
    v_rcp_f32 v151, v120
    s_nop 0
    v_mul_f32 v112, v112, v151
    v_mul_f32 v113, v113, v151
    v_mul_f32 v114, v114, v151
    v_mul_f32 v115, v115, v151
    v_mul_f32 v116, v116, v151
    v_mul_f32 v117, v117, v151
    v_mul_f32 v118, v118, v151
    v_mul_f32 v119, v119, v151
    v_cvt_pk_bf16_f32 v112, v112, v113
    v_cvt_pk_bf16_f32 v113, v114, v115
    v_cvt_pk_bf16_f32 v114, v116, v117
    v_cvt_pk_bf16_f32 v115, v118, v119
    s_add_u32 s56, s32, 10486784
    buffer_store_dwordx4 v[112:115], v2, s[4:7], s56 offen sc1
    s_waitcnt vmcnt(0)
    s_mov_b64 exec, 2
    ds_add_u32 v156, v1 offset:24
    s_mov_b64 exec, -1
    s_waitcnt lgkmcnt(0)
    s_endpgm
L_mega_kernel_fallback_45:
    v_mov_b32 v150, 0xff800000
    v_mov_b32 v151, 0xff800000
    s_mov_b32 s56, 2097152
    s_mov_b32 s57, 64
L_mega_kernel_maxloop_48:
    buffer_load_dwordx4 v[128:131], v160, s[4:7], s56 offen sc1
    s_add_u32 s56, s56, 2176
    s_waitcnt vmcnt(0)
    v_mfma_f32_32x32x16_bf16 v[48:63], v[128:131], v[8:11], 0
    v_mfma_f32_32x32x16_bf16 v[64:79], v[128:131], v[12:15], 0
    s_nop 15
    s_nop 7
    v_max3_f32 v150, v48, v49, v150
    v_max3_f32 v150, v50, v51, v150
    v_max3_f32 v150, v52, v53, v150
    v_max3_f32 v150, v54, v55, v150
    v_max3_f32 v150, v56, v57, v150
    v_max3_f32 v150, v58, v59, v150
    v_max3_f32 v150, v60, v61, v150
    v_max3_f32 v150, v62, v63, v150
    v_max3_f32 v151, v64, v65, v151
    v_max3_f32 v151, v66, v67, v151
    v_max3_f32 v151, v68, v69, v151
    v_max3_f32 v151, v70, v71, v151
    v_max3_f32 v151, v72, v73, v151
    v_max3_f32 v151, v74, v75, v151
    v_max3_f32 v151, v76, v77, v151
    v_max3_f32 v151, v78, v79, v151
    s_sub_u32 s57, s57, 1
    s_cmp_lg_u32 s57, 0
    s_cbranch_scc1 L_mega_kernel_maxloop_48
    v_mov_b32 v152, v150
    s_nop 1
    v_permlane32_swap_b32 v150, v152
    s_nop 1
    v_max_f32 v150, v150, v152
    v_sub_f32 v16, 0, v150
    v_sub_f32 v17, 0, v150
    v_sub_f32 v18, 0, v150
    v_sub_f32 v19, 0, v150
    v_sub_f32 v20, 0, v150
    v_sub_f32 v21, 0, v150
    v_sub_f32 v22, 0, v150
    v_sub_f32 v23, 0, v150
    v_sub_f32 v24, 0, v150
    v_sub_f32 v25, 0, v150
    v_sub_f32 v26, 0, v150
    v_sub_f32 v27, 0, v150
    v_sub_f32 v28, 0, v150
    v_sub_f32 v29, 0, v150
    v_sub_f32 v30, 0, v150
    v_sub_f32 v31, 0, v150
    v_mov_b32 v96, 0
    v_mov_b32 v97, 0
    v_mov_b32 v98, 0
    v_mov_b32 v99, 0
    v_mov_b32 v100, 0
    v_mov_b32 v101, 0
    v_mov_b32 v102, 0
    v_mov_b32 v103, 0
    v_mov_b32 v104, 0
    v_mov_b32 v105, 0
    v_mov_b32 v106, 0
    v_mov_b32 v107, 0
    v_mov_b32 v108, 0
    v_mov_b32 v109, 0
    v_mov_b32 v110, 0
    v_mov_b32 v111, 0
    v_mov_b32 v152, v151
    s_nop 1
    v_permlane32_swap_b32 v151, v152
    s_nop 1
    v_max_f32 v151, v151, v152
    v_sub_f32 v32, 0, v151
    v_sub_f32 v33, 0, v151
    v_sub_f32 v34, 0, v151
    v_sub_f32 v35, 0, v151
    v_sub_f32 v36, 0, v151
    v_sub_f32 v37, 0, v151
    v_sub_f32 v38, 0, v151
    v_sub_f32 v39, 0, v151
    v_sub_f32 v40, 0, v151
    v_sub_f32 v41, 0, v151
    v_sub_f32 v42, 0, v151
    v_sub_f32 v43, 0, v151
    v_sub_f32 v44, 0, v151
    v_sub_f32 v45, 0, v151
    v_sub_f32 v46, 0, v151
    v_sub_f32 v47, 0, v151
    v_mov_b32 v112, 0
    v_mov_b32 v113, 0
    v_mov_b32 v114, 0
    v_mov_b32 v115, 0
    v_mov_b32 v116, 0
    v_mov_b32 v117, 0
    v_mov_b32 v118, 0
    v_mov_b32 v119, 0
    v_mov_b32 v120, 0
    v_mov_b32 v121, 0
    v_mov_b32 v122, 0
    v_mov_b32 v123, 0
    v_mov_b32 v124, 0
    v_mov_b32 v125, 0
    v_mov_b32 v126, 0
    v_mov_b32 v127, 0
    v_subrev_u32 v152, 114688, v149
    s_mov_b32 s56, 2097152
    s_mov_b32 s57, 64
L_mega_kernel_fbloop_49:
    buffer_load_dwordx4 v[128:131], v160, s[4:7], s56 offen sc1
    buffer_load_dwordx4 v[132:135], v152, s[4:7], s56 offen sc1
    buffer_load_dwordx4 v[136:139], v152, s[4:7], s56 offen offset:576 sc1
    s_add_u32 s56, s56, 2176
    s_waitcnt vmcnt(0)
    v_mfma_f32_32x32x16_bf16 v[48:63], v[128:131], v[8:11], v[16:31]
    v_mfma_f32_32x32x16_bf16 v[64:79], v[128:131], v[12:15], v[32:47]
    s_nop 15
    s_nop 7
    v_exp_f32 v48, v48
    v_exp_f32 v49, v49
    v_exp_f32 v50, v50
    v_exp_f32 v51, v51
    v_exp_f32 v52, v52
    v_exp_f32 v53, v53
    v_exp_f32 v54, v54
    v_exp_f32 v55, v55
    v_exp_f32 v56, v56
    v_exp_f32 v57, v57
    v_exp_f32 v58, v58
    v_exp_f32 v59, v59
    v_exp_f32 v60, v60
    v_exp_f32 v61, v61
    v_exp_f32 v62, v62
    v_exp_f32 v63, v63
    v_exp_f32 v64, v64
    v_exp_f32 v65, v65
    v_exp_f32 v66, v66
    v_exp_f32 v67, v67
    v_exp_f32 v68, v68
    v_exp_f32 v69, v69
    v_exp_f32 v70, v70
    v_exp_f32 v71, v71
    v_exp_f32 v72, v72
    v_exp_f32 v73, v73
    v_exp_f32 v74, v74
    v_exp_f32 v75, v75
    v_exp_f32 v76, v76
    v_exp_f32 v77, v77
    v_exp_f32 v78, v78
    v_exp_f32 v79, v79
    s_nop 1
    v_cvt_pk_bf16_f32 v80, v48, v49
    v_cvt_pk_bf16_f32 v81, v50, v51
    v_cvt_pk_bf16_f32 v82, v52, v53
    v_cvt_pk_bf16_f32 v83, v54, v55
    v_cvt_pk_bf16_f32 v84, v56, v57
    v_cvt_pk_bf16_f32 v85, v58, v59
    v_cvt_pk_bf16_f32 v86, v60, v61
    v_cvt_pk_bf16_f32 v87, v62, v63
    v_cvt_pk_bf16_f32 v88, v64, v65
    v_cvt_pk_bf16_f32 v89, v66, v67
    v_cvt_pk_bf16_f32 v90, v68, v69
    v_cvt_pk_bf16_f32 v91, v70, v71
    v_cvt_pk_bf16_f32 v92, v72, v73
    v_cvt_pk_bf16_f32 v93, v74, v75
    v_cvt_pk_bf16_f32 v94, v76, v77
    v_cvt_pk_bf16_f32 v95, v78, v79
    s_nop 1
    v_mfma_f32_32x32x16_bf16 v[96:111], v[132:135], v[80:83], v[96:111]
    v_mfma_f32_32x32x16_bf16 v[96:111], v[136:139], v[84:87], v[96:111]
    v_mfma_f32_32x32x16_bf16 v[112:127], v[132:135], v[88:91], v[112:127]
    v_mfma_f32_32x32x16_bf16 v[112:127], v[136:139], v[92:95], v[112:127]
    s_nop 15
    s_nop 7
    s_sub_u32 s57, s57, 1
    s_cmp_lg_u32 s57, 0
    s_cbranch_scc1 L_mega_kernel_fbloop_49
    s_branch L_mega_kernel_norm_46
L_mega_kernel_roleG_6:
    s_sub_u32 s27, s20, 4
    s_cmp_ge_u32 s27, 2
    s_cbranch_scc1 L_mega_kernel_misc_50
    s_setprio 3
    s_getpc_b64 s[60:61]
L_mega_kernel_onespc_52:
    s_add_u32 s60, s60, L_mega_kernel_ones_3-L_mega_kernel_onespc_52
    s_addc_u32 s61, s61, 0
    v_and_b32 v156, 15, v1
    v_lshrrev_b32 v157, 4, v1
    v_lshlrev_b32 v158, 4, v157
    v_lshl_add_u32 v159, v156, 10, v158
    v_add_u32 v158, s60, v158
    v_cmp_gt_u32 vcc, 8, v156
    s_mov_b64 s[66:67], vcc
    v_lshrrev_b32 v138, 1, v1
    v_lshrrev_b32 v139, 2, v138
    v_and_b32 v139, 3, v139
    v_lshlrev_b32 v139, 3, v139
    v_lshrrev_b32 v136, 4, v138
    v_lshl_add_u32 v139, v136, 2, v139
    v_and_b32 v138, 3, v138
    v_add_u32 v139, v139, v138
    v_and_b32 v138, 1, v1
    v_lshlrev_b32 v138, 4, v138
    v_lshl_add_u32 v138, v139, 5, v138
    s_mul_i32 s63, s27, 17408
    s_add_u32 s63, s63, 114688
    s_lshl_b32 s58, s26, 13
    s_waitcnt lgkmcnt(0)
    s_mov_b32 s6, 268435456
    s_mov_b32 s7, 0x20000
    s_mov_b32 s8, s36
    s_mov_b32 s9, s37
    s_mov_b32 s10, 2097152
    s_mov_b32 s11, 0x20000
    s_add_u32 s56, s4, 2752512
    s_addc_u32 s57, s5, 0
    s_load_dword s23, s[56:57], 0
    s_add_u32 s58, s36, s58
    s_addc_u32 s59, s37, 0
    v_add_co_u32 v136, vcc, s58, v159
    v_mov_b32 v137, s59
    v_addc_co_u32 v137, vcc, 0, v137, vcc
    v_mov_b32 v159, s61
    v_cndmask_b32 v136, v158, v136, s[66:67]
    v_cndmask_b32 v137, v159, v137, s[66:67]
    s_cmp_eq_u32 s27, 0
    s_cselect_b32 s12, s40, s42
    s_cselect_b32 s13, s41, s43
    s_mov_b32 s14, 16384
    s_mov_b32 s15, 0x20000
    global_load_dwordx4 v[8:11], v[136:137], off offset:0
    global_load_dwordx4 v[12:15], v[136:137], off offset:64
    global_load_dwordx4 v[16:19], v[136:137], off offset:128
    global_load_dwordx4 v[20:23], v[136:137], off offset:192
    global_load_dwordx4 v[24:27], v[136:137], off offset:256
    global_load_dwordx4 v[28:31], v[136:137], off offset:320
    global_load_dwordx4 v[32:35], v[136:137], off offset:384
    global_load_dwordx4 v[36:39], v[136:137], off offset:448
    global_load_dwordx4 v[40:43], v[136:137], off offset:512
    global_load_dwordx4 v[44:47], v[136:137], off offset:576
    global_load_dwordx4 v[48:51], v[136:137], off offset:640
    global_load_dwordx4 v[52:55], v[136:137], off offset:704
    global_load_dwordx4 v[56:59], v[136:137], off offset:768
    global_load_dwordx4 v[60:63], v[136:137], off offset:832
    global_load_dwordx4 v[64:67], v[136:137], off offset:896
    global_load_dwordx4 v[68:71], v[136:137], off offset:960
    s_add_u32 m0, s63, 0
    s_mov_b32 s56, 0
    buffer_load_dwordx4 v138, s[12:15], s56 offen offset:0 lds
    buffer_load_dwordx4 v138, s[12:15], s56 offen offset:1024 lds
    buffer_load_dwordx4 v138, s[12:15], s56 offen offset:2048 lds
    buffer_load_dwordx4 v138, s[12:15], s56 offen offset:3072 lds
    s_add_u32 m0, s63, 4096
    s_mov_b32 s56, 4096
    buffer_load_dwordx4 v138, s[12:15], s56 offen offset:0 lds
    buffer_load_dwordx4 v138, s[12:15], s56 offen offset:1024 lds
    buffer_load_dwordx4 v138, s[12:15], s56 offen offset:2048 lds
    buffer_load_dwordx4 v138, s[12:15], s56 offen offset:3072 lds
    s_add_u32 m0, s63, 8192
    s_mov_b32 s56, 8192
    buffer_load_dwordx4 v138, s[12:15], s56 offen offset:0 lds
    buffer_load_dwordx4 v138, s[12:15], s56 offen offset:1024 lds
    buffer_load_dwordx4 v138, s[12:15], s56 offen offset:2048 lds
    buffer_load_dwordx4 v138, s[12:15], s56 offen offset:3072 lds
    s_add_u32 m0, s63, 12288
    s_mov_b32 s56, 12288
    buffer_load_dwordx4 v138, s[12:15], s56 offen offset:0 lds
    buffer_load_dwordx4 v138, s[12:15], s56 offen offset:1024 lds
    buffer_load_dwordx4 v138, s[12:15], s56 offen offset:2048 lds
    buffer_load_dwordx4 v138, s[12:15], s56 offen offset:3072 lds
    s_barrier
    v_mov_b32 v3, 149504
    s_lshl_b32 s56, s27, 2
    s_add_u32 s56, s56, 149568
    v_mov_b32 v4, s56
    v_lshlrev_b32 v139, 7, v157
    v_lshrrev_b32 v158, 2, v156
    v_lshl_add_u32 v139, v158, 5, v139
    v_and_b32 v158, 3, v156
    v_lshl_add_u32 v139, v158, 3, v139
    v_add_u32 v139, s63, v139
    s_lshr_b32 s30, s26, 2
    s_and_b32 s32, s26, 3
    s_mul_i32 s31, s30, 2176
    s_add_u32 s31, s31, 2097152
    s_cmp_eq_u32 s27, 1
    s_cbranch_scc1 L_mega_kernel_adV_53
    v_and_b32 v156, 7, v1
    v_and_b32 v158, 1, v157
    v_lshl_add_u32 v158, v158, 3, v156
    s_and_b32 s56, s32, 1
    s_lshl_b32 s56, s56, 3
    v_add_u32 v158, s56, v158
    v_and_b32 v158, 15, v158
    v_lshlrev_b32 v158, 4, v158
    v_lshrrev_b32 v157, 1, v157
    v_lshl_add_u32 v158, v157, 3, v158
    s_lshl_b32 s56, s32, 8
    v_add_u32 v164, s56, v158
    s_mov_b32 s33, s31
    s_branch L_mega_kernel_adE_54
L_mega_kernel_adV_53:
    v_lshlrev_b32 v158, 4, v156
    v_lshl_add_u32 v158, v157, 3, v158
    v_and_b32 v159, 3, v1
    v_lshlrev_b32 v159, 3, v159
    v_add_u32 v159, 256, v159
    v_cmp_gt_u32 vcc, 32, v1
    v_cndmask_b32 v164, v159, v158, vcc
    s_lshr_b32 s56, s32, 1
    s_mul_i32 s56, s56, 576
    s_and_b32 s57, s32, 1
    s_mul_i32 s57, s57, 288
    s_add_u32 s56, s56, s57
    s_add_u32 s56, s56, s31
    s_add_u32 s33, s56, 1024
L_mega_kernel_adE_54:
    s_and_b32 s56, s30, 7
    s_mul_i32 s56, s56, 2176
    s_add_u32 s56, s56, s33
    s_sub_u32 s56, s56, s31
    v_and_b32 v156, 0xfff0, v164
    v_add_u32 v156, s56, v156
    v_lshrrev_b32 v157, 12, v156
    v_lshlrev_b32 v157, 10, v157
    v_and_b32 v158, 0x3f0, v156
    v_add_u32 v157, v157, v158
    v_lshrrev_b32 v158, 8, v156
    v_and_b32 v158, 12, v158
    v_add_u32 v165, v157, v158
    s_lshr_b32 s56, s30, 3
    s_mul_i32 s56, s56, 5120
    s_add_u32 s35, s56, 2883584
    s_waitcnt vmcnt(0) lgkmcnt(0)
    s_add_u32 s34, s23, 1
    s_or_b32 s34, s34, 1
    v_mfma_f32_16x16x32_bf16 v[148:151], v[8:11], v[8:11], 0
    ds_read_b64_tr_b16 v[72:73], v139 offset:0
    ds_read_b64_tr_b16 v[74:75], v139 offset:512
    v_mfma_f32_16x16x32_bf16 v[152:155], v[12:15], v[12:15], 0
    ds_read_b64_tr_b16 v[76:77], v139 offset:1024
    ds_read_b64_tr_b16 v[78:79], v139 offset:1536
    v_mfma_f32_16x16x32_bf16 v[148:151], v[16:19], v[16:19], v[148:151]
    ds_read_b64_tr_b16 v[80:81], v139 offset:2048
    ds_read_b64_tr_b16 v[82:83], v139 offset:2560
    v_mfma_f32_16x16x32_bf16 v[152:155], v[20:23], v[20:23], v[152:155]
    ds_read_b64_tr_b16 v[84:85], v139 offset:3072
    ds_read_b64_tr_b16 v[86:87], v139 offset:3584
    v_mfma_f32_16x16x32_bf16 v[148:151], v[24:27], v[24:27], v[148:151]
    ds_read_b64_tr_b16 v[88:89], v139 offset:4096
    ds_read_b64_tr_b16 v[90:91], v139 offset:4608
    v_mfma_f32_16x16x32_bf16 v[152:155], v[28:31], v[28:31], v[152:155]
    ds_read_b64_tr_b16 v[92:93], v139 offset:5120
    ds_read_b64_tr_b16 v[94:95], v139 offset:5632
    v_mfma_f32_16x16x32_bf16 v[148:151], v[32:35], v[32:35], v[148:151]
    ds_read_b64_tr_b16 v[96:97], v139 offset:6144
    ds_read_b64_tr_b16 v[98:99], v139 offset:6656
    v_mfma_f32_16x16x32_bf16 v[152:155], v[36:39], v[36:39], v[152:155]
    ds_read_b64_tr_b16 v[100:101], v139 offset:7168
    ds_read_b64_tr_b16 v[102:103], v139 offset:7680
    v_mfma_f32_16x16x32_bf16 v[148:151], v[40:43], v[40:43], v[148:151]
    ds_read_b64_tr_b16 v[104:105], v139 offset:8192
    ds_read_b64_tr_b16 v[106:107], v139 offset:8704
    v_mfma_f32_16x16x32_bf16 v[152:155], v[44:47], v[44:47], v[152:155]
    ds_read_b64_tr_b16 v[108:109], v139 offset:9216
    ds_read_b64_tr_b16 v[110:111], v139 offset:9728
    v_mfma_f32_16x16x32_bf16 v[148:151], v[48:51], v[48:51], v[148:151]
    ds_read_b64_tr_b16 v[112:113], v139 offset:10240
    ds_read_b64_tr_b16 v[114:115], v139 offset:10752
    v_mfma_f32_16x16x32_bf16 v[152:155], v[52:55], v[52:55], v[152:155]
    ds_read_b64_tr_b16 v[116:117], v139 offset:11264
    ds_read_b64_tr_b16 v[118:119], v139 offset:11776
    v_mfma_f32_16x16x32_bf16 v[148:151], v[56:59], v[56:59], v[148:151]
    ds_read_b64_tr_b16 v[120:121], v139 offset:12288
    ds_read_b64_tr_b16 v[122:123], v139 offset:12800
    v_mfma_f32_16x16x32_bf16 v[152:155], v[60:63], v[60:63], v[152:155]
    ds_read_b64_tr_b16 v[124:125], v139 offset:13312
    ds_read_b64_tr_b16 v[126:127], v139 offset:13824
    v_mfma_f32_16x16x32_bf16 v[148:151], v[64:67], v[64:67], v[148:151]
    ds_read_b64_tr_b16 v[128:129], v139 offset:14336
    ds_read_b64_tr_b16 v[130:131], v139 offset:14848
    v_mfma_f32_16x16x32_bf16 v[152:155], v[68:71], v[68:71], v[152:155]
    ds_read_b64_tr_b16 v[132:133], v139 offset:15360
    ds_read_b64_tr_b16 v[134:135], v139 offset:15872
    s_cmp_eq_u32 s27, 1
    s_cbranch_scc1 L_mega_kernel_mmV_55
    s_waitcnt lgkmcnt(15)
    v_mfma_f32_16x16x32_bf16 v[140:143], v[72:75], v[8:11], 0
    s_waitcnt lgkmcnt(15)
    v_mfma_f32_16x16x32_bf16 v[144:147], v[76:79], v[12:15], 0
    s_waitcnt lgkmcnt(15)
    v_mfma_f32_16x16x32_bf16 v[140:143], v[80:83], v[16:19], v[140:143]
    v_add_f32 v148, v148, v152
    v_add_f32 v149, v149, v153
    v_add_f32 v150, v150, v154
    s_waitcnt lgkmcnt(15)
    v_mfma_f32_16x16x32_bf16 v[144:147], v[84:87], v[20:23], v[144:147]
    v_add_f32 v151, v151, v155
    v_mov_b32 v156, v148
    v_mov_b32 v157, v148
    s_waitcnt lgkmcnt(15)
    v_mfma_f32_16x16x32_bf16 v[140:143], v[88:91], v[24:27], v[140:143]
    v_mov_b32 v158, 0
    s_mov_b32 s64, 1048577
    s_mov_b32 s65, 0
    s_waitcnt lgkmcnt(15)
    v_mfma_f32_16x16x32_bf16 v[144:147], v[92:95], v[28:31], v[144:147]
    v_cndmask_b32 v158, v158, v148, s[64:65]
    s_mov_b32 s64, 2097154
    s_mov_b32 s65, 0
    s_waitcnt lgkmcnt(15)
    v_mfma_f32_16x16x32_bf16 v[140:143], v[96:99], v[32:35], v[140:143]
    v_cndmask_b32 v158, v158, v149, s[64:65]
    s_mov_b32 s64, 4194308
    s_mov_b32 s65, 0
    s_waitcnt lgkmcnt(15)
    v_mfma_f32_16x16x32_bf16 v[144:147], v[100:103], v[36:39], v[144:147]
    v_cndmask_b32 v158, v158, v150, s[64:65]
    s_mov_b32 s64, 8388616
    s_mov_b32 s65, 0
    s_waitcnt lgkmcnt(14)
    v_mfma_f32_16x16x32_bf16 v[140:143], v[104:107], v[40:43], v[140:143]
    v_cndmask_b32 v158, v158, v151, s[64:65]
    v_permlane32_swap_b32 v156, v157
    v_mov_b32 v159, v158
    s_waitcnt lgkmcnt(12)
    v_mfma_f32_16x16x32_bf16 v[144:147], v[108:111], v[44:47], v[144:147]
    s_nop 1
    v_permlane16_swap_b32 v158, v159
    s_nop 1
    v_add_f32 v158, v158, v159
    v_mov_b32 v159, v158
    s_nop 1
    v_permlane32_swap_b32 v158, v159
    s_nop 1
    v_add_f32 v158, v158, v159
    s_waitcnt lgkmcnt(10)
    v_mfma_f32_16x16x32_bf16 v[140:143], v[112:115], v[48:51], v[140:143]
    v_mul_f32 v157, 0x3b000000, v157
    v_mul_f32 v158, 0x3b000000, v158
    v_fma_f32 v158, -v157, v157, v158
    s_waitcnt lgkmcnt(8)
    v_mfma_f32_16x16x32_bf16 v[144:147], v[116:119], v[52:55], v[144:147]
    v_max_f32 v158, 0, v158
    v_cvt_pk_bf16_f32 v161, v157, v158
    v_lshlrev_b32 v160, 16, v161
    s_waitcnt lgkmcnt(6)
    v_mfma_f32_16x16x32_bf16 v[140:143], v[120:123], v[56:59], v[140:143]
    v_and_b32 v161, 0xffff0000, v161
    v_add_f32 v161, 0x3727c5ac, v161
    v_cvt_pk_bf16_f32 v161, v161, v161
    s_waitcnt lgkmcnt(4)
    v_mfma_f32_16x16x32_bf16 v[144:147], v[124:127], v[60:63], v[144:147]
    v_and_b32 v161, 0xffff0000, v161
    v_sqrt_f32 v161, v161
    v_xor_b32 v160, 0x80000000, v160
    s_waitcnt lgkmcnt(2)
    v_mfma_f32_16x16x32_bf16 v[140:143], v[128:131], v[64:67], v[140:143]
    v_cvt_pk_bf16_f32 v161, v161, v161
    v_and_b32 v161, 0xffff0000, v161
    v_rcp_f32 v161, v161
    s_waitcnt lgkmcnt(0)
    v_mfma_f32_16x16x32_bf16 v[144:147], v[132:135], v[68:71], v[144:147]
    s_nop 0
    s_nop 7
    v_xor_b32 v162, s34, v160
    v_xor_b32 v163, s34, v161
    v_add_f32 v140, v140, v144
    v_add_f32 v141, v141, v145
    v_add_f32 v142, v142, v146
    v_add_f32 v143, v143, v147
    s_nop 1
    v_fmac_f32_dpp v140, v140, v160 row_newbcast:8 row_mask:0xf bank_mask:0xf
    v_fmac_f32_dpp v141, v141, v160 row_newbcast:8 row_mask:0xf bank_mask:0xf
    v_fmac_f32_dpp v142, v142, v160 row_newbcast:8 row_mask:0xf bank_mask:0xf
    v_fmac_f32_dpp v143, v143, v160 row_newbcast:8 row_mask:0xf bank_mask:0xf
    v_mul_f32 v140, v140, v161
    v_mul_f32 v141, v141, v161
    v_mul_f32 v142, v142, v161
    v_mul_f32 v143, v143, v161
    v_cvt_pk_bf16_f32 v144, v140, v141
    v_cvt_pk_bf16_f32 v145, v142, v143
    s_mov_b32 s64, 0x00ff00ff
    s_mov_b32 s65, 0x00ff00ff
    s_mov_b64 exec, s[64:65]
    buffer_store_dwordx2 v[144:145], v164, s[4:7], s33 offen sc1
    s_mov_b64 exec, -1
    v_add_u32 v146, v144, v145
    v_add_u32 v147, v144, v145
    v_lshlrev_b32 v156, 4, v1
    s_lshl_b32 s56, s26, 7
    v_permlane32_swap_b32 v146, v147
    s_add_u32 s56, s56, 2392064
    s_mov_b32 s65, 0
    v_add3_u32 v146, v146, v147, s34
    s_mov_b64 exec, s[64:65]
    buffer_store_dword v146, v165, s[4:7], s35 offen sc1
    s_mov_b64 exec, 0xff
    buffer_store_dwordx4 v[160:163], v156, s[4:7], s56 offen sc1
    s_mov_b64 exec, -1
    s_lshl_b32 s56, s26, 6
    s_add_u32 s56, s56, 2293760
    v_lshlrev_b32 v157, 3, v1
    s_mov_b64 exec, 0xff
    buffer_store_dwordx2 v[160:161], v157, s[4:7], s56 offen sc1
    s_mov_b64 exec, -1
    v_mul_f32 v156, v140, v140
    v_mul_f32 v159, v141, v141
    v_fma_f32 v156, v142, v142, v156
    v_fma_f32 v159, v143, v143, v159
    v_add_f32 v156, v156, v159
    v_mov_b32 v159, v156
    s_nop 1
    v_permlane16_swap_b32 v156, v159
    s_nop 1
    v_add_f32 v156, v156, v159
    v_mov_b32 v159, v156
    s_nop 1
    v_permlane32_swap_b32 v156, v159
    s_nop 1
    v_add_f32 v156, v156, v159
    s_nop 1
    v_max_f32_dpp v156, v156, v156 quad_perm:[1,0,3,2] row_mask:0xf bank_mask:0xf
    s_nop 1
    v_max_f32_dpp v156, v156, v156 quad_perm:[2,3,0,1] row_mask:0xf bank_mask:0xf
    s_nop 1
    v_max_f32_dpp v156, v156, v156 row_half_mirror row_mask:0xf bank_mask:0xf
    v_mul_f32 v156, 0x3f8102de, v156
    s_lshl_b32 s56, s26, 2
    s_add_u32 s56, s56, 2260992
    v_mov_b32 v159, 0
    s_mov_b64 exec, 1
    buffer_store_dword v156, v159, s[4:7], s56 offen sc1
    s_mov_b64 exec, -1
    v_mov_b32 v159, s23
    s_mov_b64 exec, 1
    ds_write_b32 v3, v159 offset:60
    s_mov_b64 exec, -1
    s_branch L_mega_kernel_mmE_51
L_mega_kernel_mmV_55:
    s_waitcnt lgkmcnt(15)
    v_mfma_f32_16x16x32_bf16 v[140:143], v[8:11], v[72:75], 0
    s_waitcnt lgkmcnt(15)
    v_mfma_f32_16x16x32_bf16 v[144:147], v[12:15], v[76:79], 0
    s_waitcnt lgkmcnt(15)
    v_mfma_f32_16x16x32_bf16 v[140:143], v[16:19], v[80:83], v[140:143]
    v_add_f32 v148, v148, v152
    v_add_f32 v149, v149, v153
    v_add_f32 v150, v150, v154
    s_waitcnt lgkmcnt(15)
    v_mfma_f32_16x16x32_bf16 v[144:147], v[20:23], v[84:87], v[144:147]
    v_add_f32 v151, v151, v155
    v_mov_b32 v156, v148
    v_mov_b32 v157, v148
    s_waitcnt lgkmcnt(15)
    v_mfma_f32_16x16x32_bf16 v[140:143], v[24:27], v[88:91], v[140:143]
    v_mov_b32 v158, 0
    s_mov_b32 s64, 1048577
    s_mov_b32 s65, 0
    s_waitcnt lgkmcnt(15)
    v_mfma_f32_16x16x32_bf16 v[144:147], v[28:31], v[92:95], v[144:147]
    v_cndmask_b32 v158, v158, v148, s[64:65]
    s_mov_b32 s64, 2097154
    s_mov_b32 s65, 0
    s_waitcnt lgkmcnt(15)
    v_mfma_f32_16x16x32_bf16 v[140:143], v[32:35], v[96:99], v[140:143]
    v_cndmask_b32 v158, v158, v149, s[64:65]
    s_mov_b32 s64, 4194308
    s_mov_b32 s65, 0
    s_waitcnt lgkmcnt(15)
    v_mfma_f32_16x16x32_bf16 v[144:147], v[36:39], v[100:103], v[144:147]
    v_cndmask_b32 v158, v158, v150, s[64:65]
    s_mov_b32 s64, 8388616
    s_mov_b32 s65, 0
    s_waitcnt lgkmcnt(14)
    v_mfma_f32_16x16x32_bf16 v[140:143], v[40:43], v[104:107], v[140:143]
    v_cndmask_b32 v158, v158, v151, s[64:65]
    v_permlane32_swap_b32 v156, v157
    v_mov_b32 v159, v158
    s_waitcnt lgkmcnt(12)
    v_mfma_f32_16x16x32_bf16 v[144:147], v[44:47], v[108:111], v[144:147]
    s_nop 1
    v_permlane16_swap_b32 v158, v159
    s_nop 1
    v_add_f32 v158, v158, v159
    v_mov_b32 v159, v158
    s_nop 1
    v_permlane32_swap_b32 v158, v159
    s_nop 1
    v_add_f32 v158, v158, v159
    s_waitcnt lgkmcnt(10)
    v_mfma_f32_16x16x32_bf16 v[140:143], v[48:51], v[112:115], v[140:143]
    v_mul_f32 v157, 0x3b000000, v157
    v_mul_f32 v158, 0x3b000000, v158
    v_fma_f32 v158, -v157, v157, v158
    s_waitcnt lgkmcnt(8)
    v_mfma_f32_16x16x32_bf16 v[144:147], v[52:55], v[116:119], v[144:147]
    v_max_f32 v158, 0, v158
    v_cvt_pk_bf16_f32 v161, v157, v158
    v_lshlrev_b32 v160, 16, v161
    s_waitcnt lgkmcnt(6)
    v_mfma_f32_16x16x32_bf16 v[140:143], v[56:59], v[120:123], v[140:143]
    v_and_b32 v161, 0xffff0000, v161
    v_add_f32 v161, 0x3727c5ac, v161
    v_cvt_pk_bf16_f32 v161, v161, v161
    s_waitcnt lgkmcnt(4)
    v_mfma_f32_16x16x32_bf16 v[144:147], v[60:63], v[124:127], v[144:147]
    v_and_b32 v161, 0xffff0000, v161
    v_sqrt_f32 v161, v161
    v_xor_b32 v160, 0x80000000, v160
    s_waitcnt lgkmcnt(2)
    v_mfma_f32_16x16x32_bf16 v[140:143], v[64:67], v[128:131], v[140:143]
    v_cvt_pk_bf16_f32 v161, v161, v161
    v_and_b32 v161, 0xffff0000, v161
    v_rcp_f32 v161, v161
    s_waitcnt lgkmcnt(0)
    v_mfma_f32_16x16x32_bf16 v[144:147], v[68:71], v[132:135], v[144:147]
    s_nop 0
    s_nop 7
    v_add_f32 v140, v140, v144
    v_add_f32 v141, v141, v145
    v_add_f32 v142, v142, v146
    v_add_f32 v143, v143, v147
    v_mov_b32_dpp v148, v160 row_newbcast:0 row_mask:0x1 bank_mask:0xf
    v_mov_b32_dpp v148, v160 row_newbcast:4 row_mask:0x2 bank_mask:0xf
    v_mov_b32_dpp v149, v161 row_newbcast:0 row_mask:0x1 bank_mask:0xf
    v_mov_b32_dpp v149, v161 row_newbcast:4 row_mask:0x2 bank_mask:0xf
    v_mov_b32 v156, v140
    v_mov_b32 v157, v140
    v_mov_b32_dpp v150, v160 row_newbcast:1 row_mask:0x1 bank_mask:0xf
    v_mov_b32_dpp v150, v160 row_newbcast:5 row_mask:0x2 bank_mask:0xf
    v_mov_b32_dpp v151, v161 row_newbcast:1 row_mask:0x1 bank_mask:0xf
    v_mov_b32_dpp v151, v161 row_newbcast:5 row_mask:0x2 bank_mask:0xf
    v_mov_b32_dpp v152, v160 row_newbcast:2 row_mask:0x1 bank_mask:0xf
    v_mov_b32_dpp v152, v160 row_newbcast:6 row_mask:0x2 bank_mask:0xf
    v_mov_b32_dpp v153, v161 row_newbcast:2 row_mask:0x1 bank_mask:0xf
    v_mov_b32_dpp v153, v161 row_newbcast:6 row_mask:0x2 bank_mask:0xf
    v_permlane32_swap_b32 v156, v157
    v_mov_b32_dpp v154, v160 row_newbcast:3 row_mask:0x1 bank_mask:0xf
    v_mov_b32_dpp v154, v160 row_newbcast:7 row_mask:0x2 bank_mask:0xf
    v_mov_b32_dpp v155, v161 row_newbcast:3 row_mask:0x1 bank_mask:0xf
    v_mov_b32_dpp v155, v161 row_newbcast:7 row_mask:0x2 bank_mask:0xf
    v_fma_f32 v140, v148, v157, v140
    v_fma_f32 v141, v150, v157, v141
    v_fma_f32 v142, v152, v157, v142
    v_fma_f32 v143, v154, v157, v143
    v_mul_f32 v140, v140, v149
    v_mul_f32 v141, v141, v151
    v_mul_f32 v142, v142, v153
    v_mul_f32 v143, v143, v155
    v_cvt_pk_bf16_f32 v144, v140, v141
    v_cvt_pk_bf16_f32 v145, v142, v143
    v_mov_b32 v156, 0x3f803f80
    v_cmp_gt_u32 vcc, 34, v1
    s_nop 1
    v_cndmask_b32 v156, 0, v156, vcc
    v_cmp_gt_u32 vcc, 32, v1
    s_nop 1
    v_cndmask_b32 v144, v156, v144, vcc
    v_cndmask_b32 v145, v156, v145, vcc
    s_mov_b32 s64, -1
    s_mov_b32 s65, 15
    s_mov_b64 exec, s[64:65]
    buffer_store_dwordx2 v[144:145], v164, s[4:7], s33 offen sc1
    s_mov_b64 exec, -1
    v_add_u32 v146, v144, v145
    v_add_u32 v147, v144, v145
    v_lshlrev_b32 v156, 2, v156
    s_nop 0
    v_permlane16_swap_b32 v146, v147
    s_nop 1
    v_add_u32 v146, v146, v147
    v_cndmask_b32 v146, v156, v146, vcc
    v_add_u32 v146, s34, v146
    s_mov_b32 s64, 0xffff
    s_mov_b32 s65, 5
    s_mov_b64 exec, s[64:65]
    buffer_store_dword v146, v165, s[4:7], s35 offen sc1
    s_mov_b64 exec, -1
L_mega_kernel_mmE_51:
    s_cmp_eq_u32 s27, 1
    s_cbranch_scc1 L_mega_kernel_ckG1_56
    s_mov_b64 exec, 2
    ds_add_u32 v3, v1 offset:0
    s_mov_b64 exec, -1
    s_waitcnt vmcnt(0)
    s_add_u32 s56, s23, 1
    v_mov_b32 v148, s56
    v_lshlrev_b32 v149, 15, v1
    s_lshl_b32 s56, s26, 7
    s_lshl_b32 s57, s27, 2
    s_add_u32 s56, s56, s57
    s_add_u32 s56, s56, 2424832
    s_mov_b64 exec, 0xff
    buffer_store_dword v148, v149, s[4:7], s56 offen sc1
    s_mov_b64 exec, -1
    s_mov_b32 s57, 400000
L_mega_kernel_lp_59:
    ds_read_b32 v5, v3 offset:40
    s_waitcnt lgkmcnt(0)
    v_readfirstlane_b32 s56, v5
    s_sub_u32 s57, s57, 1
    s_cmp_ge_u32 s56, 4
    s_cbranch_scc1 L_mega_kernel_ok_60
    s_sleep 1
    s_cmp_lg_u32 s57, 0
    s_cbranch_scc1 L_mega_kernel_lp_59
L_mega_kernel_ok_60:
    s_sub_u32 s56, s2, 0
    s_and_b32 s56, s56, 7
    s_mul_i32 s57, s56, 17408
    s_add_u32 s57, s57, 2097152
    s_mul_i32 s58, s56, 5120
    s_add_u32 s58, s58, 2883584
    s_mov_b32 m0, 114688
    s_add_u32 s60, s57, 0
    buffer_load_dwordx4 v2, s[4:7], s60 offen offset:0 sc1 lds
    buffer_load_dwordx4 v2, s[4:7], s60 offen offset:1024 sc1 lds
    buffer_load_dwordx4 v2, s[4:7], s60 offen offset:2048 sc1 lds
    buffer_load_dwordx4 v2, s[4:7], s60 offen offset:3072 sc1 lds
    s_mov_b32 m0, 118784
    s_add_u32 s60, s57, 4096
    buffer_load_dwordx4 v2, s[4:7], s60 offen offset:0 sc1 lds
    buffer_load_dwordx4 v2, s[4:7], s60 offen offset:1024 sc1 lds
    buffer_load_dwordx4 v2, s[4:7], s60 offen offset:2048 sc1 lds
    buffer_load_dwordx4 v2, s[4:7], s60 offen offset:3072 sc1 lds
    s_mov_b32 m0, 122880
    s_add_u32 s60, s57, 8192
    buffer_load_dwordx4 v2, s[4:7], s60 offen offset:0 sc1 lds
    s_add_u32 s59, s58, 0
    buffer_load_dwordx4 v[8:11], v2, s[4:7], s59 offen sc1
    s_add_u32 s59, s58, 1024
    buffer_load_dwordx4 v[12:15], v2, s[4:7], s59 offen sc1
    s_add_u32 s59, s58, 2048
    buffer_load_dwordx4 v[16:19], v2, s[4:7], s59 offen sc1
    s_mov_b64 exec, 2
    ds_add_u32 v3, v1 offset:4
    s_mov_b64 exec, -1
    v_and_b32 v148, 15, v1
    v_lshrrev_b32 v149, 4, v1
    v_lshrrev_b32 v150, 1, v148
    s_lshl_b32 s56, s27, 5
    v_add_u32 v151, s56, v148
    v_lshlrev_b32 v151, 7, v151
    v_add_u32 v151, 65536, v151
    v_xor_b32 v152, v149, v150
    v_lshl_add_u32 v167, v152, 4, v151
    v_xor_b32 v152, 4, v152
    v_lshl_add_u32 v0, v152, 4, v151
    v_lshrrev_b32 v150, 2, v148
    v_and_b32 v151, 1, v149
    v_lshl_add_u32 v152, v150, 1, v151
    v_lshl_add_u32 v153, v151, 3, v150
    v_lshlrev_b32 v153, 8, v153
    v_lshrrev_b32 v154, 1, v149
    v_lshl_add_u32 v153, v154, 13, v153
    v_and_b32 v154, 3, v148
    v_lshl_add_u32 v153, v154, 3, v153
    v_xor_b32 v154, 0, v152
    v_lshl_add_u32 v160, v154, 5, v153
    v_xor_b32 v154, 1, v152
    v_lshl_add_u32 v161, v154, 5, v153
    v_xor_b32 v154, 2, v152
    v_lshl_add_u32 v162, v154, 5, v153
    v_xor_b32 v154, 3, v152
    v_lshl_add_u32 v163, v154, 5, v153
    v_xor_b32 v154, 4, v152
    v_lshl_add_u32 v164, v154, 5, v153
    v_xor_b32 v154, 5, v152
    v_lshl_add_u32 v165, v154, 5, v153
    v_xor_b32 v154, 6, v152
    v_lshl_add_u32 v166, v154, 5, v153
    s_mov_b32 s62, 100000
    v_add_u32 v28, 114688, v2
L_mega_kernel_ckr_61:
    s_waitcnt vmcnt(0)
    ds_read_b128 v[32:35], v28 offset:0
    ds_read_b128 v[36:39], v28 offset:1024
    ds_read_b128 v[40:43], v28 offset:2048
    ds_read_b128 v[44:47], v28 offset:3072
    ds_read_b128 v[48:51], v28 offset:4096
    ds_read_b128 v[52:55], v28 offset:5120
    ds_read_b128 v[56:59], v28 offset:6144
    ds_read_b128 v[60:63], v28 offset:7168
    ds_read_b128 v[64:67], v28 offset:8192
    v_mov_b32 v148, 0
    s_waitcnt lgkmcnt(8)
    v_add3_u32 v152, v32, v33, v34
    v_add3_u32 v152, v152, v35, s34
    v_bitop3_b32 v148, v148, v152, v8 bitop3:0xf6
    s_waitcnt lgkmcnt(7)
    v_add3_u32 v152, v36, v37, v38
    v_add3_u32 v152, v152, v39, s34
    v_bitop3_b32 v148, v148, v152, v9 bitop3:0xf6
    s_waitcnt lgkmcnt(6)
    v_add3_u32 v152, v40, v41, v42
    v_add3_u32 v152, v152, v43, s34
    v_bitop3_b32 v148, v148, v152, v10 bitop3:0xf6
    s_waitcnt lgkmcnt(5)
    v_add3_u32 v152, v44, v45, v46
    v_add3_u32 v152, v152, v47, s34
    v_bitop3_b32 v148, v148, v152, v11 bitop3:0xf6
    s_waitcnt lgkmcnt(4)
    v_add3_u32 v152, v48, v49, v50
    v_add3_u32 v152, v152, v51, s34
    v_bitop3_b32 v148, v148, v152, v12 bitop3:0xf6
    s_waitcnt lgkmcnt(3)
    v_add3_u32 v152, v52, v53, v54
    v_add3_u32 v152, v152, v55, s34
    v_bitop3_b32 v148, v148, v152, v13 bitop3:0xf6
    s_waitcnt lgkmcnt(2)
    v_add3_u32 v152, v56, v57, v58
    v_add3_u32 v152, v152, v59, s34
    v_bitop3_b32 v148, v148, v152, v14 bitop3:0xf6
    s_waitcnt lgkmcnt(1)
    v_add3_u32 v152, v60, v61, v62
    v_add3_u32 v152, v152, v63, s34
    v_bitop3_b32 v148, v148, v152, v15 bitop3:0xf6
    s_waitcnt lgkmcnt(0)
    v_add3_u32 v152, v64, v65, v66
    v_add3_u32 v152, v152, v67, s34
    v_bitop3_b32 v148, v148, v152, v16 bitop3:0xf6
    v_cmp_ne_u32 vcc, 0, v148
    s_sub_u32 s62, s62, 1
    s_cmp_eq_u64 vcc, 0
    s_cbranch_scc1 L_mega_kernel_ckok_62
    s_cmp_eq_u32 s62, 0
    s_cbranch_scc1 L_mega_kernel_ckok_62
    s_sub_u32 s56, s2, 0
    s_and_b32 s56, s56, 7
    s_mul_i32 s57, s56, 17408
    s_add_u32 s57, s57, 2097152
    s_mul_i32 s58, s56, 5120
    s_add_u32 s58, s58, 2883584
    s_mov_b32 m0, 114688
    s_add_u32 s60, s57, 0
    buffer_load_dwordx4 v2, s[4:7], s60 offen offset:0 sc1 lds
    buffer_load_dwordx4 v2, s[4:7], s60 offen offset:1024 sc1 lds
    buffer_load_dwordx4 v2, s[4:7], s60 offen offset:2048 sc1 lds
    buffer_load_dwordx4 v2, s[4:7], s60 offen offset:3072 sc1 lds
    s_mov_b32 m0, 118784
    s_add_u32 s60, s57, 4096
    buffer_load_dwordx4 v2, s[4:7], s60 offen offset:0 sc1 lds
    buffer_load_dwordx4 v2, s[4:7], s60 offen offset:1024 sc1 lds
    buffer_load_dwordx4 v2, s[4:7], s60 offen offset:2048 sc1 lds
    buffer_load_dwordx4 v2, s[4:7], s60 offen offset:3072 sc1 lds
    s_mov_b32 m0, 122880
    s_add_u32 s60, s57, 8192
    buffer_load_dwordx4 v2, s[4:7], s60 offen offset:0 sc1 lds
    s_add_u32 s59, s58, 0
    buffer_load_dwordx4 v[8:11], v2, s[4:7], s59 offen sc1
    s_add_u32 s59, s58, 1024
    buffer_load_dwordx4 v[12:15], v2, s[4:7], s59 offen sc1
    s_add_u32 s59, s58, 2048
    buffer_load_dwordx4 v[16:19], v2, s[4:7], s59 offen sc1
    s_branch L_mega_kernel_ckr_61
L_mega_kernel_ckok_62:
    s_mov_b64 exec, 2
    ds_add_u32 v3, v1 offset:12
    s_mov_b64 exec, -1
    s_branch L_mega_kernel_finE_58
L_mega_kernel_ckG1_56:
    s_mov_b64 exec, 2
    ds_add_u32 v3, v1 offset:4
    s_mov_b64 exec, -1
    s_waitcnt vmcnt(0)
    s_add_u32 s56, s23, 1
    v_mov_b32 v148, s56
    v_lshlrev_b32 v149, 15, v1
    s_lshl_b32 s56, s26, 7
    s_lshl_b32 s57, s27, 2
    s_add_u32 s56, s56, s57
    s_add_u32 s56, s56, 2424832
    s_mov_b64 exec, 0xff
    buffer_store_dword v148, v149, s[4:7], s56 offen sc1
    s_mov_b64 exec, -1
    v_and_b32 v148, 15, v1
    v_lshrrev_b32 v149, 4, v1
    v_lshrrev_b32 v150, 1, v148
    s_lshl_b32 s56, s27, 5
    v_add_u32 v151, s56, v148
    v_lshlrev_b32 v151, 7, v151
    v_add_u32 v151, 65536, v151
    v_xor_b32 v152, v149, v150
    v_lshl_add_u32 v167, v152, 4, v151
    v_xor_b32 v152, 4, v152
    v_lshl_add_u32 v0, v152, 4, v151
    v_lshrrev_b32 v150, 2, v148
    v_and_b32 v151, 1, v149
    v_lshl_add_u32 v152, v150, 1, v151
    v_lshl_add_u32 v153, v151, 3, v150
    v_lshlrev_b32 v153, 8, v153
    v_lshrrev_b32 v154, 1, v149
    v_lshl_add_u32 v153, v154, 13, v153
    v_and_b32 v154, 3, v148
    v_lshl_add_u32 v153, v154, 3, v153
    v_xor_b32 v154, 0, v152
    v_lshl_add_u32 v160, v154, 5, v153
    v_xor_b32 v154, 1, v152
    v_lshl_add_u32 v161, v154, 5, v153
    v_xor_b32 v154, 2, v152
    v_lshl_add_u32 v162, v154, 5, v153
    v_xor_b32 v154, 3, v152
    v_lshl_add_u32 v163, v154, 5, v153
    v_xor_b32 v154, 4, v152
    v_lshl_add_u32 v164, v154, 5, v153
    v_xor_b32 v154, 5, v152
    v_lshl_add_u32 v165, v154, 5, v153
    v_xor_b32 v154, 6, v152
    v_lshl_add_u32 v166, v154, 5, v153
    s_branch L_mega_kernel_finE_58
L_mega_kernel_misc_50:
    v_mov_b32 v3, 149504
    s_lshl_b32 s56, s27, 2
    s_add_u32 s56, s56, 149568
    v_mov_b32 v4, s56
    s_waitcnt lgkmcnt(0)
    s_mov_b32 s6, 268435456
    s_mov_b32 s7, 0x20000
    s_mov_b32 s8, s36
    s_mov_b32 s9, s37
    s_mov_b32 s10, 2097152
    s_mov_b32 s11, 0x20000
    v_and_b32 v148, 15, v1
    v_lshrrev_b32 v149, 4, v1
    v_lshrrev_b32 v150, 1, v148
    s_lshl_b32 s56, s27, 5
    v_add_u32 v151, s56, v148
    v_lshlrev_b32 v151, 7, v151
    v_add_u32 v151, 65536, v151
    v_xor_b32 v152, v149, v150
    v_lshl_add_u32 v167, v152, 4, v151
    v_xor_b32 v152, 4, v152
    v_lshl_add_u32 v0, v152, 4, v151
    v_lshrrev_b32 v150, 2, v148
    v_and_b32 v151, 1, v149
    v_lshl_add_u32 v152, v150, 1, v151
    v_lshl_add_u32 v153, v151, 3, v150
    v_lshlrev_b32 v153, 8, v153
    v_lshrrev_b32 v154, 1, v149
    v_lshl_add_u32 v153, v154, 13, v153
    v_and_b32 v154, 3, v148
    v_lshl_add_u32 v153, v154, 3, v153
    v_xor_b32 v154, 0, v152
    v_lshl_add_u32 v160, v154, 5, v153
    v_xor_b32 v154, 1, v152
    v_lshl_add_u32 v161, v154, 5, v153
    v_xor_b32 v154, 2, v152
    v_lshl_add_u32 v162, v154, 5, v153
    v_xor_b32 v154, 3, v152
    v_lshl_add_u32 v163, v154, 5, v153
    v_xor_b32 v154, 4, v152
    v_lshl_add_u32 v164, v154, 5, v153
    v_xor_b32 v154, 5, v152
    v_lshl_add_u32 v165, v154, 5, v153
    v_xor_b32 v154, 6, v152
    v_lshl_add_u32 v166, v154, 5, v153
    s_barrier
    s_setprio 1
    s_cmp_eq_u32 s27, 2
    s_cbranch_scc1 L_mega_kernel_G2_65
    s_mov_b32 s57, 400000
L_mega_kernel_lp_66:
    ds_read_b32 v5, v3 offset:0
    s_waitcnt lgkmcnt(0)
    v_readfirstlane_b32 s56, v5
    s_sub_u32 s57, s57, 1
    s_cmp_ge_u32 s56, 1
    s_cbranch_scc1 L_mega_kernel_ok_67
    s_sleep 1
    s_cmp_lg_u32 s57, 0
    s_cbranch_scc1 L_mega_kernel_lp_66
L_mega_kernel_ok_67:
    ds_read_b32 v5, v3 offset:60
    s_waitcnt lgkmcnt(0)
    v_readfirstlane_b32 s23, v5
    s_add_u32 s34, s23, 1
    s_or_b32 s34, s34, 1
    s_mov_b32 s57, 400000
L_mega_kernel_lp_68:
    ds_read_b32 v5, v3 offset:40
    s_waitcnt lgkmcnt(0)
    v_readfirstlane_b32 s56, v5
    s_sub_u32 s57, s57, 1
    s_cmp_ge_u32 s56, 4
    s_cbranch_scc1 L_mega_kernel_ok_69
    s_sleep 1
    s_cmp_lg_u32 s57, 0
    s_cbranch_scc1 L_mega_kernel_lp_68
L_mega_kernel_ok_69:
    s_sub_u32 s56, s2, 0
    s_and_b32 s56, s56, 7
    s_mul_i32 s57, s56, 17408
    s_add_u32 s57, s57, 2106368
    s_mul_i32 s58, s56, 5120
    s_add_u32 s58, s58, 2883584
    s_mov_b32 m0, 123904
    s_add_u32 s60, s57, 0
    buffer_load_dwordx4 v2, s[4:7], s60 offen offset:0 sc1 lds
    buffer_load_dwordx4 v2, s[4:7], s60 offen offset:1024 sc1 lds
    buffer_load_dwordx4 v2, s[4:7], s60 offen offset:2048 sc1 lds
    buffer_load_dwordx4 v2, s[4:7], s60 offen offset:3072 sc1 lds
    s_mov_b32 m0, 128000
    s_add_u32 s60, s57, 4096
    buffer_load_dwordx4 v2, s[4:7], s60 offen offset:0 sc1 lds
    buffer_load_dwordx4 v2, s[4:7], s60 offen offset:1024 sc1 lds
    buffer_load_dwordx4 v2, s[4:7], s60 offen offset:2048 sc1 lds
    buffer_load_dwordx4 v2, s[4:7], s60 offen offset:3072 sc1 lds
    s_add_u32 s59, s58, 2048
    buffer_load_dwordx4 v[16:19], v2, s[4:7], s59 offen sc1
    s_add_u32 s59, s58, 3072
    buffer_load_dwordx4 v[20:23], v2, s[4:7], s59 offen sc1
    s_add_u32 s59, s58, 4096
    buffer_load_dwordx4 v[24:27], v2, s[4:7], s59 offen sc1
    s_mov_b32 s62, 100000
    v_add_u32 v28, 123904, v2
L_mega_kernel_ckr_70:
    s_waitcnt vmcnt(0)
    ds_read_b128 v[32:35], v28 offset:0
    ds_read_b128 v[36:39], v28 offset:1024
    ds_read_b128 v[40:43], v28 offset:2048
    ds_read_b128 v[44:47], v28 offset:3072
    ds_read_b128 v[48:51], v28 offset:4096
    ds_read_b128 v[52:55], v28 offset:5120
    ds_read_b128 v[56:59], v28 offset:6144
    ds_read_b128 v[60:63], v28 offset:7168
    v_mov_b32 v148, 0
    s_waitcnt lgkmcnt(7)
    v_add3_u32 v152, v32, v33, v34
    v_add3_u32 v152, v152, v35, s34
    v_bitop3_b32 v148, v148, v152, v17 bitop3:0xf6
    s_waitcnt lgkmcnt(6)
    v_add3_u32 v152, v36, v37, v38
    v_add3_u32 v152, v152, v39, s34
    v_bitop3_b32 v148, v148, v152, v18 bitop3:0xf6
    s_waitcnt lgkmcnt(5)
    v_add3_u32 v152, v40, v41, v42
    v_add3_u32 v152, v152, v43, s34
    v_bitop3_b32 v148, v148, v152, v19 bitop3:0xf6
    s_waitcnt lgkmcnt(4)
    v_add3_u32 v152, v44, v45, v46
    v_add3_u32 v152, v152, v47, s34
    v_bitop3_b32 v148, v148, v152, v20 bitop3:0xf6
    s_waitcnt lgkmcnt(3)
    v_add3_u32 v152, v48, v49, v50
    v_add3_u32 v152, v152, v51, s34
    v_bitop3_b32 v148, v148, v152, v21 bitop3:0xf6
    s_waitcnt lgkmcnt(2)
    v_add3_u32 v152, v52, v53, v54
    v_add3_u32 v152, v152, v55, s34
    v_bitop3_b32 v148, v148, v152, v22 bitop3:0xf6
    s_waitcnt lgkmcnt(1)
    v_add3_u32 v152, v56, v57, v58
    v_add3_u32 v152, v152, v59, s34
    v_bitop3_b32 v148, v148, v152, v23 bitop3:0xf6
    s_waitcnt lgkmcnt(0)
    v_add3_u32 v152, v60, v61, v62
    v_add3_u32 v152, v152, v63, s34
    v_bitop3_b32 v148, v148, v152, v24 bitop3:0xf6
    v_cmp_ne_u32 vcc, 0, v148
    s_sub_u32 s62, s62, 1
    s_cmp_eq_u64 vcc, 0
    s_cbranch_scc1 L_mega_kernel_ckok_71
    s_cmp_eq_u32 s62, 0
    s_cbranch_scc1 L_mega_kernel_ckok_71
    s_sub_u32 s56, s2, 0
    s_and_b32 s56, s56, 7
    s_mul_i32 s57, s56, 17408
    s_add_u32 s57, s57, 2106368
    s_mul_i32 s58, s56, 5120
    s_add_u32 s58, s58, 2883584
    s_mov_b32 m0, 123904
    s_add_u32 s60, s57, 0
    buffer_load_dwordx4 v2, s[4:7], s60 offen offset:0 sc1 lds
    buffer_load_dwordx4 v2, s[4:7], s60 offen offset:1024 sc1 lds
    buffer_load_dwordx4 v2, s[4:7], s60 offen offset:2048 sc1 lds
    buffer_load_dwordx4 v2, s[4:7], s60 offen offset:3072 sc1 lds
    s_mov_b32 m0, 128000
    s_add_u32 s60, s57, 4096
    buffer_load_dwordx4 v2, s[4:7], s60 offen offset:0 sc1 lds
    buffer_load_dwordx4 v2, s[4:7], s60 offen offset:1024 sc1 lds
    buffer_load_dwordx4 v2, s[4:7], s60 offen offset:2048 sc1 lds
    buffer_load_dwordx4 v2, s[4:7], s60 offen offset:3072 sc1 lds
    s_add_u32 s59, s58, 2048
    buffer_load_dwordx4 v[16:19], v2, s[4:7], s59 offen sc1
    s_add_u32 s59, s58, 3072
    buffer_load_dwordx4 v[20:23], v2, s[4:7], s59 offen sc1
    s_add_u32 s59, s58, 4096
    buffer_load_dwordx4 v[24:27], v2, s[4:7], s59 offen sc1
    s_branch L_mega_kernel_ckr_70
L_mega_kernel_ckok_71:
    s_mov_b64 exec, 2
    ds_add_u32 v3, v1 offset:48
    s_mov_b64 exec, -1
    s_branch L_mega_kernel_finE_58
L_mega_kernel_G2_65:
L_mega_kernel_mCS_63:
    s_and_b32 s56, s2, 1
    s_lshl_b32 s56, s56, 5
    s_lshr_b32 s57, s2, 3
    s_add_u32 s56, s56, s57
    s_lshr_b32 s58, s56, 2
    s_and_b32 s69, s56, 3
    s_lshr_b32 s59, s22, 2
    s_mul_i32 s59, s59, 7
    s_cmp_ge_u32 s58, 7
    s_cselect_b32 s12, s50, s48
    s_cselect_b32 s13, s51, s49
    s_cselect_b32 s60, 7, 0
    s_cselect_b32 s61, 28, 0
    s_sub_u32 s60, s58, s60
    s_add_u32 s60, s60, s59
    s_add_u32 s68, s60, s61
    s_mov_b32 s14, 1835008
    s_mov_b32 s15, 0x20000
    s_cmp_ge_u32 s58, 14
    s_cbranch_scc1 L_mega_kernel_finE_58
    s_lshl_b32 s56, s69, 7
    v_lshrrev_b32 v8, 3, v1
    v_add_u32 v8, s56, v8
    v_mul_u32_u24 v8, 3584, v8
    v_and_b32 v9, 7, v1
    v_lshlrev_b32 v9, 4, v9
    v_add_u32 v8, v8, v9
    s_lshl_b32 s56, s60, 7
    buffer_load_dwordx4 v[16:19], v8, s[12:15], s56 offen
    s_add_u32 s56, s56, 28672
    buffer_load_dwordx4 v[20:23], v8, s[12:15], s56 offen
    s_add_u32 s56, s56, 28672
    buffer_load_dwordx4 v[24:27], v8, s[12:15], s56 offen
    s_add_u32 s56, s56, 28672
    buffer_load_dwordx4 v[28:31], v8, s[12:15], s56 offen
    s_add_u32 s56, s56, 28672
    buffer_load_dwordx4 v[32:35], v8, s[12:15], s56 offen
    s_add_u32 s56, s56, 28672
    buffer_load_dwordx4 v[36:39], v8, s[12:15], s56 offen
    s_add_u32 s56, s56, 28672
    buffer_load_dwordx4 v[40:43], v8, s[12:15], s56 offen
    s_add_u32 s56, s56, 28672
    buffer_load_dwordx4 v[44:47], v8, s[12:15], s56 offen
    s_add_u32 s56, s56, 28672
    buffer_load_dwordx4 v[48:51], v8, s[12:15], s56 offen
    s_add_u32 s56, s56, 28672
    buffer_load_dwordx4 v[52:55], v8, s[12:15], s56 offen
    s_add_u32 s56, s56, 28672
    buffer_load_dwordx4 v[56:59], v8, s[12:15], s56 offen
    s_add_u32 s56, s56, 28672
    buffer_load_dwordx4 v[60:63], v8, s[12:15], s56 offen
    s_add_u32 s56, s56, 28672
    buffer_load_dwordx4 v[64:67], v8, s[12:15], s56 offen
    s_add_u32 s56, s56, 28672
    buffer_load_dwordx4 v[68:71], v8, s[12:15], s56 offen
    s_add_u32 s56, s56, 28672
    buffer_load_dwordx4 v[72:75], v8, s[12:15], s56 offen
    s_add_u32 s56, s56, 28672
    buffer_load_dwordx4 v[76:79], v8, s[12:15], s56 offen
    s_waitcnt vmcnt(15)
    v_lshlrev_b32 v88, 16, v16
    v_and_b32 v89, 0xffff0000, v16
    v_lshlrev_b32 v90, 16, v17
    v_and_b32 v91, 0xffff0000, v17
    v_lshlrev_b32 v92, 16, v18
    v_and_b32 v93, 0xffff0000, v18
    v_lshlrev_b32 v94, 16, v19
    v_and_b32 v95, 0xffff0000, v19
    s_waitcnt vmcnt(14)
    v_lshlrev_b32 v10, 16, v20
    v_and_b32 v11, 0xffff0000, v20
    v_add_f32 v88, v88, v10
    v_add_f32 v89, v89, v11
    v_lshlrev_b32 v10, 16, v21
    v_and_b32 v11, 0xffff0000, v21
    v_add_f32 v90, v90, v10
    v_add_f32 v91, v91, v11
    v_lshlrev_b32 v10, 16, v22
    v_and_b32 v11, 0xffff0000, v22
    v_add_f32 v92, v92, v10
    v_add_f32 v93, v93, v11
    v_lshlrev_b32 v10, 16, v23
    v_and_b32 v11, 0xffff0000, v23
    v_add_f32 v94, v94, v10
    v_add_f32 v95, v95, v11
    s_waitcnt vmcnt(13)
    v_lshlrev_b32 v10, 16, v24
    v_and_b32 v11, 0xffff0000, v24
    v_add_f32 v88, v88, v10
    v_add_f32 v89, v89, v11
    v_lshlrev_b32 v10, 16, v25
    v_and_b32 v11, 0xffff0000, v25
    v_add_f32 v90, v90, v10
    v_add_f32 v91, v91, v11
    v_lshlrev_b32 v10, 16, v26
    v_and_b32 v11, 0xffff0000, v26
    v_add_f32 v92, v92, v10
    v_add_f32 v93, v93, v11
    v_lshlrev_b32 v10, 16, v27
    v_and_b32 v11, 0xffff0000, v27
    v_add_f32 v94, v94, v10
    v_add_f32 v95, v95, v11
    s_waitcnt vmcnt(12)
    v_lshlrev_b32 v10, 16, v28
    v_and_b32 v11, 0xffff0000, v28
    v_add_f32 v88, v88, v10
    v_add_f32 v89, v89, v11
    v_lshlrev_b32 v10, 16, v29
    v_and_b32 v11, 0xffff0000, v29
    v_add_f32 v90, v90, v10
    v_add_f32 v91, v91, v11
    v_lshlrev_b32 v10, 16, v30
    v_and_b32 v11, 0xffff0000, v30
    v_add_f32 v92, v92, v10
    v_add_f32 v93, v93, v11
    v_lshlrev_b32 v10, 16, v31
    v_and_b32 v11, 0xffff0000, v31
    v_add_f32 v94, v94, v10
    v_add_f32 v95, v95, v11
    s_waitcnt vmcnt(11)
    v_lshlrev_b32 v10, 16, v32
    v_and_b32 v11, 0xffff0000, v32
    v_add_f32 v88, v88, v10
    v_add_f32 v89, v89, v11
    v_lshlrev_b32 v10, 16, v33
    v_and_b32 v11, 0xffff0000, v33
    v_add_f32 v90, v90, v10
    v_add_f32 v91, v91, v11
    v_lshlrev_b32 v10, 16, v34
    v_and_b32 v11, 0xffff0000, v34
    v_add_f32 v92, v92, v10
    v_add_f32 v93, v93, v11
    v_lshlrev_b32 v10, 16, v35
    v_and_b32 v11, 0xffff0000, v35
    v_add_f32 v94, v94, v10
    v_add_f32 v95, v95, v11
    s_waitcnt vmcnt(10)
    v_lshlrev_b32 v10, 16, v36
    v_and_b32 v11, 0xffff0000, v36
    v_add_f32 v88, v88, v10
    v_add_f32 v89, v89, v11
    v_lshlrev_b32 v10, 16, v37
    v_and_b32 v11, 0xffff0000, v37
    v_add_f32 v90, v90, v10
    v_add_f32 v91, v91, v11
    v_lshlrev_b32 v10, 16, v38
    v_and_b32 v11, 0xffff0000, v38
    v_add_f32 v92, v92, v10
    v_add_f32 v93, v93, v11
    v_lshlrev_b32 v10, 16, v39
    v_and_b32 v11, 0xffff0000, v39
    v_add_f32 v94, v94, v10
    v_add_f32 v95, v95, v11
    s_waitcnt vmcnt(9)
    v_lshlrev_b32 v10, 16, v40
    v_and_b32 v11, 0xffff0000, v40
    v_add_f32 v88, v88, v10
    v_add_f32 v89, v89, v11
    v_lshlrev_b32 v10, 16, v41
    v_and_b32 v11, 0xffff0000, v41
    v_add_f32 v90, v90, v10
    v_add_f32 v91, v91, v11
    v_lshlrev_b32 v10, 16, v42
    v_and_b32 v11, 0xffff0000, v42
    v_add_f32 v92, v92, v10
    v_add_f32 v93, v93, v11
    v_lshlrev_b32 v10, 16, v43
    v_and_b32 v11, 0xffff0000, v43
    v_add_f32 v94, v94, v10
    v_add_f32 v95, v95, v11
    s_waitcnt vmcnt(8)
    v_lshlrev_b32 v10, 16, v44
    v_and_b32 v11, 0xffff0000, v44
    v_add_f32 v88, v88, v10
    v_add_f32 v89, v89, v11
    v_lshlrev_b32 v10, 16, v45
    v_and_b32 v11, 0xffff0000, v45
    v_add_f32 v90, v90, v10
    v_add_f32 v91, v91, v11
    v_lshlrev_b32 v10, 16, v46
    v_and_b32 v11, 0xffff0000, v46
    v_add_f32 v92, v92, v10
    v_add_f32 v93, v93, v11
    v_lshlrev_b32 v10, 16, v47
    v_and_b32 v11, 0xffff0000, v47
    v_add_f32 v94, v94, v10
    v_add_f32 v95, v95, v11
    s_waitcnt vmcnt(7)
    v_lshlrev_b32 v10, 16, v48
    v_and_b32 v11, 0xffff0000, v48
    v_add_f32 v88, v88, v10
    v_add_f32 v89, v89, v11
    v_lshlrev_b32 v10, 16, v49
    v_and_b32 v11, 0xffff0000, v49
    v_add_f32 v90, v90, v10
    v_add_f32 v91, v91, v11
    v_lshlrev_b32 v10, 16, v50
    v_and_b32 v11, 0xffff0000, v50
    v_add_f32 v92, v92, v10
    v_add_f32 v93, v93, v11
    v_lshlrev_b32 v10, 16, v51
    v_and_b32 v11, 0xffff0000, v51
    v_add_f32 v94, v94, v10
    v_add_f32 v95, v95, v11
    s_waitcnt vmcnt(6)
    v_lshlrev_b32 v10, 16, v52
    v_and_b32 v11, 0xffff0000, v52
    v_add_f32 v88, v88, v10
    v_add_f32 v89, v89, v11
    v_lshlrev_b32 v10, 16, v53
    v_and_b32 v11, 0xffff0000, v53
    v_add_f32 v90, v90, v10
    v_add_f32 v91, v91, v11
    v_lshlrev_b32 v10, 16, v54
    v_and_b32 v11, 0xffff0000, v54
    v_add_f32 v92, v92, v10
    v_add_f32 v93, v93, v11
    v_lshlrev_b32 v10, 16, v55
    v_and_b32 v11, 0xffff0000, v55
    v_add_f32 v94, v94, v10
    v_add_f32 v95, v95, v11
    s_waitcnt vmcnt(5)
    v_lshlrev_b32 v10, 16, v56
    v_and_b32 v11, 0xffff0000, v56
    v_add_f32 v88, v88, v10
    v_add_f32 v89, v89, v11
    v_lshlrev_b32 v10, 16, v57
    v_and_b32 v11, 0xffff0000, v57
    v_add_f32 v90, v90, v10
    v_add_f32 v91, v91, v11
    v_lshlrev_b32 v10, 16, v58
    v_and_b32 v11, 0xffff0000, v58
    v_add_f32 v92, v92, v10
    v_add_f32 v93, v93, v11
    v_lshlrev_b32 v10, 16, v59
    v_and_b32 v11, 0xffff0000, v59
    v_add_f32 v94, v94, v10
    v_add_f32 v95, v95, v11
    s_waitcnt vmcnt(4)
    v_lshlrev_b32 v10, 16, v60
    v_and_b32 v11, 0xffff0000, v60
    v_add_f32 v88, v88, v10
    v_add_f32 v89, v89, v11
    v_lshlrev_b32 v10, 16, v61
    v_and_b32 v11, 0xffff0000, v61
    v_add_f32 v90, v90, v10
    v_add_f32 v91, v91, v11
    v_lshlrev_b32 v10, 16, v62
    v_and_b32 v11, 0xffff0000, v62
    v_add_f32 v92, v92, v10
    v_add_f32 v93, v93, v11
    v_lshlrev_b32 v10, 16, v63
    v_and_b32 v11, 0xffff0000, v63
    v_add_f32 v94, v94, v10
    v_add_f32 v95, v95, v11
    s_waitcnt vmcnt(3)
    v_lshlrev_b32 v10, 16, v64
    v_and_b32 v11, 0xffff0000, v64
    v_add_f32 v88, v88, v10
    v_add_f32 v89, v89, v11
    v_lshlrev_b32 v10, 16, v65
    v_and_b32 v11, 0xffff0000, v65
    v_add_f32 v90, v90, v10
    v_add_f32 v91, v91, v11
    v_lshlrev_b32 v10, 16, v66
    v_and_b32 v11, 0xffff0000, v66
    v_add_f32 v92, v92, v10
    v_add_f32 v93, v93, v11
    v_lshlrev_b32 v10, 16, v67
    v_and_b32 v11, 0xffff0000, v67
    v_add_f32 v94, v94, v10
    v_add_f32 v95, v95, v11
    s_waitcnt vmcnt(2)
    v_lshlrev_b32 v10, 16, v68
    v_and_b32 v11, 0xffff0000, v68
    v_add_f32 v88, v88, v10
    v_add_f32 v89, v89, v11
    v_lshlrev_b32 v10, 16, v69
    v_and_b32 v11, 0xffff0000, v69
    v_add_f32 v90, v90, v10
    v_add_f32 v91, v91, v11
    v_lshlrev_b32 v10, 16, v70
    v_and_b32 v11, 0xffff0000, v70
    v_add_f32 v92, v92, v10
    v_add_f32 v93, v93, v11
    v_lshlrev_b32 v10, 16, v71
    v_and_b32 v11, 0xffff0000, v71
    v_add_f32 v94, v94, v10
    v_add_f32 v95, v95, v11
    s_waitcnt vmcnt(1)
    v_lshlrev_b32 v10, 16, v72
    v_and_b32 v11, 0xffff0000, v72
    v_add_f32 v88, v88, v10
    v_add_f32 v89, v89, v11
    v_lshlrev_b32 v10, 16, v73
    v_and_b32 v11, 0xffff0000, v73
    v_add_f32 v90, v90, v10
    v_add_f32 v91, v91, v11
    v_lshlrev_b32 v10, 16, v74
    v_and_b32 v11, 0xffff0000, v74
    v_add_f32 v92, v92, v10
    v_add_f32 v93, v93, v11
    v_lshlrev_b32 v10, 16, v75
    v_and_b32 v11, 0xffff0000, v75
    v_add_f32 v94, v94, v10
    v_add_f32 v95, v95, v11
    s_waitcnt vmcnt(0)
    v_lshlrev_b32 v10, 16, v76
    v_and_b32 v11, 0xffff0000, v76
    v_add_f32 v88, v88, v10
    v_add_f32 v89, v89, v11
    v_lshlrev_b32 v10, 16, v77
    v_and_b32 v11, 0xffff0000, v77
    v_add_f32 v90, v90, v10
    v_add_f32 v91, v91, v11
    v_lshlrev_b32 v10, 16, v78
    v_and_b32 v11, 0xffff0000, v78
    v_add_f32 v92, v92, v10
    v_add_f32 v93, v93, v11
    v_lshlrev_b32 v10, 16, v79
    v_and_b32 v11, 0xffff0000, v79
    v_add_f32 v94, v94, v10
    v_add_f32 v95, v95, v11
    s_nop 1
    v_add_f32_dpp v88, v88, v88 row_ror:8 row_mask:0xf bank_mask:0xf
    v_add_f32_dpp v89, v89, v89 row_ror:8 row_mask:0xf bank_mask:0xf
    v_add_f32_dpp v90, v90, v90 row_ror:8 row_mask:0xf bank_mask:0xf
    v_add_f32_dpp v91, v91, v91 row_ror:8 row_mask:0xf bank_mask:0xf
    v_add_f32_dpp v92, v92, v92 row_ror:8 row_mask:0xf bank_mask:0xf
    v_add_f32_dpp v93, v93, v93 row_ror:8 row_mask:0xf bank_mask:0xf
    v_add_f32_dpp v94, v94, v94 row_ror:8 row_mask:0xf bank_mask:0xf
    v_add_f32_dpp v95, v95, v95 row_ror:8 row_mask:0xf bank_mask:0xf
    v_mov_b32 v16, v88
    v_mov_b32 v17, v89
    v_mov_b32 v18, v90
    v_mov_b32 v19, v91
    v_mov_b32 v20, v92
    v_mov_b32 v21, v93
    v_mov_b32 v22, v94
    v_mov_b32 v23, v95
    s_nop 1
    v_permlane16_swap_b32 v88, v16
    v_permlane16_swap_b32 v89, v17
    v_permlane16_swap_b32 v90, v18
    v_permlane16_swap_b32 v91, v19
    v_permlane16_swap_b32 v92, v20
    v_permlane16_swap_b32 v93, v21
    v_permlane16_swap_b32 v94, v22
    v_permlane16_swap_b32 v95, v23
    s_nop 1
    v_add_f32 v88, v88, v16
    v_add_f32 v89, v89, v17
    v_add_f32 v90, v90, v18
    v_add_f32 v91, v91, v19
    v_add_f32 v92, v92, v20
    v_add_f32 v93, v93, v21
    v_add_f32 v94, v94, v22
    v_add_f32 v95, v95, v23
    v_mov_b32 v16, v88
    v_mov_b32 v17, v89
    v_mov_b32 v18, v90
    v_mov_b32 v19, v91
    v_mov_b32 v20, v92
    v_mov_b32 v21, v93
    v_mov_b32 v22, v94
    v_mov_b32 v23, v95
    s_nop 1
    v_permlane32_swap_b32 v88, v16
    v_permlane32_swap_b32 v89, v17
    v_permlane32_swap_b32 v90, v18
    v_permlane32_swap_b32 v91, v19
    v_permlane32_swap_b32 v92, v20
    v_permlane32_swap_b32 v93, v21
    v_permlane32_swap_b32 v94, v22
    v_permlane32_swap_b32 v95, v23
    s_nop 1
    v_add_f32 v88, v88, v16
    v_add_f32 v89, v89, v17
    v_add_f32 v90, v90, v18
    v_add_f32 v91, v91, v19
    v_add_f32 v92, v92, v20
    v_add_f32 v93, v93, v21
    v_add_f32 v94, v94, v22
    v_add_f32 v95, v95, v23
    v_lshlrev_b32 v8, 5, v1
    v_add_u32 v8, 152576, v8
    s_mov_b64 exec, 0xff
    ds_write_b128 v8, v[88:91]
    ds_write_b128 v8, v[92:95] offset:16
    s_mov_b64 exec, -1
    v_lshlrev_b32 v8, 2, v1
    v_add_u32 v9, 152576, v8
    ds_read_b32 v16, v9
    s_lshl_b32 s56, s68, 10
    s_lshl_b32 s57, s69, 2
    s_add_u32 s56, s56, s57
    s_add_u32 s56, s56, 2326528
    v_lshlrev_b32 v8, 4, v1
    s_waitcnt lgkmcnt(0)
    buffer_store_dword v16, v8, s[4:7], s56 offen sc1
L_mega_kernel_finE_58:
    s_setprio 0
    s_mov_b32 s29, 0
    s_mov_b32 s72, 0
    s_mov_b32 s73, 0
    s_mov_b32 s74, 0
    s_mov_b32 s75, 0
    s_cmp_ge_u32 s29, 1
    s_cbranch_scc1 L_mega_kernel_rdy_73
    s_mov_b32 s57, 400000
L_mega_kernel_lp_74:
    ds_read_b32 v5, v4 offset:64
    s_waitcnt lgkmcnt(0)
    v_readfirstlane_b32 s29, v5
    s_sub_u32 s57, s57, 1
    s_cmp_ge_u32 s29, 1
    s_cbranch_scc1 L_mega_kernel_ok_75
    s_sleep 1
    s_cmp_lg_u32 s57, 0
    s_cbranch_scc1 L_mega_kernel_lp_74
L_mega_kernel_ok_75:
L_mega_kernel_rdy_73:
    s_cmp_ge_u32 s72, 1
    s_cbranch_scc1 L_mega_kernel_rdy_76
    s_mov_b32 s57, 400000
L_mega_kernel_lp_77:
    ds_read_b32 v5, v3 offset:112
    s_waitcnt lgkmcnt(0)
    v_readfirstlane_b32 s72, v5
    s_sub_u32 s57, s57, 1
    s_cmp_ge_u32 s72, 1
    s_cbranch_scc1 L_mega_kernel_ok_78
    s_sleep 1
    s_cmp_lg_u32 s57, 0
    s_cbranch_scc1 L_mega_kernel_lp_77
L_mega_kernel_ok_78:
L_mega_kernel_rdy_76:
    s_cmp_ge_u32 s73, 1
    s_cbranch_scc1 L_mega_kernel_rdy_79
    s_mov_b32 s57, 400000
L_mega_kernel_lp_80:
    ds_read_b32 v5, v3 offset:116
    s_waitcnt lgkmcnt(0)
    v_readfirstlane_b32 s73, v5
    s_sub_u32 s57, s57, 1
    s_cmp_ge_u32 s73, 1
    s_cbranch_scc1 L_mega_kernel_ok_81
    s_sleep 1
    s_cmp_lg_u32 s57, 0
    s_cbranch_scc1 L_mega_kernel_lp_80
L_mega_kernel_ok_81:
L_mega_kernel_rdy_79:
    ds_read_b128 v[144:147], v167 offset:32768
    ds_read_b128 v[148:151], v167 offset:34816
    ds_read_b64_tr_b16 v[120:121], v160 offset:0
    ds_read_b64_tr_b16 v[122:123], v160 offset:1024
    ds_read_b64_tr_b16 v[124:125], v160 offset:4096
    ds_read_b64_tr_b16 v[126:127], v160 offset:5120
    ds_read_b64_tr_b16 v[128:129], v161 offset:0
    ds_read_b64_tr_b16 v[130:131], v161 offset:1024
    ds_read_b64_tr_b16 v[132:133], v161 offset:4096
    ds_read_b64_tr_b16 v[134:135], v161 offset:5120
    ds_read_b64_tr_b16 v[136:137], v162 offset:0
    ds_read_b64_tr_b16 v[138:139], v162 offset:1024
    ds_read_b64_tr_b16 v[140:141], v162 offset:4096
    ds_read_b64_tr_b16 v[142:143], v162 offset:5120
    ds_read_b64 v[6:7], v3 offset:120
    s_waitcnt lgkmcnt(0)
    v_readfirstlane_b32 s74, v6
    v_readfirstlane_b32 s75, v7
    s_cmp_ge_u32 s74, 1
    s_cbranch_scc1 L_mega_kernel_rdy_82
    s_mov_b32 s57, 400000
L_mega_kernel_lp_83:
    ds_read_b32 v5, v3 offset:120
    s_waitcnt lgkmcnt(0)
    v_readfirstlane_b32 s74, v5
    s_sub_u32 s57, s57, 1
    s_cmp_ge_u32 s74, 1
    s_cbranch_scc1 L_mega_kernel_ok_84
    s_sleep 1
    s_cmp_lg_u32 s57, 0
    s_cbranch_scc1 L_mega_kernel_lp_83
L_mega_kernel_ok_84:
L_mega_kernel_rdy_82:
    s_cmp_ge_u32 s75, 1
    s_cbranch_scc1 L_mega_kernel_rdy_85
    s_mov_b32 s57, 400000
L_mega_kernel_lp_86:
    ds_read_b32 v5, v3 offset:124
    s_waitcnt lgkmcnt(0)
    v_readfirstlane_b32 s75, v5
    s_sub_u32 s57, s57, 1
    s_cmp_ge_u32 s75, 1
    s_cbranch_scc1 L_mega_kernel_ok_87
    s_sleep 1
    s_cmp_lg_u32 s57, 0
    s_cbranch_scc1 L_mega_kernel_lp_86
L_mega_kernel_ok_87:
L_mega_kernel_rdy_85:
    v_mfma_f32_16x16x32_bf16 v[8:11], v[120:123], v[144:147], 0
    v_mfma_f32_16x16x32_bf16 v[12:15], v[120:123], v[148:151], 0
    ds_read_b64_tr_b16 v[120:121], v163 offset:0
    ds_read_b64_tr_b16 v[122:123], v163 offset:1024
    v_mfma_f32_16x16x32_bf16 v[16:19], v[124:127], v[144:147], 0
    v_mfma_f32_16x16x32_bf16 v[20:23], v[124:127], v[148:151], 0
    ds_read_b64_tr_b16 v[124:125], v163 offset:4096
    ds_read_b64_tr_b16 v[126:127], v163 offset:5120
    ds_read_b128 v[152:155], v0 offset:32768
    ds_read_b128 v[156:159], v0 offset:34816
    v_mfma_f32_16x16x32_bf16 v[24:27], v[128:131], v[144:147], 0
    v_mfma_f32_16x16x32_bf16 v[28:31], v[128:131], v[148:151], 0
    ds_read_b64_tr_b16 v[128:129], v164 offset:0
    ds_read_b64_tr_b16 v[130:131], v164 offset:1024
    v_mfma_f32_16x16x32_bf16 v[32:35], v[132:135], v[144:147], 0
    v_mfma_f32_16x16x32_bf16 v[36:39], v[132:135], v[148:151], 0
    ds_read_b64_tr_b16 v[132:133], v164 offset:4096
    ds_read_b64_tr_b16 v[134:135], v164 offset:5120
    v_mfma_f32_16x16x32_bf16 v[40:43], v[136:139], v[144:147], 0
    v_mfma_f32_16x16x32_bf16 v[44:47], v[136:139], v[148:151], 0
    ds_read_b64_tr_b16 v[136:137], v165 offset:0
    ds_read_b64_tr_b16 v[138:139], v165 offset:1024
    v_mfma_f32_16x16x32_bf16 v[48:51], v[140:143], v[144:147], 0
    v_mfma_f32_16x16x32_bf16 v[52:55], v[140:143], v[148:151], 0
    ds_read_b64_tr_b16 v[140:141], v165 offset:4096
    ds_read_b64_tr_b16 v[142:143], v165 offset:5120
    s_waitcnt lgkmcnt(12)
    v_mfma_f32_16x16x32_bf16 v[56:59], v[120:123], v[144:147], 0
    v_mfma_f32_16x16x32_bf16 v[60:63], v[120:123], v[148:151], 0
    ds_read_b64_tr_b16 v[120:121], v166 offset:0
    ds_read_b64_tr_b16 v[122:123], v166 offset:1024
    ds_read_b64 v[6:7], v3 offset:112
    ds_read_b32 v5, v4 offset:64
    s_waitcnt lgkmcnt(14)
    v_mfma_f32_16x16x32_bf16 v[64:67], v[124:127], v[144:147], 0
    v_mfma_f32_16x16x32_bf16 v[68:71], v[124:127], v[148:151], 0
    ds_read_b64_tr_b16 v[124:125], v166 offset:4096
    ds_read_b64_tr_b16 v[126:127], v166 offset:5120
    s_waitcnt lgkmcnt(12)
    v_mfma_f32_16x16x32_bf16 v[72:75], v[128:131], v[144:147], 0
    v_mfma_f32_16x16x32_bf16 v[76:79], v[128:131], v[148:151], 0
    ds_read_b64_tr_b16 v[128:129], v160 offset:16384
    ds_read_b64_tr_b16 v[130:131], v160 offset:17408
    s_waitcnt lgkmcnt(12)
    v_mfma_f32_16x16x32_bf16 v[80:83], v[132:135], v[144:147], 0
    v_mfma_f32_16x16x32_bf16 v[84:87], v[132:135], v[148:151], 0
    ds_read_b64_tr_b16 v[132:133], v160 offset:20480
    ds_read_b64_tr_b16 v[134:135], v160 offset:21504
    s_waitcnt lgkmcnt(12)
    v_mfma_f32_16x16x32_bf16 v[88:91], v[136:139], v[144:147], 0
    v_mfma_f32_16x16x32_bf16 v[92:95], v[136:139], v[148:151], 0
    ds_read_b64_tr_b16 v[136:137], v161 offset:16384
    ds_read_b64_tr_b16 v[138:139], v161 offset:17408
    s_waitcnt lgkmcnt(12)
    v_mfma_f32_16x16x32_bf16 v[96:99], v[140:143], v[144:147], 0
    v_mfma_f32_16x16x32_bf16 v[100:103], v[140:143], v[148:151], 0
    ds_read_b64_tr_b16 v[140:141], v161 offset:20480
    ds_read_b64_tr_b16 v[142:143], v161 offset:21504
    s_waitcnt lgkmcnt(12)
    v_mfma_f32_16x16x32_bf16 v[104:107], v[120:123], v[144:147], 0
    v_mfma_f32_16x16x32_bf16 v[108:111], v[120:123], v[148:151], 0
    ds_read_b64_tr_b16 v[120:121], v162 offset:16384
    ds_read_b64_tr_b16 v[122:123], v162 offset:17408
    s_waitcnt lgkmcnt(10)
    v_mfma_f32_16x16x32_bf16 v[112:115], v[124:127], v[144:147], 0
    v_mfma_f32_16x16x32_bf16 v[116:119], v[124:127], v[148:151], 0
    ds_read_b64_tr_b16 v[124:125], v162 offset:20480
    ds_read_b64_tr_b16 v[126:127], v162 offset:21504
    s_mov_b64 exec, 4
    ds_add_u32 v4, v1
    s_mov_b64 exec, -1
    s_setprio 1
    v_readfirstlane_b32 s72, v6
    v_readfirstlane_b32 s73, v7
    v_readfirstlane_b32 s29, v5
    s_setprio 0
    s_cmp_ge_u32 s29, 2
    s_cbranch_scc1 L_mega_kernel_rdy_88
    s_mov_b32 s57, 400000
L_mega_kernel_lp_89:
    ds_read_b32 v5, v4 offset:64
    s_waitcnt lgkmcnt(0)
    v_readfirstlane_b32 s29, v5
    s_sub_u32 s57, s57, 1
    s_cmp_ge_u32 s29, 2
    s_cbranch_scc1 L_mega_kernel_ok_90
    s_sleep 1
    s_cmp_lg_u32 s57, 0
    s_cbranch_scc1 L_mega_kernel_lp_89
L_mega_kernel_ok_90:
L_mega_kernel_rdy_88:
    s_cmp_ge_u32 s72, 2
    s_cbranch_scc1 L_mega_kernel_rdy_91
    s_mov_b32 s57, 400000
L_mega_kernel_lp_92:
    ds_read_b32 v5, v3 offset:112
    s_waitcnt lgkmcnt(0)
    v_readfirstlane_b32 s72, v5
    s_sub_u32 s57, s57, 1
    s_cmp_ge_u32 s72, 2
    s_cbranch_scc1 L_mega_kernel_ok_93
    s_sleep 1
    s_cmp_lg_u32 s57, 0
    s_cbranch_scc1 L_mega_kernel_lp_92
L_mega_kernel_ok_93:
L_mega_kernel_rdy_91:
    s_cmp_ge_u32 s73, 2
    s_cbranch_scc1 L_mega_kernel_rdy_94
    s_mov_b32 s57, 400000
L_mega_kernel_lp_95:
    ds_read_b32 v5, v3 offset:116
    s_waitcnt lgkmcnt(0)
    v_readfirstlane_b32 s73, v5
    s_sub_u32 s57, s57, 1
    s_cmp_ge_u32 s73, 2
    s_cbranch_scc1 L_mega_kernel_ok_96
    s_sleep 1
    s_cmp_lg_u32 s57, 0
    s_cbranch_scc1 L_mega_kernel_lp_95
L_mega_kernel_ok_96:
L_mega_kernel_rdy_94:
    s_waitcnt lgkmcnt(11)
    v_mfma_f32_16x16x32_bf16 v[8:11], v[128:131], v[152:155], v[8:11]
    v_mfma_f32_16x16x32_bf16 v[12:15], v[128:131], v[156:159], v[12:15]
    ds_read_b64_tr_b16 v[128:129], v163 offset:16384
    ds_read_b64_tr_b16 v[130:131], v163 offset:17408
    s_waitcnt lgkmcnt(11)
    v_mfma_f32_16x16x32_bf16 v[16:19], v[132:135], v[152:155], v[16:19]
    v_mfma_f32_16x16x32_bf16 v[20:23], v[132:135], v[156:159], v[20:23]
    ds_read_b64_tr_b16 v[132:133], v163 offset:20480
    ds_read_b64_tr_b16 v[134:135], v163 offset:21504
    ds_read_b128 v[144:147], v167 offset:0
    ds_read_b128 v[148:151], v167 offset:2048
    s_waitcnt lgkmcnt(13)
    v_mfma_f32_16x16x32_bf16 v[24:27], v[136:139], v[152:155], v[24:27]
    v_mfma_f32_16x16x32_bf16 v[28:31], v[136:139], v[156:159], v[28:31]
    ds_read_b64_tr_b16 v[136:137], v164 offset:16384
    ds_read_b64_tr_b16 v[138:139], v164 offset:17408
    s_waitcnt lgkmcnt(13)
    v_mfma_f32_16x16x32_bf16 v[32:35], v[140:143], v[152:155], v[32:35]
    v_mfma_f32_16x16x32_bf16 v[36:39], v[140:143], v[156:159], v[36:39]
    ds_read_b64_tr_b16 v[140:141], v164 offset:20480
    ds_read_b64_tr_b16 v[142:143], v164 offset:21504
    s_waitcnt lgkmcnt(13)
    v_mfma_f32_16x16x32_bf16 v[40:43], v[120:123], v[152:155], v[40:43]
    v_mfma_f32_16x16x32_bf16 v[44:47], v[120:123], v[156:159], v[44:47]
    ds_read_b64_tr_b16 v[120:121], v165 offset:16384
    ds_read_b64_tr_b16 v[122:123], v165 offset:17408
    s_waitcnt lgkmcnt(13)
    v_mfma_f32_16x16x32_bf16 v[48:51], v[124:127], v[152:155], v[48:51]
    v_mfma_f32_16x16x32_bf16 v[52:55], v[124:127], v[156:159], v[52:55]
    ds_read_b64_tr_b16 v[124:125], v165 offset:20480
    ds_read_b64_tr_b16 v[126:127], v165 offset:21504
    s_waitcnt lgkmcnt(12)
    v_mfma_f32_16x16x32_bf16 v[56:59], v[128:131], v[152:155], v[56:59]
    v_mfma_f32_16x16x32_bf16 v[60:63], v[128:131], v[156:159], v[60:63]
    ds_read_b64_tr_b16 v[128:129], v166 offset:16384
    ds_read_b64_tr_b16 v[130:131], v166 offset:17408
    ds_read_b64 v[6:7], v3 offset:120
    s_waitcnt lgkmcnt(13)
    v_mfma_f32_16x16x32_bf16 v[64:67], v[132:135], v[152:155], v[64:67]
    v_mfma_f32_16x16x32_bf16 v[68:71], v[132:135], v[156:159], v[68:71]
    ds_read_b64_tr_b16 v[132:133], v166 offset:20480
    ds_read_b64_tr_b16 v[134:135], v166 offset:21504
    s_waitcnt lgkmcnt(11)
    v_mfma_f32_16x16x32_bf16 v[72:75], v[136:139], v[152:155], v[72:75]
    v_mfma_f32_16x16x32_bf16 v[76:79], v[136:139], v[156:159], v[76:79]
    ds_read_b64_tr_b16 v[136:137], v160 offset:32768
    ds_read_b64_tr_b16 v[138:139], v160 offset:33792
    s_waitcnt lgkmcnt(11)
    v_mfma_f32_16x16x32_bf16 v[80:83], v[140:143], v[152:155], v[80:83]
    v_mfma_f32_16x16x32_bf16 v[84:87], v[140:143], v[156:159], v[84:87]
    ds_read_b64_tr_b16 v[140:141], v160 offset:36864
    ds_read_b64_tr_b16 v[142:143], v160 offset:37888
    s_waitcnt lgkmcnt(11)
    v_mfma_f32_16x16x32_bf16 v[88:91], v[120:123], v[152:155], v[88:91]
    v_mfma_f32_16x16x32_bf16 v[92:95], v[120:123], v[156:159], v[92:95]
    ds_read_b64_tr_b16 v[120:121], v161 offset:32768
    ds_read_b64_tr_b16 v[122:123], v161 offset:33792
    s_waitcnt lgkmcnt(11)
    v_mfma_f32_16x16x32_bf16 v[96:99], v[124:127], v[152:155], v[96:99]
    v_mfma_f32_16x16x32_bf16 v[100:103], v[124:127], v[156:159], v[100:103]
    ds_read_b64_tr_b16 v[124:125], v161 offset:36864
    ds_read_b64_tr_b16 v[126:127], v161 offset:37888
    s_waitcnt lgkmcnt(11)
    v_mfma_f32_16x16x32_bf16 v[104:107], v[128:131], v[152:155], v[104:107]
    v_mfma_f32_16x16x32_bf16 v[108:111], v[128:131], v[156:159], v[108:111]
    ds_read_b64_tr_b16 v[128:129], v162 offset:32768
    ds_read_b64_tr_b16 v[130:131], v162 offset:33792
    s_waitcnt lgkmcnt(10)
    v_mfma_f32_16x16x32_bf16 v[112:115], v[132:135], v[152:155], v[112:115]
    v_mfma_f32_16x16x32_bf16 v[116:119], v[132:135], v[156:159], v[116:119]
    ds_read_b64_tr_b16 v[132:133], v162 offset:36864
    ds_read_b64_tr_b16 v[134:135], v162 offset:37888
    s_mov_b64 exec, 4
    ds_add_u32 v4, v1
    s_mov_b64 exec, -1
    s_setprio 1
    v_readfirstlane_b32 s74, v6
    v_readfirstlane_b32 s75, v7
    s_setprio 0
    s_cmp_ge_u32 s74, 2
    s_cbranch_scc1 L_mega_kernel_rdy_97
    s_mov_b32 s57, 400000
L_mega_kernel_lp_98:
    ds_read_b32 v5, v3 offset:120
    s_waitcnt lgkmcnt(0)
    v_readfirstlane_b32 s74, v5
    s_sub_u32 s57, s57, 1
    s_cmp_ge_u32 s74, 2
    s_cbranch_scc1 L_mega_kernel_ok_99
    s_sleep 1
    s_cmp_lg_u32 s57, 0
    s_cbranch_scc1 L_mega_kernel_lp_98
L_mega_kernel_ok_99:
L_mega_kernel_rdy_97:
    s_cmp_ge_u32 s75, 2
    s_cbranch_scc1 L_mega_kernel_rdy_100
    s_mov_b32 s57, 400000
L_mega_kernel_lp_101:
    ds_read_b32 v5, v3 offset:124
    s_waitcnt lgkmcnt(0)
    v_readfirstlane_b32 s75, v5
    s_sub_u32 s57, s57, 1
    s_cmp_ge_u32 s75, 2
    s_cbranch_scc1 L_mega_kernel_ok_102
    s_sleep 1
    s_cmp_lg_u32 s57, 0
    s_cbranch_scc1 L_mega_kernel_lp_101
L_mega_kernel_ok_102:
L_mega_kernel_rdy_100:
    s_waitcnt lgkmcnt(11)
    v_mfma_f32_16x16x32_bf16 v[8:11], v[136:139], v[144:147], v[8:11]
    v_mfma_f32_16x16x32_bf16 v[12:15], v[136:139], v[148:151], v[12:15]
    ds_read_b64_tr_b16 v[136:137], v163 offset:32768
    ds_read_b64_tr_b16 v[138:139], v163 offset:33792
    s_waitcnt lgkmcnt(11)
    v_mfma_f32_16x16x32_bf16 v[16:19], v[140:143], v[144:147], v[16:19]
    v_mfma_f32_16x16x32_bf16 v[20:23], v[140:143], v[148:151], v[20:23]
    ds_read_b64_tr_b16 v[140:141], v163 offset:36864
    ds_read_b64_tr_b16 v[142:143], v163 offset:37888
    ds_read_b128 v[152:155], v0 offset:0
    ds_read_b128 v[156:159], v0 offset:2048
    s_waitcnt lgkmcnt(13)
    v_mfma_f32_16x16x32_bf16 v[24:27], v[120:123], v[144:147], v[24:27]
    v_mfma_f32_16x16x32_bf16 v[28:31], v[120:123], v[148:151], v[28:31]
    ds_read_b64_tr_b16 v[120:121], v164 offset:32768
    ds_read_b64_tr_b16 v[122:123], v164 offset:33792
    s_waitcnt lgkmcnt(13)
    v_mfma_f32_16x16x32_bf16 v[32:35], v[124:127], v[144:147], v[32:35]
    v_mfma_f32_16x16x32_bf16 v[36:39], v[124:127], v[148:151], v[36:39]
    ds_read_b64_tr_b16 v[124:125], v164 offset:36864
    ds_read_b64_tr_b16 v[126:127], v164 offset:37888
    s_waitcnt lgkmcnt(13)
    v_mfma_f32_16x16x32_bf16 v[40:43], v[128:131], v[144:147], v[40:43]
    v_mfma_f32_16x16x32_bf16 v[44:47], v[128:131], v[148:151], v[44:47]
    ds_read_b64_tr_b16 v[128:129], v165 offset:32768
    ds_read_b64_tr_b16 v[130:131], v165 offset:33792
    s_waitcnt lgkmcnt(13)
    v_mfma_f32_16x16x32_bf16 v[48:51], v[132:135], v[144:147], v[48:51]
    v_mfma_f32_16x16x32_bf16 v[52:55], v[132:135], v[148:151], v[52:55]
    ds_read_b64_tr_b16 v[132:133], v165 offset:36864
    ds_read_b64_tr_b16 v[134:135], v165 offset:37888
    s_waitcnt lgkmcnt(12)
    v_mfma_f32_16x16x32_bf16 v[56:59], v[136:139], v[144:147], v[56:59]
    v_mfma_f32_16x16x32_bf16 v[60:63], v[136:139], v[148:151], v[60:63]
    ds_read_b64_tr_b16 v[136:137], v166 offset:32768
    ds_read_b64_tr_b16 v[138:139], v166 offset:33792
    ds_read_b64 v[6:7], v3 offset:112
    ds_read_b32 v5, v4 offset:64
    s_waitcnt lgkmcnt(14)
    v_mfma_f32_16x16x32_bf16 v[64:67], v[140:143], v[144:147], v[64:67]
    v_mfma_f32_16x16x32_bf16 v[68:71], v[140:143], v[148:151], v[68:71]
    ds_read_b64_tr_b16 v[140:141], v166 offset:36864
    ds_read_b64_tr_b16 v[142:143], v166 offset:37888
    s_waitcnt lgkmcnt(12)
    v_mfma_f32_16x16x32_bf16 v[72:75], v[120:123], v[144:147], v[72:75]
    v_mfma_f32_16x16x32_bf16 v[76:79], v[120:123], v[148:151], v[76:79]
    ds_read_b64_tr_b16 v[120:121], v160 offset:49152
    ds_read_b64_tr_b16 v[122:123], v160 offset:50176
    s_waitcnt lgkmcnt(12)
    v_mfma_f32_16x16x32_bf16 v[80:83], v[124:127], v[144:147], v[80:83]
    v_mfma_f32_16x16x32_bf16 v[84:87], v[124:127], v[148:151], v[84:87]
    ds_read_b64_tr_b16 v[124:125], v160 offset:53248
    ds_read_b64_tr_b16 v[126:127], v160 offset:54272
    s_waitcnt lgkmcnt(12)
    v_mfma_f32_16x16x32_bf16 v[88:91], v[128:131], v[144:147], v[88:91]
    v_mfma_f32_16x16x32_bf16 v[92:95], v[128:131], v[148:151], v[92:95]
    ds_read_b64_tr_b16 v[128:129], v161 offset:49152
    ds_read_b64_tr_b16 v[130:131], v161 offset:50176
    s_waitcnt lgkmcnt(12)
    v_mfma_f32_16x16x32_bf16 v[96:99], v[132:135], v[144:147], v[96:99]
    v_mfma_f32_16x16x32_bf16 v[100:103], v[132:135], v[148:151], v[100:103]
    ds_read_b64_tr_b16 v[132:133], v161 offset:53248
    ds_read_b64_tr_b16 v[134:135], v161 offset:54272
    s_waitcnt lgkmcnt(12)
    v_mfma_f32_16x16x32_bf16 v[104:107], v[136:139], v[144:147], v[104:107]
    v_mfma_f32_16x16x32_bf16 v[108:111], v[136:139], v[148:151], v[108:111]
    ds_read_b64_tr_b16 v[136:137], v162 offset:49152
    ds_read_b64_tr_b16 v[138:139], v162 offset:50176
    s_waitcnt lgkmcnt(10)
    v_mfma_f32_16x16x32_bf16 v[112:115], v[140:143], v[144:147], v[112:115]
    v_mfma_f32_16x16x32_bf16 v[116:119], v[140:143], v[148:151], v[116:119]
    ds_read_b64_tr_b16 v[140:141], v162 offset:53248
    ds_read_b64_tr_b16 v[142:143], v162 offset:54272
    s_mov_b64 exec, 4
    ds_add_u32 v4, v1
    s_mov_b64 exec, -1
    s_setprio 1
    v_readfirstlane_b32 s72, v6
    v_readfirstlane_b32 s73, v7
    v_readfirstlane_b32 s29, v5
    s_setprio 0
    s_cmp_ge_u32 s29, 3
    s_cbranch_scc1 L_mega_kernel_rdy_103
    s_mov_b32 s57, 400000
L_mega_kernel_lp_104:
    ds_read_b32 v5, v4 offset:64
    s_waitcnt lgkmcnt(0)
    v_readfirstlane_b32 s29, v5
    s_sub_u32 s57, s57, 1
    s_cmp_ge_u32 s29, 3
    s_cbranch_scc1 L_mega_kernel_ok_105
    s_sleep 1
    s_cmp_lg_u32 s57, 0
    s_cbranch_scc1 L_mega_kernel_lp_104
L_mega_kernel_ok_105:
L_mega_kernel_rdy_103:
    s_cmp_ge_u32 s72, 3
    s_cbranch_scc1 L_mega_kernel_rdy_106
    s_mov_b32 s57, 400000
L_mega_kernel_lp_107:
    ds_read_b32 v5, v3 offset:112
    s_waitcnt lgkmcnt(0)
    v_readfirstlane_b32 s72, v5
    s_sub_u32 s57, s57, 1
    s_cmp_ge_u32 s72, 3
    s_cbranch_scc1 L_mega_kernel_ok_108
    s_sleep 1
    s_cmp_lg_u32 s57, 0
    s_cbranch_scc1 L_mega_kernel_lp_107
L_mega_kernel_ok_108:
L_mega_kernel_rdy_106:
    s_cmp_ge_u32 s73, 3
    s_cbranch_scc1 L_mega_kernel_rdy_109
    s_mov_b32 s57, 400000
L_mega_kernel_lp_110:
    ds_read_b32 v5, v3 offset:116
    s_waitcnt lgkmcnt(0)
    v_readfirstlane_b32 s73, v5
    s_sub_u32 s57, s57, 1
    s_cmp_ge_u32 s73, 3
    s_cbranch_scc1 L_mega_kernel_ok_111
    s_sleep 1
    s_cmp_lg_u32 s57, 0
    s_cbranch_scc1 L_mega_kernel_lp_110
L_mega_kernel_ok_111:
L_mega_kernel_rdy_109:
    s_waitcnt lgkmcnt(11)
    v_mfma_f32_16x16x32_bf16 v[8:11], v[120:123], v[152:155], v[8:11]
    v_mfma_f32_16x16x32_bf16 v[12:15], v[120:123], v[156:159], v[12:15]
    ds_read_b64_tr_b16 v[120:121], v163 offset:49152
    ds_read_b64_tr_b16 v[122:123], v163 offset:50176
    s_waitcnt lgkmcnt(11)
    v_mfma_f32_16x16x32_bf16 v[16:19], v[124:127], v[152:155], v[16:19]
    v_mfma_f32_16x16x32_bf16 v[20:23], v[124:127], v[156:159], v[20:23]
    ds_read_b64_tr_b16 v[124:125], v163 offset:53248
    ds_read_b64_tr_b16 v[126:127], v163 offset:54272
    ds_read_b128 v[144:147], v167 offset:16384
    ds_read_b128 v[148:151], v167 offset:18432
    s_waitcnt lgkmcnt(13)
    v_mfma_f32_16x16x32_bf16 v[24:27], v[128:131], v[152:155], v[24:27]
    v_mfma_f32_16x16x32_bf16 v[28:31], v[128:131], v[156:159], v[28:31]
    ds_read_b64_tr_b16 v[128:129], v164 offset:49152
    ds_read_b64_tr_b16 v[130:131], v164 offset:50176
    s_waitcnt lgkmcnt(13)
    v_mfma_f32_16x16x32_bf16 v[32:35], v[132:135], v[152:155], v[32:35]
    v_mfma_f32_16x16x32_bf16 v[36:39], v[132:135], v[156:159], v[36:39]
    ds_read_b64_tr_b16 v[132:133], v164 offset:53248
    ds_read_b64_tr_b16 v[134:135], v164 offset:54272
    s_waitcnt lgkmcnt(13)
    v_mfma_f32_16x16x32_bf16 v[40:43], v[136:139], v[152:155], v[40:43]
    v_mfma_f32_16x16x32_bf16 v[44:47], v[136:139], v[156:159], v[44:47]
    ds_read_b64_tr_b16 v[136:137], v165 offset:49152
    ds_read_b64_tr_b16 v[138:139], v165 offset:50176
    s_waitcnt lgkmcnt(13)
    v_mfma_f32_16x16x32_bf16 v[48:51], v[140:143], v[152:155], v[48:51]
    v_mfma_f32_16x16x32_bf16 v[52:55], v[140:143], v[156:159], v[52:55]
    ds_read_b64_tr_b16 v[140:141], v165 offset:53248
    ds_read_b64_tr_b16 v[142:143], v165 offset:54272
    s_waitcnt lgkmcnt(12)
    v_mfma_f32_16x16x32_bf16 v[56:59], v[120:123], v[152:155], v[56:59]
    v_mfma_f32_16x16x32_bf16 v[60:63], v[120:123], v[156:159], v[60:63]
    ds_read_b64_tr_b16 v[120:121], v166 offset:49152
    ds_read_b64_tr_b16 v[122:123], v166 offset:50176
    ds_read_b64 v[6:7], v3 offset:120
    s_waitcnt lgkmcnt(13)
    v_mfma_f32_16x16x32_bf16 v[64:67], v[124:127], v[152:155], v[64:67]
    v_mfma_f32_16x16x32_bf16 v[68:71], v[124:127], v[156:159], v[68:71]
    ds_read_b64_tr_b16 v[124:125], v166 offset:53248
    ds_read_b64_tr_b16 v[126:127], v166 offset:54272
    s_waitcnt lgkmcnt(11)
    v_mfma_f32_16x16x32_bf16 v[72:75], v[128:131], v[152:155], v[72:75]
    v_mfma_f32_16x16x32_bf16 v[76:79], v[128:131], v[156:159], v[76:79]
    ds_read_b64_tr_b16 v[128:129], v160 offset:0
    ds_read_b64_tr_b16 v[130:131], v160 offset:1024
    s_waitcnt lgkmcnt(11)
    v_mfma_f32_16x16x32_bf16 v[80:83], v[132:135], v[152:155], v[80:83]
    v_mfma_f32_16x16x32_bf16 v[84:87], v[132:135], v[156:159], v[84:87]
    ds_read_b64_tr_b16 v[132:133], v160 offset:4096
    ds_read_b64_tr_b16 v[134:135], v160 offset:5120
    s_waitcnt lgkmcnt(11)
    v_mfma_f32_16x16x32_bf16 v[88:91], v[136:139], v[152:155], v[88:91]
    v_mfma_f32_16x16x32_bf16 v[92:95], v[136:139], v[156:159], v[92:95]
    ds_read_b64_tr_b16 v[136:137], v161 offset:0
    ds_read_b64_tr_b16 v[138:139], v161 offset:1024
    s_waitcnt lgkmcnt(11)
    v_mfma_f32_16x16x32_bf16 v[96:99], v[140:143], v[152:155], v[96:99]
    v_mfma_f32_16x16x32_bf16 v[100:103], v[140:143], v[156:159], v[100:103]
    ds_read_b64_tr_b16 v[140:141], v161 offset:4096
    ds_read_b64_tr_b16 v[142:143], v161 offset:5120
    s_waitcnt lgkmcnt(11)
    v_mfma_f32_16x16x32_bf16 v[104:107], v[120:123], v[152:155], v[104:107]
    v_mfma_f32_16x16x32_bf16 v[108:111], v[120:123], v[156:159], v[108:111]
    ds_read_b64_tr_b16 v[120:121], v162 offset:0
    ds_read_b64_tr_b16 v[122:123], v162 offset:1024
    s_waitcnt lgkmcnt(10)
    v_mfma_f32_16x16x32_bf16 v[112:115], v[124:127], v[152:155], v[112:115]
    v_mfma_f32_16x16x32_bf16 v[116:119], v[124:127], v[156:159], v[116:119]
    ds_read_b64_tr_b16 v[124:125], v162 offset:4096
    ds_read_b64_tr_b16 v[126:127], v162 offset:5120
    s_mov_b64 exec, 4
    ds_add_u32 v4, v1
    s_mov_b64 exec, -1
    s_waitcnt vmcnt(0)
    s_mov_b64 exec, 2
    ds_add_u32 v3, v1 offset:16
    s_mov_b64 exec, -1
    s_waitcnt lgkmcnt(0)
    s_mov_b32 s57, 400000
L_mega_kernel_lp_112:
    ds_read_b32 v5, v3 offset:4
    s_waitcnt lgkmcnt(0)
    v_readfirstlane_b32 s56, v5
    s_sub_u32 s57, s57, 1
    s_cmp_ge_u32 s56, 2
    s_cbranch_scc1 L_mega_kernel_ok_113
    s_sleep 1
    s_cmp_lg_u32 s57, 0
    s_cbranch_scc1 L_mega_kernel_lp_112
L_mega_kernel_ok_113:
    ds_read_b32 v5, v3 offset:60
    s_waitcnt lgkmcnt(0)
    v_readfirstlane_b32 s23, v5
    s_setprio 1
    v_readfirstlane_b32 s74, v6
    v_readfirstlane_b32 s75, v7
    s_setprio 0
    s_cmp_ge_u32 s74, 3
    s_cbranch_scc1 L_mega_kernel_rdy_114
    s_mov_b32 s57, 400000
L_mega_kernel_lp_115:
    ds_read_b32 v5, v3 offset:120
    s_waitcnt lgkmcnt(0)
    v_readfirstlane_b32 s74, v5
    s_sub_u32 s57, s57, 1
    s_cmp_ge_u32 s74, 3
    s_cbranch_scc1 L_mega_kernel_ok_116
    s_sleep 1
    s_cmp_lg_u32 s57, 0
    s_cbranch_scc1 L_mega_kernel_lp_115
L_mega_kernel_ok_116:
L_mega_kernel_rdy_114:
    s_cmp_ge_u32 s75, 3
    s_cbranch_scc1 L_mega_kernel_rdy_117
    s_mov_b32 s57, 400000
L_mega_kernel_lp_118:
    ds_read_b32 v5, v3 offset:124
    s_waitcnt lgkmcnt(0)
    v_readfirstlane_b32 s75, v5
    s_sub_u32 s57, s57, 1
    s_cmp_ge_u32 s75, 3
    s_cbranch_scc1 L_mega_kernel_ok_119
    s_sleep 1
    s_cmp_lg_u32 s57, 0
    s_cbranch_scc1 L_mega_kernel_lp_118
L_mega_kernel_ok_119:
L_mega_kernel_rdy_117:
    v_mfma_f32_16x16x32_bf16 v[8:11], v[128:131], v[144:147], v[8:11]
    v_mfma_f32_16x16x32_bf16 v[12:15], v[128:131], v[148:151], v[12:15]
    ds_read_b64_tr_b16 v[128:129], v163 offset:0
    ds_read_b64_tr_b16 v[130:131], v163 offset:1024
    v_mfma_f32_16x16x32_bf16 v[16:19], v[132:135], v[144:147], v[16:19]
    v_mfma_f32_16x16x32_bf16 v[20:23], v[132:135], v[148:151], v[20:23]
    ds_read_b64_tr_b16 v[132:133], v163 offset:4096
    ds_read_b64_tr_b16 v[134:135], v163 offset:5120
    ds_read_b128 v[152:155], v0 offset:16384
    ds_read_b128 v[156:159], v0 offset:18432
    v_mfma_f32_16x16x32_bf16 v[24:27], v[136:139], v[144:147], v[24:27]
    v_mfma_f32_16x16x32_bf16 v[28:31], v[136:139], v[148:151], v[28:31]
    ds_read_b64_tr_b16 v[136:137], v164 offset:0
    ds_read_b64_tr_b16 v[138:139], v164 offset:1024
    v_mfma_f32_16x16x32_bf16 v[32:35], v[140:143], v[144:147], v[32:35]
    v_mfma_f32_16x16x32_bf16 v[36:39], v[140:143], v[148:151], v[36:39]
    ds_read_b64_tr_b16 v[140:141], v164 offset:4096
    ds_read_b64_tr_b16 v[142:143], v164 offset:5120
    v_mfma_f32_16x16x32_bf16 v[40:43], v[120:123], v[144:147], v[40:43]
    v_mfma_f32_16x16x32_bf16 v[44:47], v[120:123], v[148:151], v[44:47]
    ds_read_b64_tr_b16 v[120:121], v165 offset:0
    ds_read_b64_tr_b16 v[122:123], v165 offset:1024
    v_mfma_f32_16x16x32_bf16 v[48:51], v[124:127], v[144:147], v[48:51]
    v_mfma_f32_16x16x32_bf16 v[52:55], v[124:127], v[148:151], v[52:55]
    ds_read_b64_tr_b16 v[124:125], v165 offset:4096
    ds_read_b64_tr_b16 v[126:127], v165 offset:5120
    s_waitcnt lgkmcnt(12)
    v_mfma_f32_16x16x32_bf16 v[56:59], v[128:131], v[144:147], v[56:59]
    v_mfma_f32_16x16x32_bf16 v[60:63], v[128:131], v[148:151], v[60:63]
    ds_read_b64_tr_b16 v[128:129], v166 offset:0
    ds_read_b64_tr_b16 v[130:131], v166 offset:1024
    ds_read_b64 v[6:7], v3 offset:112
    ds_read_b32 v5, v4 offset:64
    s_waitcnt lgkmcnt(14)
    v_mfma_f32_16x16x32_bf16 v[64:67], v[132:135], v[144:147], v[64:67]
    v_mfma_f32_16x16x32_bf16 v[68:71], v[132:135], v[148:151], v[68:71]
    ds_read_b64_tr_b16 v[132:133], v166 offset:4096
    ds_read_b64_tr_b16 v[134:135], v166 offset:5120
    s_waitcnt lgkmcnt(12)
    v_mfma_f32_16x16x32_bf16 v[72:75], v[136:139], v[144:147], v[72:75]
    v_mfma_f32_16x16x32_bf16 v[76:79], v[136:139], v[148:151], v[76:79]
    ds_read_b64_tr_b16 v[136:137], v160 offset:16384
    ds_read_b64_tr_b16 v[138:139], v160 offset:17408
    s_waitcnt lgkmcnt(12)
    v_mfma_f32_16x16x32_bf16 v[80:83], v[140:143], v[144:147], v[80:83]
    v_mfma_f32_16x16x32_bf16 v[84:87], v[140:143], v[148:151], v[84:87]
    ds_read_b64_tr_b16 v[140:141], v160 offset:20480
    ds_read_b64_tr_b16 v[142:143], v160 offset:21504
    s_waitcnt lgkmcnt(12)
    v_mfma_f32_16x16x32_bf16 v[88:91], v[120:123], v[144:147], v[88:91]
    v_mfma_f32_16x16x32_bf16 v[92:95], v[120:123], v[148:151], v[92:95]
    ds_read_b64_tr_b16 v[120:121], v161 offset:16384
    ds_read_b64_tr_b16 v[122:123], v161 offset:17408
    s_waitcnt lgkmcnt(12)
    v_mfma_f32_16x16x32_bf16 v[96:99], v[124:127], v[144:147], v[96:99]
    v_mfma_f32_16x16x32_bf16 v[100:103], v[124:127], v[148:151], v[100:103]
    ds_read_b64_tr_b16 v[124:125], v161 offset:20480
    ds_read_b64_tr_b16 v[126:127], v161 offset:21504
    s_waitcnt lgkmcnt(12)
    v_mfma_f32_16x16x32_bf16 v[104:107], v[128:131], v[144:147], v[104:107]
    v_mfma_f32_16x16x32_bf16 v[108:111], v[128:131], v[148:151], v[108:111]
    ds_read_b64_tr_b16 v[128:129], v162 offset:16384
    ds_read_b64_tr_b16 v[130:131], v162 offset:17408
    s_waitcnt lgkmcnt(10)
    v_mfma_f32_16x16x32_bf16 v[112:115], v[132:135], v[144:147], v[112:115]
    v_mfma_f32_16x16x32_bf16 v[116:119], v[132:135], v[148:151], v[116:119]
    ds_read_b64_tr_b16 v[132:133], v162 offset:20480
    ds_read_b64_tr_b16 v[134:135], v162 offset:21504
    s_mov_b64 exec, 4
    ds_add_u32 v4, v1
    s_mov_b64 exec, -1
    s_setprio 1
    v_readfirstlane_b32 s72, v6
    v_readfirstlane_b32 s73, v7
    v_readfirstlane_b32 s29, v5
    s_setprio 0
    s_cmp_ge_u32 s29, 4
    s_cbranch_scc1 L_mega_kernel_rdy_120
    s_mov_b32 s57, 400000
L_mega_kernel_lp_121:
    ds_read_b32 v5, v4 offset:64
    s_waitcnt lgkmcnt(0)
    v_readfirstlane_b32 s29, v5
    s_sub_u32 s57, s57, 1
    s_cmp_ge_u32 s29, 4
    s_cbranch_scc1 L_mega_kernel_ok_122
    s_sleep 1
    s_cmp_lg_u32 s57, 0
    s_cbranch_scc1 L_mega_kernel_lp_121
L_mega_kernel_ok_122:
L_mega_kernel_rdy_120:
    s_cmp_ge_u32 s72, 4
    s_cbranch_scc1 L_mega_kernel_rdy_123
    s_mov_b32 s57, 400000
L_mega_kernel_lp_124:
    ds_read_b32 v5, v3 offset:112
    s_waitcnt lgkmcnt(0)
    v_readfirstlane_b32 s72, v5
    s_sub_u32 s57, s57, 1
    s_cmp_ge_u32 s72, 4
    s_cbranch_scc1 L_mega_kernel_ok_125
    s_sleep 1
    s_cmp_lg_u32 s57, 0
    s_cbranch_scc1 L_mega_kernel_lp_124
L_mega_kernel_ok_125:
L_mega_kernel_rdy_123:
    s_cmp_ge_u32 s73, 4
    s_cbranch_scc1 L_mega_kernel_rdy_126
    s_mov_b32 s57, 400000
L_mega_kernel_lp_127:
    ds_read_b32 v5, v3 offset:116
    s_waitcnt lgkmcnt(0)
    v_readfirstlane_b32 s73, v5
    s_sub_u32 s57, s57, 1
    s_cmp_ge_u32 s73, 4
    s_cbranch_scc1 L_mega_kernel_ok_128
    s_sleep 1
    s_cmp_lg_u32 s57, 0
    s_cbranch_scc1 L_mega_kernel_lp_127
L_mega_kernel_ok_128:
L_mega_kernel_rdy_126:
    s_waitcnt lgkmcnt(11)
    v_mfma_f32_16x16x32_bf16 v[8:11], v[136:139], v[152:155], v[8:11]
    v_mfma_f32_16x16x32_bf16 v[12:15], v[136:139], v[156:159], v[12:15]
    ds_read_b64_tr_b16 v[136:137], v163 offset:16384
    ds_read_b64_tr_b16 v[138:139], v163 offset:17408
    s_waitcnt lgkmcnt(11)
    v_mfma_f32_16x16x32_bf16 v[16:19], v[140:143], v[152:155], v[16:19]
    v_mfma_f32_16x16x32_bf16 v[20:23], v[140:143], v[156:159], v[20:23]
    ds_read_b64_tr_b16 v[140:141], v163 offset:20480
    ds_read_b64_tr_b16 v[142:143], v163 offset:21504
    ds_read_b128 v[144:147], v167 offset:32768
    ds_read_b128 v[148:151], v167 offset:34816
    s_waitcnt lgkmcnt(13)
    v_mfma_f32_16x16x32_bf16 v[24:27], v[120:123], v[152:155], v[24:27]
    v_mfma_f32_16x16x32_bf16 v[28:31], v[120:123], v[156:159], v[28:31]
    ds_read_b64_tr_b16 v[120:121], v164 offset:16384
    ds_read_b64_tr_b16 v[122:123], v164 offset:17408
    s_waitcnt lgkmcnt(13)
    v_mfma_f32_16x16x32_bf16 v[32:35], v[124:127], v[152:155], v[32:35]
    v_mfma_f32_16x16x32_bf16 v[36:39], v[124:127], v[156:159], v[36:39]
    ds_read_b64_tr_b16 v[124:125], v164 offset:20480
    ds_read_b64_tr_b16 v[126:127], v164 offset:21504
    s_waitcnt lgkmcnt(13)
    v_mfma_f32_16x16x32_bf16 v[40:43], v[128:131], v[152:155], v[40:43]
    v_mfma_f32_16x16x32_bf16 v[44:47], v[128:131], v[156:159], v[44:47]
    ds_read_b64_tr_b16 v[128:129], v165 offset:16384
    ds_read_b64_tr_b16 v[130:131], v165 offset:17408
    s_waitcnt lgkmcnt(13)
    v_mfma_f32_16x16x32_bf16 v[48:51], v[132:135], v[152:155], v[48:51]
    v_mfma_f32_16x16x32_bf16 v[52:55], v[132:135], v[156:159], v[52:55]
    ds_read_b64_tr_b16 v[132:133], v165 offset:20480
    ds_read_b64_tr_b16 v[134:135], v165 offset:21504
    s_waitcnt lgkmcnt(12)
    v_mfma_f32_16x16x32_bf16 v[56:59], v[136:139], v[152:155], v[56:59]
    v_mfma_f32_16x16x32_bf16 v[60:63], v[136:139], v[156:159], v[60:63]
    ds_read_b64_tr_b16 v[136:137], v166 offset:16384
    ds_read_b64_tr_b16 v[138:139], v166 offset:17408
    ds_read_b64 v[6:7], v3 offset:120
    s_waitcnt lgkmcnt(13)
    v_mfma_f32_16x16x32_bf16 v[64:67], v[140:143], v[152:155], v[64:67]
    v_mfma_f32_16x16x32_bf16 v[68:71], v[140:143], v[156:159], v[68:71]
    ds_read_b64_tr_b16 v[140:141], v166 offset:20480
    ds_read_b64_tr_b16 v[142:143], v166 offset:21504
    s_waitcnt lgkmcnt(11)
    v_mfma_f32_16x16x32_bf16 v[72:75], v[120:123], v[152:155], v[72:75]
    v_mfma_f32_16x16x32_bf16 v[76:79], v[120:123], v[156:159], v[76:79]
    ds_read_b64_tr_b16 v[120:121], v160 offset:32768
    ds_read_b64_tr_b16 v[122:123], v160 offset:33792
    s_waitcnt lgkmcnt(11)
    v_mfma_f32_16x16x32_bf16 v[80:83], v[124:127], v[152:155], v[80:83]
    v_mfma_f32_16x16x32_bf16 v[84:87], v[124:127], v[156:159], v[84:87]
    ds_read_b64_tr_b16 v[124:125], v160 offset:36864
    ds_read_b64_tr_b16 v[126:127], v160 offset:37888
    s_waitcnt lgkmcnt(11)
    v_mfma_f32_16x16x32_bf16 v[88:91], v[128:131], v[152:155], v[88:91]
    v_mfma_f32_16x16x32_bf16 v[92:95], v[128:131], v[156:159], v[92:95]
    ds_read_b64_tr_b16 v[128:129], v161 offset:32768
    ds_read_b64_tr_b16 v[130:131], v161 offset:33792
    s_waitcnt lgkmcnt(11)
    v_mfma_f32_16x16x32_bf16 v[96:99], v[132:135], v[152:155], v[96:99]
    v_mfma_f32_16x16x32_bf16 v[100:103], v[132:135], v[156:159], v[100:103]
    ds_read_b64_tr_b16 v[132:133], v161 offset:36864
    ds_read_b64_tr_b16 v[134:135], v161 offset:37888
    s_waitcnt lgkmcnt(11)
    v_mfma_f32_16x16x32_bf16 v[104:107], v[136:139], v[152:155], v[104:107]
    v_mfma_f32_16x16x32_bf16 v[108:111], v[136:139], v[156:159], v[108:111]
    ds_read_b64_tr_b16 v[136:137], v162 offset:32768
    ds_read_b64_tr_b16 v[138:139], v162 offset:33792
    s_waitcnt lgkmcnt(10)
    v_mfma_f32_16x16x32_bf16 v[112:115], v[140:143], v[152:155], v[112:115]
    v_mfma_f32_16x16x32_bf16 v[116:119], v[140:143], v[156:159], v[116:119]
    ds_read_b64_tr_b16 v[140:141], v162 offset:36864
    ds_read_b64_tr_b16 v[142:143], v162 offset:37888
    s_mov_b64 exec, 4
    ds_add_u32 v4, v1
    s_mov_b64 exec, -1
    s_setprio 1
    v_readfirstlane_b32 s74, v6
    v_readfirstlane_b32 s75, v7
    s_setprio 0
    s_cmp_ge_u32 s74, 4
    s_cbranch_scc1 L_mega_kernel_rdy_129
    s_mov_b32 s57, 400000
L_mega_kernel_lp_130:
    ds_read_b32 v5, v3 offset:120
    s_waitcnt lgkmcnt(0)
    v_readfirstlane_b32 s74, v5
    s_sub_u32 s57, s57, 1
    s_cmp_ge_u32 s74, 4
    s_cbranch_scc1 L_mega_kernel_ok_131
    s_sleep 1
    s_cmp_lg_u32 s57, 0
    s_cbranch_scc1 L_mega_kernel_lp_130
L_mega_kernel_ok_131:
L_mega_kernel_rdy_129:
    s_cmp_ge_u32 s75, 4
    s_cbranch_scc1 L_mega_kernel_rdy_132
    s_mov_b32 s57, 400000
L_mega_kernel_lp_133:
    ds_read_b32 v5, v3 offset:124
    s_waitcnt lgkmcnt(0)
    v_readfirstlane_b32 s75, v5
    s_sub_u32 s57, s57, 1
    s_cmp_ge_u32 s75, 4
    s_cbranch_scc1 L_mega_kernel_ok_134
    s_sleep 1
    s_cmp_lg_u32 s57, 0
    s_cbranch_scc1 L_mega_kernel_lp_133
L_mega_kernel_ok_134:
L_mega_kernel_rdy_132:
    s_waitcnt lgkmcnt(11)
    v_mfma_f32_16x16x32_bf16 v[8:11], v[120:123], v[144:147], v[8:11]
    v_mfma_f32_16x16x32_bf16 v[12:15], v[120:123], v[148:151], v[12:15]
    ds_read_b64_tr_b16 v[120:121], v163 offset:32768
    ds_read_b64_tr_b16 v[122:123], v163 offset:33792
    s_waitcnt lgkmcnt(11)
    v_mfma_f32_16x16x32_bf16 v[16:19], v[124:127], v[144:147], v[16:19]
    v_mfma_f32_16x16x32_bf16 v[20:23], v[124:127], v[148:151], v[20:23]
    ds_read_b64_tr_b16 v[124:125], v163 offset:36864
    ds_read_b64_tr_b16 v[126:127], v163 offset:37888
    ds_read_b128 v[152:155], v0 offset:32768
    ds_read_b128 v[156:159], v0 offset:34816
    s_waitcnt lgkmcnt(13)
    v_mfma_f32_16x16x32_bf16 v[24:27], v[128:131], v[144:147], v[24:27]
    v_mfma_f32_16x16x32_bf16 v[28:31], v[128:131], v[148:151], v[28:31]
    ds_read_b64_tr_b16 v[128:129], v164 offset:32768
    ds_read_b64_tr_b16 v[130:131], v164 offset:33792
    s_waitcnt lgkmcnt(13)
    v_mfma_f32_16x16x32_bf16 v[32:35], v[132:135], v[144:147], v[32:35]
    v_mfma_f32_16x16x32_bf16 v[36:39], v[132:135], v[148:151], v[36:39]
    ds_read_b64_tr_b16 v[132:133], v164 offset:36864
    ds_read_b64_tr_b16 v[134:135], v164 offset:37888
    s_waitcnt lgkmcnt(13)
    v_mfma_f32_16x16x32_bf16 v[40:43], v[136:139], v[144:147], v[40:43]
    v_mfma_f32_16x16x32_bf16 v[44:47], v[136:139], v[148:151], v[44:47]
    ds_read_b64_tr_b16 v[136:137], v165 offset:32768
    ds_read_b64_tr_b16 v[138:139], v165 offset:33792
    s_waitcnt lgkmcnt(13)
    v_mfma_f32_16x16x32_bf16 v[48:51], v[140:143], v[144:147], v[48:51]
    v_mfma_f32_16x16x32_bf16 v[52:55], v[140:143], v[148:151], v[52:55]
    ds_read_b64_tr_b16 v[140:141], v165 offset:36864
    ds_read_b64_tr_b16 v[142:143], v165 offset:37888
    s_waitcnt lgkmcnt(12)
    v_mfma_f32_16x16x32_bf16 v[56:59], v[120:123], v[144:147], v[56:59]
    v_mfma_f32_16x16x32_bf16 v[60:63], v[120:123], v[148:151], v[60:63]
    ds_read_b64_tr_b16 v[120:121], v166 offset:32768
    ds_read_b64_tr_b16 v[122:123], v166 offset:33792
    ds_read_b64 v[6:7], v3 offset:112
    ds_read_b32 v5, v4 offset:64
    s_waitcnt lgkmcnt(14)
    v_mfma_f32_16x16x32_bf16 v[64:67], v[124:127], v[144:147], v[64:67]
    v_mfma_f32_16x16x32_bf16 v[68:71], v[124:127], v[148:151], v[68:71]
    ds_read_b64_tr_b16 v[124:125], v166 offset:36864
    ds_read_b64_tr_b16 v[126:127], v166 offset:37888
    s_waitcnt lgkmcnt(12)
    v_mfma_f32_16x16x32_bf16 v[72:75], v[128:131], v[144:147], v[72:75]
    v_mfma_f32_16x16x32_bf16 v[76:79], v[128:131], v[148:151], v[76:79]
    ds_read_b64_tr_b16 v[128:129], v160 offset:49152
    ds_read_b64_tr_b16 v[130:131], v160 offset:50176
    s_waitcnt lgkmcnt(12)
    v_mfma_f32_16x16x32_bf16 v[80:83], v[132:135], v[144:147], v[80:83]
    v_mfma_f32_16x16x32_bf16 v[84:87], v[132:135], v[148:151], v[84:87]
    ds_read_b64_tr_b16 v[132:133], v160 offset:53248
    ds_read_b64_tr_b16 v[134:135], v160 offset:54272
    s_waitcnt lgkmcnt(12)
    v_mfma_f32_16x16x32_bf16 v[88:91], v[136:139], v[144:147], v[88:91]
    v_mfma_f32_16x16x32_bf16 v[92:95], v[136:139], v[148:151], v[92:95]
    ds_read_b64_tr_b16 v[136:137], v161 offset:49152
    ds_read_b64_tr_b16 v[138:139], v161 offset:50176
    s_waitcnt lgkmcnt(12)
    v_mfma_f32_16x16x32_bf16 v[96:99], v[140:143], v[144:147], v[96:99]
    v_mfma_f32_16x16x32_bf16 v[100:103], v[140:143], v[148:151], v[100:103]
    ds_read_b64_tr_b16 v[140:141], v161 offset:53248
    ds_read_b64_tr_b16 v[142:143], v161 offset:54272
    s_waitcnt lgkmcnt(12)
    v_mfma_f32_16x16x32_bf16 v[104:107], v[120:123], v[144:147], v[104:107]
    v_mfma_f32_16x16x32_bf16 v[108:111], v[120:123], v[148:151], v[108:111]
    ds_read_b64_tr_b16 v[120:121], v162 offset:49152
    ds_read_b64_tr_b16 v[122:123], v162 offset:50176
    s_waitcnt lgkmcnt(10)
    v_mfma_f32_16x16x32_bf16 v[112:115], v[124:127], v[144:147], v[112:115]
    v_mfma_f32_16x16x32_bf16 v[116:119], v[124:127], v[148:151], v[116:119]
    ds_read_b64_tr_b16 v[124:125], v162 offset:53248
    ds_read_b64_tr_b16 v[126:127], v162 offset:54272
    s_mov_b64 exec, 4
    ds_add_u32 v4, v1
    s_mov_b64 exec, -1
    s_setprio 1
    v_readfirstlane_b32 s72, v6
    v_readfirstlane_b32 s73, v7
    v_readfirstlane_b32 s29, v5
    s_setprio 0
    s_cmp_ge_u32 s29, 5
    s_cbranch_scc1 L_mega_kernel_rdy_135
    s_mov_b32 s57, 400000
L_mega_kernel_lp_136:
    ds_read_b32 v5, v4 offset:64
    s_waitcnt lgkmcnt(0)
    v_readfirstlane_b32 s29, v5
    s_sub_u32 s57, s57, 1
    s_cmp_ge_u32 s29, 5
    s_cbranch_scc1 L_mega_kernel_ok_137
    s_sleep 1
    s_cmp_lg_u32 s57, 0
    s_cbranch_scc1 L_mega_kernel_lp_136
L_mega_kernel_ok_137:
L_mega_kernel_rdy_135:
    s_cmp_ge_u32 s72, 5
    s_cbranch_scc1 L_mega_kernel_rdy_138
    s_mov_b32 s57, 400000
L_mega_kernel_lp_139:
    ds_read_b32 v5, v3 offset:112
    s_waitcnt lgkmcnt(0)
    v_readfirstlane_b32 s72, v5
    s_sub_u32 s57, s57, 1
    s_cmp_ge_u32 s72, 5
    s_cbranch_scc1 L_mega_kernel_ok_140
    s_sleep 1
    s_cmp_lg_u32 s57, 0
    s_cbranch_scc1 L_mega_kernel_lp_139
L_mega_kernel_ok_140:
L_mega_kernel_rdy_138:
    s_cmp_ge_u32 s73, 5
    s_cbranch_scc1 L_mega_kernel_rdy_141
    s_mov_b32 s57, 400000
L_mega_kernel_lp_142:
    ds_read_b32 v5, v3 offset:116
    s_waitcnt lgkmcnt(0)
    v_readfirstlane_b32 s73, v5
    s_sub_u32 s57, s57, 1
    s_cmp_ge_u32 s73, 5
    s_cbranch_scc1 L_mega_kernel_ok_143
    s_sleep 1
    s_cmp_lg_u32 s57, 0
    s_cbranch_scc1 L_mega_kernel_lp_142
L_mega_kernel_ok_143:
L_mega_kernel_rdy_141:
    s_waitcnt lgkmcnt(11)
    v_mfma_f32_16x16x32_bf16 v[8:11], v[128:131], v[152:155], v[8:11]
    v_mfma_f32_16x16x32_bf16 v[12:15], v[128:131], v[156:159], v[12:15]
    ds_read_b64_tr_b16 v[128:129], v163 offset:49152
    ds_read_b64_tr_b16 v[130:131], v163 offset:50176
    s_waitcnt lgkmcnt(11)
    v_mfma_f32_16x16x32_bf16 v[16:19], v[132:135], v[152:155], v[16:19]
    v_mfma_f32_16x16x32_bf16 v[20:23], v[132:135], v[156:159], v[20:23]
    ds_read_b64_tr_b16 v[132:133], v163 offset:53248
    ds_read_b64_tr_b16 v[134:135], v163 offset:54272
    ds_read_b128 v[144:147], v167 offset:0
    ds_read_b128 v[148:151], v167 offset:2048
    s_waitcnt lgkmcnt(13)
    v_mfma_f32_16x16x32_bf16 v[24:27], v[136:139], v[152:155], v[24:27]
    v_mfma_f32_16x16x32_bf16 v[28:31], v[136:139], v[156:159], v[28:31]
    ds_read_b64_tr_b16 v[136:137], v164 offset:49152
    ds_read_b64_tr_b16 v[138:139], v164 offset:50176
    s_waitcnt lgkmcnt(13)
    v_mfma_f32_16x16x32_bf16 v[32:35], v[140:143], v[152:155], v[32:35]
    v_mfma_f32_16x16x32_bf16 v[36:39], v[140:143], v[156:159], v[36:39]
    ds_read_b64_tr_b16 v[140:141], v164 offset:53248
    ds_read_b64_tr_b16 v[142:143], v164 offset:54272
    s_waitcnt lgkmcnt(13)
    v_mfma_f32_16x16x32_bf16 v[40:43], v[120:123], v[152:155], v[40:43]
    v_mfma_f32_16x16x32_bf16 v[44:47], v[120:123], v[156:159], v[44:47]
    ds_read_b64_tr_b16 v[120:121], v165 offset:49152
    ds_read_b64_tr_b16 v[122:123], v165 offset:50176
    s_waitcnt lgkmcnt(13)
    v_mfma_f32_16x16x32_bf16 v[48:51], v[124:127], v[152:155], v[48:51]
    v_mfma_f32_16x16x32_bf16 v[52:55], v[124:127], v[156:159], v[52:55]
    ds_read_b64_tr_b16 v[124:125], v165 offset:53248
    ds_read_b64_tr_b16 v[126:127], v165 offset:54272
    s_waitcnt lgkmcnt(12)
    v_mfma_f32_16x16x32_bf16 v[56:59], v[128:131], v[152:155], v[56:59]
    v_mfma_f32_16x16x32_bf16 v[60:63], v[128:131], v[156:159], v[60:63]
    ds_read_b64_tr_b16 v[128:129], v166 offset:49152
    ds_read_b64_tr_b16 v[130:131], v166 offset:50176
    ds_read_b64 v[6:7], v3 offset:120
    s_waitcnt lgkmcnt(13)
    v_mfma_f32_16x16x32_bf16 v[64:67], v[132:135], v[152:155], v[64:67]
    v_mfma_f32_16x16x32_bf16 v[68:71], v[132:135], v[156:159], v[68:71]
    ds_read_b64_tr_b16 v[132:133], v166 offset:53248
    ds_read_b64_tr_b16 v[134:135], v166 offset:54272
    s_waitcnt lgkmcnt(11)
    v_mfma_f32_16x16x32_bf16 v[72:75], v[136:139], v[152:155], v[72:75]
    v_mfma_f32_16x16x32_bf16 v[76:79], v[136:139], v[156:159], v[76:79]
    ds_read_b64_tr_b16 v[136:137], v160 offset:0
    ds_read_b64_tr_b16 v[138:139], v160 offset:1024
    s_waitcnt lgkmcnt(11)
    v_mfma_f32_16x16x32_bf16 v[80:83], v[140:143], v[152:155], v[80:83]
    v_mfma_f32_16x16x32_bf16 v[84:87], v[140:143], v[156:159], v[84:87]
    ds_read_b64_tr_b16 v[140:141], v160 offset:4096
    ds_read_b64_tr_b16 v[142:143], v160 offset:5120
    s_waitcnt lgkmcnt(11)
    v_mfma_f32_16x16x32_bf16 v[88:91], v[120:123], v[152:155], v[88:91]
    v_mfma_f32_16x16x32_bf16 v[92:95], v[120:123], v[156:159], v[92:95]
    ds_read_b64_tr_b16 v[120:121], v161 offset:0
    ds_read_b64_tr_b16 v[122:123], v161 offset:1024
    s_waitcnt lgkmcnt(11)
    v_mfma_f32_16x16x32_bf16 v[96:99], v[124:127], v[152:155], v[96:99]
    v_mfma_f32_16x16x32_bf16 v[100:103], v[124:127], v[156:159], v[100:103]
    ds_read_b64_tr_b16 v[124:125], v161 offset:4096
    ds_read_b64_tr_b16 v[126:127], v161 offset:5120
    s_waitcnt lgkmcnt(11)
    v_mfma_f32_16x16x32_bf16 v[104:107], v[128:131], v[152:155], v[104:107]
    v_mfma_f32_16x16x32_bf16 v[108:111], v[128:131], v[156:159], v[108:111]
    ds_read_b64_tr_b16 v[128:129], v162 offset:0
    ds_read_b64_tr_b16 v[130:131], v162 offset:1024
    s_waitcnt lgkmcnt(10)
    v_mfma_f32_16x16x32_bf16 v[112:115], v[132:135], v[152:155], v[112:115]
    v_mfma_f32_16x16x32_bf16 v[116:119], v[132:135], v[156:159], v[116:119]
    ds_read_b64_tr_b16 v[132:133], v162 offset:4096
    ds_read_b64_tr_b16 v[134:135], v162 offset:5120
    s_mov_b64 exec, 4
    ds_add_u32 v4, v1
    s_mov_b64 exec, -1
    s_setprio 1
    v_readfirstlane_b32 s74, v6
    v_readfirstlane_b32 s75, v7
    s_setprio 0
    s_cmp_ge_u32 s74, 5
    s_cbranch_scc1 L_mega_kernel_rdy_144
    s_mov_b32 s57, 400000
L_mega_kernel_lp_145:
    ds_read_b32 v5, v3 offset:120
    s_waitcnt lgkmcnt(0)
    v_readfirstlane_b32 s74, v5
    s_sub_u32 s57, s57, 1
    s_cmp_ge_u32 s74, 5
    s_cbranch_scc1 L_mega_kernel_ok_146
    s_sleep 1
    s_cmp_lg_u32 s57, 0
    s_cbranch_scc1 L_mega_kernel_lp_145
L_mega_kernel_ok_146:
L_mega_kernel_rdy_144:
    s_cmp_ge_u32 s75, 5
    s_cbranch_scc1 L_mega_kernel_rdy_147
    s_mov_b32 s57, 400000
L_mega_kernel_lp_148:
    ds_read_b32 v5, v3 offset:124
    s_waitcnt lgkmcnt(0)
    v_readfirstlane_b32 s75, v5
    s_sub_u32 s57, s57, 1
    s_cmp_ge_u32 s75, 5
    s_cbranch_scc1 L_mega_kernel_ok_149
    s_sleep 1
    s_cmp_lg_u32 s57, 0
    s_cbranch_scc1 L_mega_kernel_lp_148
L_mega_kernel_ok_149:
L_mega_kernel_rdy_147:
    s_waitcnt lgkmcnt(11)
    v_mfma_f32_16x16x32_bf16 v[8:11], v[136:139], v[144:147], v[8:11]
    v_mfma_f32_16x16x32_bf16 v[12:15], v[136:139], v[148:151], v[12:15]
    ds_read_b64_tr_b16 v[136:137], v163 offset:0
    ds_read_b64_tr_b16 v[138:139], v163 offset:1024
    s_waitcnt lgkmcnt(11)
    v_mfma_f32_16x16x32_bf16 v[16:19], v[140:143], v[144:147], v[16:19]
    v_mfma_f32_16x16x32_bf16 v[20:23], v[140:143], v[148:151], v[20:23]
    ds_read_b64_tr_b16 v[140:141], v163 offset:4096
    ds_read_b64_tr_b16 v[142:143], v163 offset:5120
    ds_read_b128 v[152:155], v0 offset:0
    ds_read_b128 v[156:159], v0 offset:2048
    s_waitcnt lgkmcnt(13)
    v_mfma_f32_16x16x32_bf16 v[24:27], v[120:123], v[144:147], v[24:27]
    v_mfma_f32_16x16x32_bf16 v[28:31], v[120:123], v[148:151], v[28:31]
    ds_read_b64_tr_b16 v[120:121], v164 offset:0
    ds_read_b64_tr_b16 v[122:123], v164 offset:1024
    s_waitcnt lgkmcnt(13)
    v_mfma_f32_16x16x32_bf16 v[32:35], v[124:127], v[144:147], v[32:35]
    v_mfma_f32_16x16x32_bf16 v[36:39], v[124:127], v[148:151], v[36:39]
    ds_read_b64_tr_b16 v[124:125], v164 offset:4096
    ds_read_b64_tr_b16 v[126:127], v164 offset:5120
    s_waitcnt lgkmcnt(13)
    v_mfma_f32_16x16x32_bf16 v[40:43], v[128:131], v[144:147], v[40:43]
    v_mfma_f32_16x16x32_bf16 v[44:47], v[128:131], v[148:151], v[44:47]
    ds_read_b64_tr_b16 v[128:129], v165 offset:0
    ds_read_b64_tr_b16 v[130:131], v165 offset:1024
    s_waitcnt lgkmcnt(13)
    v_mfma_f32_16x16x32_bf16 v[48:51], v[132:135], v[144:147], v[48:51]
    v_mfma_f32_16x16x32_bf16 v[52:55], v[132:135], v[148:151], v[52:55]
    ds_read_b64_tr_b16 v[132:133], v165 offset:4096
    ds_read_b64_tr_b16 v[134:135], v165 offset:5120
    s_waitcnt lgkmcnt(12)
    v_mfma_f32_16x16x32_bf16 v[56:59], v[136:139], v[144:147], v[56:59]
    v_mfma_f32_16x16x32_bf16 v[60:63], v[136:139], v[148:151], v[60:63]
    ds_read_b64_tr_b16 v[136:137], v166 offset:0
    ds_read_b64_tr_b16 v[138:139], v166 offset:1024
    ds_read_b64 v[6:7], v3 offset:112
    ds_read_b32 v5, v4 offset:64
    s_waitcnt lgkmcnt(14)
    v_mfma_f32_16x16x32_bf16 v[64:67], v[140:143], v[144:147], v[64:67]
    v_mfma_f32_16x16x32_bf16 v[68:71], v[140:143], v[148:151], v[68:71]
    ds_read_b64_tr_b16 v[140:141], v166 offset:4096
    ds_read_b64_tr_b16 v[142:143], v166 offset:5120
    s_waitcnt lgkmcnt(12)
    v_mfma_f32_16x16x32_bf16 v[72:75], v[120:123], v[144:147], v[72:75]
    v_mfma_f32_16x16x32_bf16 v[76:79], v[120:123], v[148:151], v[76:79]
    ds_read_b64_tr_b16 v[120:121], v160 offset:16384
    ds_read_b64_tr_b16 v[122:123], v160 offset:17408
    s_waitcnt lgkmcnt(12)
    v_mfma_f32_16x16x32_bf16 v[80:83], v[124:127], v[144:147], v[80:83]
    v_mfma_f32_16x16x32_bf16 v[84:87], v[124:127], v[148:151], v[84:87]
    ds_read_b64_tr_b16 v[124:125], v160 offset:20480
    ds_read_b64_tr_b16 v[126:127], v160 offset:21504
    s_waitcnt lgkmcnt(12)
    v_mfma_f32_16x16x32_bf16 v[88:91], v[128:131], v[144:147], v[88:91]
    v_mfma_f32_16x16x32_bf16 v[92:95], v[128:131], v[148:151], v[92:95]
    ds_read_b64_tr_b16 v[128:129], v161 offset:16384
    ds_read_b64_tr_b16 v[130:131], v161 offset:17408
    s_waitcnt lgkmcnt(12)
    v_mfma_f32_16x16x32_bf16 v[96:99], v[132:135], v[144:147], v[96:99]
    v_mfma_f32_16x16x32_bf16 v[100:103], v[132:135], v[148:151], v[100:103]
    ds_read_b64_tr_b16 v[132:133], v161 offset:20480
    ds_read_b64_tr_b16 v[134:135], v161 offset:21504
    s_waitcnt lgkmcnt(12)
    v_mfma_f32_16x16x32_bf16 v[104:107], v[136:139], v[144:147], v[104:107]
    v_mfma_f32_16x16x32_bf16 v[108:111], v[136:139], v[148:151], v[108:111]
    ds_read_b64_tr_b16 v[136:137], v162 offset:16384
    ds_read_b64_tr_b16 v[138:139], v162 offset:17408
    s_waitcnt lgkmcnt(10)
    v_mfma_f32_16x16x32_bf16 v[112:115], v[140:143], v[144:147], v[112:115]
    v_mfma_f32_16x16x32_bf16 v[116:119], v[140:143], v[148:151], v[116:119]
    ds_read_b64_tr_b16 v[140:141], v162 offset:20480
    ds_read_b64_tr_b16 v[142:143], v162 offset:21504
    s_mov_b64 exec, 4
    ds_add_u32 v4, v1
    s_mov_b64 exec, -1
    s_setprio 1
    v_readfirstlane_b32 s72, v6
    v_readfirstlane_b32 s73, v7
    v_readfirstlane_b32 s29, v5
    s_setprio 0
    s_cmp_ge_u32 s29, 6
    s_cbranch_scc1 L_mega_kernel_rdy_150
    s_mov_b32 s57, 400000
L_mega_kernel_lp_151:
    ds_read_b32 v5, v4 offset:64
    s_waitcnt lgkmcnt(0)
    v_readfirstlane_b32 s29, v5
    s_sub_u32 s57, s57, 1
    s_cmp_ge_u32 s29, 6
    s_cbranch_scc1 L_mega_kernel_ok_152
    s_sleep 1
    s_cmp_lg_u32 s57, 0
    s_cbranch_scc1 L_mega_kernel_lp_151
L_mega_kernel_ok_152:
L_mega_kernel_rdy_150:
    s_cmp_ge_u32 s72, 6
    s_cbranch_scc1 L_mega_kernel_rdy_153
    s_mov_b32 s57, 400000
L_mega_kernel_lp_154:
    ds_read_b32 v5, v3 offset:112
    s_waitcnt lgkmcnt(0)
    v_readfirstlane_b32 s72, v5
    s_sub_u32 s57, s57, 1
    s_cmp_ge_u32 s72, 6
    s_cbranch_scc1 L_mega_kernel_ok_155
    s_sleep 1
    s_cmp_lg_u32 s57, 0
    s_cbranch_scc1 L_mega_kernel_lp_154
L_mega_kernel_ok_155:
L_mega_kernel_rdy_153:
    s_cmp_ge_u32 s73, 6
    s_cbranch_scc1 L_mega_kernel_rdy_156
    s_mov_b32 s57, 400000
L_mega_kernel_lp_157:
    ds_read_b32 v5, v3 offset:116
    s_waitcnt lgkmcnt(0)
    v_readfirstlane_b32 s73, v5
    s_sub_u32 s57, s57, 1
    s_cmp_ge_u32 s73, 6
    s_cbranch_scc1 L_mega_kernel_ok_158
    s_sleep 1
    s_cmp_lg_u32 s57, 0
    s_cbranch_scc1 L_mega_kernel_lp_157
L_mega_kernel_ok_158:
L_mega_kernel_rdy_156:
    s_waitcnt lgkmcnt(11)
    v_mfma_f32_16x16x32_bf16 v[8:11], v[120:123], v[152:155], v[8:11]
    v_mfma_f32_16x16x32_bf16 v[12:15], v[120:123], v[156:159], v[12:15]
    ds_read_b64_tr_b16 v[120:121], v163 offset:16384
    ds_read_b64_tr_b16 v[122:123], v163 offset:17408
    s_waitcnt lgkmcnt(11)
    v_mfma_f32_16x16x32_bf16 v[16:19], v[124:127], v[152:155], v[16:19]
    v_mfma_f32_16x16x32_bf16 v[20:23], v[124:127], v[156:159], v[20:23]
    ds_read_b64_tr_b16 v[124:125], v163 offset:20480
    ds_read_b64_tr_b16 v[126:127], v163 offset:21504
    ds_read_b128 v[144:147], v167 offset:16384
    ds_read_b128 v[148:151], v167 offset:18432
    s_waitcnt lgkmcnt(13)
    v_mfma_f32_16x16x32_bf16 v[24:27], v[128:131], v[152:155], v[24:27]
    v_mfma_f32_16x16x32_bf16 v[28:31], v[128:131], v[156:159], v[28:31]
    ds_read_b64_tr_b16 v[128:129], v164 offset:16384
    ds_read_b64_tr_b16 v[130:131], v164 offset:17408
    s_waitcnt lgkmcnt(13)
    v_mfma_f32_16x16x32_bf16 v[32:35], v[132:135], v[152:155], v[32:35]
    v_mfma_f32_16x16x32_bf16 v[36:39], v[132:135], v[156:159], v[36:39]
    ds_read_b64_tr_b16 v[132:133], v164 offset:20480
    ds_read_b64_tr_b16 v[134:135], v164 offset:21504
    s_waitcnt lgkmcnt(13)
    v_mfma_f32_16x16x32_bf16 v[40:43], v[136:139], v[152:155], v[40:43]
    v_mfma_f32_16x16x32_bf16 v[44:47], v[136:139], v[156:159], v[44:47]
    ds_read_b64_tr_b16 v[136:137], v165 offset:16384
    ds_read_b64_tr_b16 v[138:139], v165 offset:17408
    s_waitcnt lgkmcnt(13)
    v_mfma_f32_16x16x32_bf16 v[48:51], v[140:143], v[152:155], v[48:51]
    v_mfma_f32_16x16x32_bf16 v[52:55], v[140:143], v[156:159], v[52:55]
    ds_read_b64_tr_b16 v[140:141], v165 offset:20480
    ds_read_b64_tr_b16 v[142:143], v165 offset:21504
    s_waitcnt lgkmcnt(12)
    v_mfma_f32_16x16x32_bf16 v[56:59], v[120:123], v[152:155], v[56:59]
    v_mfma_f32_16x16x32_bf16 v[60:63], v[120:123], v[156:159], v[60:63]
    ds_read_b64_tr_b16 v[120:121], v166 offset:16384
    ds_read_b64_tr_b16 v[122:123], v166 offset:17408
    ds_read_b64 v[6:7], v3 offset:120
    s_waitcnt lgkmcnt(13)
    v_mfma_f32_16x16x32_bf16 v[64:67], v[124:127], v[152:155], v[64:67]
    v_mfma_f32_16x16x32_bf16 v[68:71], v[124:127], v[156:159], v[68:71]
    ds_read_b64_tr_b16 v[124:125], v166 offset:20480
    ds_read_b64_tr_b16 v[126:127], v166 offset:21504
    s_waitcnt lgkmcnt(11)
    v_mfma_f32_16x16x32_bf16 v[72:75], v[128:131], v[152:155], v[72:75]
    v_mfma_f32_16x16x32_bf16 v[76:79], v[128:131], v[156:159], v[76:79]
    ds_read_b64_tr_b16 v[128:129], v160 offset:32768
    ds_read_b64_tr_b16 v[130:131], v160 offset:33792
    s_waitcnt lgkmcnt(11)
    v_mfma_f32_16x16x32_bf16 v[80:83], v[132:135], v[152:155], v[80:83]
    v_mfma_f32_16x16x32_bf16 v[84:87], v[132:135], v[156:159], v[84:87]
    ds_read_b64_tr_b16 v[132:133], v160 offset:36864
    ds_read_b64_tr_b16 v[134:135], v160 offset:37888
    s_waitcnt lgkmcnt(11)
    v_mfma_f32_16x16x32_bf16 v[88:91], v[136:139], v[152:155], v[88:91]
    v_mfma_f32_16x16x32_bf16 v[92:95], v[136:139], v[156:159], v[92:95]
    ds_read_b64_tr_b16 v[136:137], v161 offset:32768
    ds_read_b64_tr_b16 v[138:139], v161 offset:33792
    s_waitcnt lgkmcnt(11)
    v_mfma_f32_16x16x32_bf16 v[96:99], v[140:143], v[152:155], v[96:99]
    v_mfma_f32_16x16x32_bf16 v[100:103], v[140:143], v[156:159], v[100:103]
    ds_read_b64_tr_b16 v[140:141], v161 offset:36864
    ds_read_b64_tr_b16 v[142:143], v161 offset:37888
    s_waitcnt lgkmcnt(11)
    v_mfma_f32_16x16x32_bf16 v[104:107], v[120:123], v[152:155], v[104:107]
    v_mfma_f32_16x16x32_bf16 v[108:111], v[120:123], v[156:159], v[108:111]
    ds_read_b64_tr_b16 v[120:121], v162 offset:32768
    ds_read_b64_tr_b16 v[122:123], v162 offset:33792
    s_waitcnt lgkmcnt(10)
    v_mfma_f32_16x16x32_bf16 v[112:115], v[124:127], v[152:155], v[112:115]
    v_mfma_f32_16x16x32_bf16 v[116:119], v[124:127], v[156:159], v[116:119]
    ds_read_b64_tr_b16 v[124:125], v162 offset:36864
    ds_read_b64_tr_b16 v[126:127], v162 offset:37888
    s_mov_b64 exec, 4
    ds_add_u32 v4, v1
    s_mov_b64 exec, -1
    s_setprio 1
    v_readfirstlane_b32 s74, v6
    v_readfirstlane_b32 s75, v7
    s_setprio 0
    s_cmp_ge_u32 s74, 6
    s_cbranch_scc1 L_mega_kernel_rdy_159
    s_mov_b32 s57, 400000
L_mega_kernel_lp_160:
    ds_read_b32 v5, v3 offset:120
    s_waitcnt lgkmcnt(0)
    v_readfirstlane_b32 s74, v5
    s_sub_u32 s57, s57, 1
    s_cmp_ge_u32 s74, 6
    s_cbranch_scc1 L_mega_kernel_ok_161
    s_sleep 1
    s_cmp_lg_u32 s57, 0
    s_cbranch_scc1 L_mega_kernel_lp_160
L_mega_kernel_ok_161:
L_mega_kernel_rdy_159:
    s_cmp_ge_u32 s75, 6
    s_cbranch_scc1 L_mega_kernel_rdy_162
    s_mov_b32 s57, 400000
L_mega_kernel_lp_163:
    ds_read_b32 v5, v3 offset:124
    s_waitcnt lgkmcnt(0)
    v_readfirstlane_b32 s75, v5
    s_sub_u32 s57, s57, 1
    s_cmp_ge_u32 s75, 6
    s_cbranch_scc1 L_mega_kernel_ok_164
    s_sleep 1
    s_cmp_lg_u32 s57, 0
    s_cbranch_scc1 L_mega_kernel_lp_163
L_mega_kernel_ok_164:
L_mega_kernel_rdy_162:
    s_waitcnt lgkmcnt(11)
    v_mfma_f32_16x16x32_bf16 v[8:11], v[128:131], v[144:147], v[8:11]
    v_mfma_f32_16x16x32_bf16 v[12:15], v[128:131], v[148:151], v[12:15]
    ds_read_b64_tr_b16 v[128:129], v163 offset:32768
    ds_read_b64_tr_b16 v[130:131], v163 offset:33792
    s_waitcnt lgkmcnt(11)
    v_mfma_f32_16x16x32_bf16 v[16:19], v[132:135], v[144:147], v[16:19]
    v_mfma_f32_16x16x32_bf16 v[20:23], v[132:135], v[148:151], v[20:23]
    ds_read_b64_tr_b16 v[132:133], v163 offset:36864
    ds_read_b64_tr_b16 v[134:135], v163 offset:37888
    ds_read_b128 v[152:155], v0 offset:16384
    ds_read_b128 v[156:159], v0 offset:18432
    s_waitcnt lgkmcnt(13)
    v_mfma_f32_16x16x32_bf16 v[24:27], v[136:139], v[144:147], v[24:27]
    v_mfma_f32_16x16x32_bf16 v[28:31], v[136:139], v[148:151], v[28:31]
    ds_read_b64_tr_b16 v[136:137], v164 offset:32768
    ds_read_b64_tr_b16 v[138:139], v164 offset:33792
    s_waitcnt lgkmcnt(13)
    v_mfma_f32_16x16x32_bf16 v[32:35], v[140:143], v[144:147], v[32:35]
    v_mfma_f32_16x16x32_bf16 v[36:39], v[140:143], v[148:151], v[36:39]
    ds_read_b64_tr_b16 v[140:141], v164 offset:36864
    ds_read_b64_tr_b16 v[142:143], v164 offset:37888
    s_waitcnt lgkmcnt(13)
    v_mfma_f32_16x16x32_bf16 v[40:43], v[120:123], v[144:147], v[40:43]
    v_mfma_f32_16x16x32_bf16 v[44:47], v[120:123], v[148:151], v[44:47]
    ds_read_b64_tr_b16 v[120:121], v165 offset:32768
    ds_read_b64_tr_b16 v[122:123], v165 offset:33792
    s_waitcnt lgkmcnt(13)
    v_mfma_f32_16x16x32_bf16 v[48:51], v[124:127], v[144:147], v[48:51]
    v_mfma_f32_16x16x32_bf16 v[52:55], v[124:127], v[148:151], v[52:55]
    ds_read_b64_tr_b16 v[124:125], v165 offset:36864
    ds_read_b64_tr_b16 v[126:127], v165 offset:37888
    s_waitcnt lgkmcnt(12)
    v_mfma_f32_16x16x32_bf16 v[56:59], v[128:131], v[144:147], v[56:59]
    v_mfma_f32_16x16x32_bf16 v[60:63], v[128:131], v[148:151], v[60:63]
    ds_read_b64_tr_b16 v[128:129], v166 offset:32768
    ds_read_b64_tr_b16 v[130:131], v166 offset:33792
    ds_read_b64 v[6:7], v3 offset:112
    ds_read_b32 v5, v4 offset:64
    s_waitcnt lgkmcnt(14)
    v_mfma_f32_16x16x32_bf16 v[64:67], v[132:135], v[144:147], v[64:67]
    v_mfma_f32_16x16x32_bf16 v[68:71], v[132:135], v[148:151], v[68:71]
    ds_read_b64_tr_b16 v[132:133], v166 offset:36864
    ds_read_b64_tr_b16 v[134:135], v166 offset:37888
    s_waitcnt lgkmcnt(12)
    v_mfma_f32_16x16x32_bf16 v[72:75], v[136:139], v[144:147], v[72:75]
    v_mfma_f32_16x16x32_bf16 v[76:79], v[136:139], v[148:151], v[76:79]
    ds_read_b64_tr_b16 v[136:137], v160 offset:49152
    ds_read_b64_tr_b16 v[138:139], v160 offset:50176
    s_waitcnt lgkmcnt(12)
    v_mfma_f32_16x16x32_bf16 v[80:83], v[140:143], v[144:147], v[80:83]
    v_mfma_f32_16x16x32_bf16 v[84:87], v[140:143], v[148:151], v[84:87]
    ds_read_b64_tr_b16 v[140:141], v160 offset:53248
    ds_read_b64_tr_b16 v[142:143], v160 offset:54272
    s_waitcnt lgkmcnt(12)
    v_mfma_f32_16x16x32_bf16 v[88:91], v[120:123], v[144:147], v[88:91]
    v_mfma_f32_16x16x32_bf16 v[92:95], v[120:123], v[148:151], v[92:95]
    ds_read_b64_tr_b16 v[120:121], v161 offset:49152
    ds_read_b64_tr_b16 v[122:123], v161 offset:50176
    s_waitcnt lgkmcnt(12)
    v_mfma_f32_16x16x32_bf16 v[96:99], v[124:127], v[144:147], v[96:99]
    v_mfma_f32_16x16x32_bf16 v[100:103], v[124:127], v[148:151], v[100:103]
    ds_read_b64_tr_b16 v[124:125], v161 offset:53248
    ds_read_b64_tr_b16 v[126:127], v161 offset:54272
    s_waitcnt lgkmcnt(12)
    v_mfma_f32_16x16x32_bf16 v[104:107], v[128:131], v[144:147], v[104:107]
    v_mfma_f32_16x16x32_bf16 v[108:111], v[128:131], v[148:151], v[108:111]
    ds_read_b64_tr_b16 v[128:129], v162 offset:49152
    ds_read_b64_tr_b16 v[130:131], v162 offset:50176
    s_waitcnt lgkmcnt(10)
    v_mfma_f32_16x16x32_bf16 v[112:115], v[132:135], v[144:147], v[112:115]
    v_mfma_f32_16x16x32_bf16 v[116:119], v[132:135], v[148:151], v[116:119]
    ds_read_b64_tr_b16 v[132:133], v162 offset:53248
    ds_read_b64_tr_b16 v[134:135], v162 offset:54272
    s_mov_b64 exec, 4
    ds_add_u32 v4, v1
    s_mov_b64 exec, -1
    s_setprio 1
    v_readfirstlane_b32 s72, v6
    v_readfirstlane_b32 s73, v7
    v_readfirstlane_b32 s29, v5
    s_setprio 0
    s_cmp_ge_u32 s29, 7
    s_cbranch_scc1 L_mega_kernel_rdy_165
    s_mov_b32 s57, 400000
L_mega_kernel_lp_166:
    ds_read_b32 v5, v4 offset:64
    s_waitcnt lgkmcnt(0)
    v_readfirstlane_b32 s29, v5
    s_sub_u32 s57, s57, 1
    s_cmp_ge_u32 s29, 7
    s_cbranch_scc1 L_mega_kernel_ok_167
    s_sleep 1
    s_cmp_lg_u32 s57, 0
    s_cbranch_scc1 L_mega_kernel_lp_166
L_mega_kernel_ok_167:
L_mega_kernel_rdy_165:
    s_cmp_ge_u32 s72, 7
    s_cbranch_scc1 L_mega_kernel_rdy_168
    s_mov_b32 s57, 400000
L_mega_kernel_lp_169:
    ds_read_b32 v5, v3 offset:112
    s_waitcnt lgkmcnt(0)
    v_readfirstlane_b32 s72, v5
    s_sub_u32 s57, s57, 1
    s_cmp_ge_u32 s72, 7
    s_cbranch_scc1 L_mega_kernel_ok_170
    s_sleep 1
    s_cmp_lg_u32 s57, 0
    s_cbranch_scc1 L_mega_kernel_lp_169
L_mega_kernel_ok_170:
L_mega_kernel_rdy_168:
    s_cmp_ge_u32 s73, 7
    s_cbranch_scc1 L_mega_kernel_rdy_171
    s_mov_b32 s57, 400000
L_mega_kernel_lp_172:
    ds_read_b32 v5, v3 offset:116
    s_waitcnt lgkmcnt(0)
    v_readfirstlane_b32 s73, v5
    s_sub_u32 s57, s57, 1
    s_cmp_ge_u32 s73, 7
    s_cbranch_scc1 L_mega_kernel_ok_173
    s_sleep 1
    s_cmp_lg_u32 s57, 0
    s_cbranch_scc1 L_mega_kernel_lp_172
L_mega_kernel_ok_173:
L_mega_kernel_rdy_171:
    s_waitcnt lgkmcnt(11)
    v_mfma_f32_16x16x32_bf16 v[8:11], v[136:139], v[152:155], v[8:11]
    v_mfma_f32_16x16x32_bf16 v[12:15], v[136:139], v[156:159], v[12:15]
    ds_read_b64_tr_b16 v[136:137], v163 offset:49152
    ds_read_b64_tr_b16 v[138:139], v163 offset:50176
    s_waitcnt lgkmcnt(11)
    v_mfma_f32_16x16x32_bf16 v[16:19], v[140:143], v[152:155], v[16:19]
    v_mfma_f32_16x16x32_bf16 v[20:23], v[140:143], v[156:159], v[20:23]
    ds_read_b64_tr_b16 v[140:141], v163 offset:53248
    ds_read_b64_tr_b16 v[142:143], v163 offset:54272
    ds_read_b128 v[144:147], v167 offset:32768
    ds_read_b128 v[148:151], v167 offset:34816
    s_waitcnt lgkmcnt(13)
    v_mfma_f32_16x16x32_bf16 v[24:27], v[120:123], v[152:155], v[24:27]
    v_mfma_f32_16x16x32_bf16 v[28:31], v[120:123], v[156:159], v[28:31]
    ds_read_b64_tr_b16 v[120:121], v164 offset:49152
    ds_read_b64_tr_b16 v[122:123], v164 offset:50176
    s_waitcnt lgkmcnt(13)
    v_mfma_f32_16x16x32_bf16 v[32:35], v[124:127], v[152:155], v[32:35]
    v_mfma_f32_16x16x32_bf16 v[36:39], v[124:127], v[156:159], v[36:39]
    ds_read_b64_tr_b16 v[124:125], v164 offset:53248
    ds_read_b64_tr_b16 v[126:127], v164 offset:54272
    s_waitcnt lgkmcnt(13)
    v_mfma_f32_16x16x32_bf16 v[40:43], v[128:131], v[152:155], v[40:43]
    v_mfma_f32_16x16x32_bf16 v[44:47], v[128:131], v[156:159], v[44:47]
    ds_read_b64_tr_b16 v[128:129], v165 offset:49152
    ds_read_b64_tr_b16 v[130:131], v165 offset:50176
    s_waitcnt lgkmcnt(13)
    v_mfma_f32_16x16x32_bf16 v[48:51], v[132:135], v[152:155], v[48:51]
    v_mfma_f32_16x16x32_bf16 v[52:55], v[132:135], v[156:159], v[52:55]
    ds_read_b64_tr_b16 v[132:133], v165 offset:53248
    ds_read_b64_tr_b16 v[134:135], v165 offset:54272
    s_waitcnt lgkmcnt(12)
    v_mfma_f32_16x16x32_bf16 v[56:59], v[136:139], v[152:155], v[56:59]
    v_mfma_f32_16x16x32_bf16 v[60:63], v[136:139], v[156:159], v[60:63]
    ds_read_b64_tr_b16 v[136:137], v166 offset:49152
    ds_read_b64_tr_b16 v[138:139], v166 offset:50176
    ds_read_b64 v[6:7], v3 offset:120
    s_waitcnt lgkmcnt(13)
    v_mfma_f32_16x16x32_bf16 v[64:67], v[140:143], v[152:155], v[64:67]
    v_mfma_f32_16x16x32_bf16 v[68:71], v[140:143], v[156:159], v[68:71]
    ds_read_b64_tr_b16 v[140:141], v166 offset:53248
    ds_read_b64_tr_b16 v[142:143], v166 offset:54272
    s_waitcnt lgkmcnt(11)
    v_mfma_f32_16x16x32_bf16 v[72:75], v[120:123], v[152:155], v[72:75]
    v_mfma_f32_16x16x32_bf16 v[76:79], v[120:123], v[156:159], v[76:79]
    ds_read_b64_tr_b16 v[120:121], v160 offset:0
    ds_read_b64_tr_b16 v[122:123], v160 offset:1024
    s_waitcnt lgkmcnt(11)
    v_mfma_f32_16x16x32_bf16 v[80:83], v[124:127], v[152:155], v[80:83]
    v_mfma_f32_16x16x32_bf16 v[84:87], v[124:127], v[156:159], v[84:87]
    ds_read_b64_tr_b16 v[124:125], v160 offset:4096
    ds_read_b64_tr_b16 v[126:127], v160 offset:5120
    s_waitcnt lgkmcnt(11)
    v_mfma_f32_16x16x32_bf16 v[88:91], v[128:131], v[152:155], v[88:91]
    v_mfma_f32_16x16x32_bf16 v[92:95], v[128:131], v[156:159], v[92:95]
    ds_read_b64_tr_b16 v[128:129], v161 offset:0
    ds_read_b64_tr_b16 v[130:131], v161 offset:1024
    s_waitcnt lgkmcnt(11)
    v_mfma_f32_16x16x32_bf16 v[96:99], v[132:135], v[152:155], v[96:99]
    v_mfma_f32_16x16x32_bf16 v[100:103], v[132:135], v[156:159], v[100:103]
    ds_read_b64_tr_b16 v[132:133], v161 offset:4096
    ds_read_b64_tr_b16 v[134:135], v161 offset:5120
    s_waitcnt lgkmcnt(11)
    v_mfma_f32_16x16x32_bf16 v[104:107], v[136:139], v[152:155], v[104:107]
    v_mfma_f32_16x16x32_bf16 v[108:111], v[136:139], v[156:159], v[108:111]
    ds_read_b64_tr_b16 v[136:137], v162 offset:0
    ds_read_b64_tr_b16 v[138:139], v162 offset:1024
    s_waitcnt lgkmcnt(10)
    v_mfma_f32_16x16x32_bf16 v[112:115], v[140:143], v[152:155], v[112:115]
    v_mfma_f32_16x16x32_bf16 v[116:119], v[140:143], v[156:159], v[116:119]
    ds_read_b64_tr_b16 v[140:141], v162 offset:4096
    ds_read_b64_tr_b16 v[142:143], v162 offset:5120
    s_mov_b64 exec, 4
    ds_add_u32 v4, v1
    s_mov_b64 exec, -1
    s_setprio 1
    v_readfirstlane_b32 s74, v6
    v_readfirstlane_b32 s75, v7
    s_setprio 0
    s_cmp_ge_u32 s74, 7
    s_cbranch_scc1 L_mega_kernel_rdy_174
    s_mov_b32 s57, 400000
L_mega_kernel_lp_175:
    ds_read_b32 v5, v3 offset:120
    s_waitcnt lgkmcnt(0)
    v_readfirstlane_b32 s74, v5
    s_sub_u32 s57, s57, 1
    s_cmp_ge_u32 s74, 7
    s_cbranch_scc1 L_mega_kernel_ok_176
    s_sleep 1
    s_cmp_lg_u32 s57, 0
    s_cbranch_scc1 L_mega_kernel_lp_175
L_mega_kernel_ok_176:
L_mega_kernel_rdy_174:
    s_cmp_ge_u32 s75, 7
    s_cbranch_scc1 L_mega_kernel_rdy_177
    s_mov_b32 s57, 400000
L_mega_kernel_lp_178:
    ds_read_b32 v5, v3 offset:124
    s_waitcnt lgkmcnt(0)
    v_readfirstlane_b32 s75, v5
    s_sub_u32 s57, s57, 1
    s_cmp_ge_u32 s75, 7
    s_cbranch_scc1 L_mega_kernel_ok_179
    s_sleep 1
    s_cmp_lg_u32 s57, 0
    s_cbranch_scc1 L_mega_kernel_lp_178
L_mega_kernel_ok_179:
L_mega_kernel_rdy_177:
    s_waitcnt lgkmcnt(11)
    v_mfma_f32_16x16x32_bf16 v[8:11], v[120:123], v[144:147], v[8:11]
    v_mfma_f32_16x16x32_bf16 v[12:15], v[120:123], v[148:151], v[12:15]
    ds_read_b64_tr_b16 v[120:121], v163 offset:0
    ds_read_b64_tr_b16 v[122:123], v163 offset:1024
    s_waitcnt lgkmcnt(11)
    v_mfma_f32_16x16x32_bf16 v[16:19], v[124:127], v[144:147], v[16:19]
    v_mfma_f32_16x16x32_bf16 v[20:23], v[124:127], v[148:151], v[20:23]
    ds_read_b64_tr_b16 v[124:125], v163 offset:4096
    ds_read_b64_tr_b16 v[126:127], v163 offset:5120
    ds_read_b128 v[152:155], v0 offset:32768
    ds_read_b128 v[156:159], v0 offset:34816
    s_waitcnt lgkmcnt(13)
    v_mfma_f32_16x16x32_bf16 v[24:27], v[128:131], v[144:147], v[24:27]
    v_mfma_f32_16x16x32_bf16 v[28:31], v[128:131], v[148:151], v[28:31]
    ds_read_b64_tr_b16 v[128:129], v164 offset:0
    ds_read_b64_tr_b16 v[130:131], v164 offset:1024
    s_waitcnt lgkmcnt(13)
    v_mfma_f32_16x16x32_bf16 v[32:35], v[132:135], v[144:147], v[32:35]
    v_mfma_f32_16x16x32_bf16 v[36:39], v[132:135], v[148:151], v[36:39]
    ds_read_b64_tr_b16 v[132:133], v164 offset:4096
    ds_read_b64_tr_b16 v[134:135], v164 offset:5120
    s_waitcnt lgkmcnt(13)
    v_mfma_f32_16x16x32_bf16 v[40:43], v[136:139], v[144:147], v[40:43]
    v_mfma_f32_16x16x32_bf16 v[44:47], v[136:139], v[148:151], v[44:47]
    ds_read_b64_tr_b16 v[136:137], v165 offset:0
    ds_read_b64_tr_b16 v[138:139], v165 offset:1024
    s_waitcnt lgkmcnt(13)
    v_mfma_f32_16x16x32_bf16 v[48:51], v[140:143], v[144:147], v[48:51]
    v_mfma_f32_16x16x32_bf16 v[52:55], v[140:143], v[148:151], v[52:55]
    ds_read_b64_tr_b16 v[140:141], v165 offset:4096
    ds_read_b64_tr_b16 v[142:143], v165 offset:5120
    s_waitcnt lgkmcnt(12)
    v_mfma_f32_16x16x32_bf16 v[56:59], v[120:123], v[144:147], v[56:59]
    v_mfma_f32_16x16x32_bf16 v[60:63], v[120:123], v[148:151], v[60:63]
    ds_read_b64_tr_b16 v[120:121], v166 offset:0
    ds_read_b64_tr_b16 v[122:123], v166 offset:1024
    ds_read_b64 v[6:7], v3 offset:112
    ds_read_b32 v5, v4 offset:64
    s_waitcnt lgkmcnt(14)
    v_mfma_f32_16x16x32_bf16 v[64:67], v[124:127], v[144:147], v[64:67]
    v_mfma_f32_16x16x32_bf16 v[68:71], v[124:127], v[148:151], v[68:71]
    ds_read_b64_tr_b16 v[124:125], v166 offset:4096
    ds_read_b64_tr_b16 v[126:127], v166 offset:5120
    s_waitcnt lgkmcnt(12)
    v_mfma_f32_16x16x32_bf16 v[72:75], v[128:131], v[144:147], v[72:75]
    v_mfma_f32_16x16x32_bf16 v[76:79], v[128:131], v[148:151], v[76:79]
    ds_read_b64_tr_b16 v[128:129], v160 offset:16384
    ds_read_b64_tr_b16 v[130:131], v160 offset:17408
    s_waitcnt lgkmcnt(12)
    v_mfma_f32_16x16x32_bf16 v[80:83], v[132:135], v[144:147], v[80:83]
    v_mfma_f32_16x16x32_bf16 v[84:87], v[132:135], v[148:151], v[84:87]
    ds_read_b64_tr_b16 v[132:133], v160 offset:20480
    ds_read_b64_tr_b16 v[134:135], v160 offset:21504
    s_waitcnt lgkmcnt(12)
    v_mfma_f32_16x16x32_bf16 v[88:91], v[136:139], v[144:147], v[88:91]
    v_mfma_f32_16x16x32_bf16 v[92:95], v[136:139], v[148:151], v[92:95]
    ds_read_b64_tr_b16 v[136:137], v161 offset:16384
    ds_read_b64_tr_b16 v[138:139], v161 offset:17408
    s_waitcnt lgkmcnt(12)
    v_mfma_f32_16x16x32_bf16 v[96:99], v[140:143], v[144:147], v[96:99]
    v_mfma_f32_16x16x32_bf16 v[100:103], v[140:143], v[148:151], v[100:103]
    ds_read_b64_tr_b16 v[140:141], v161 offset:20480
    ds_read_b64_tr_b16 v[142:143], v161 offset:21504
    s_waitcnt lgkmcnt(12)
    v_mfma_f32_16x16x32_bf16 v[104:107], v[120:123], v[144:147], v[104:107]
    v_mfma_f32_16x16x32_bf16 v[108:111], v[120:123], v[148:151], v[108:111]
    ds_read_b64_tr_b16 v[120:121], v162 offset:16384
    ds_read_b64_tr_b16 v[122:123], v162 offset:17408
    s_waitcnt lgkmcnt(10)
    v_mfma_f32_16x16x32_bf16 v[112:115], v[124:127], v[144:147], v[112:115]
    v_mfma_f32_16x16x32_bf16 v[116:119], v[124:127], v[148:151], v[116:119]
    ds_read_b64_tr_b16 v[124:125], v162 offset:20480
    ds_read_b64_tr_b16 v[126:127], v162 offset:21504
    s_mov_b64 exec, 4
    ds_add_u32 v4, v1
    s_mov_b64 exec, -1
    s_setprio 1
    v_readfirstlane_b32 s72, v6
    v_readfirstlane_b32 s73, v7
    v_readfirstlane_b32 s29, v5
    s_setprio 0
    s_cmp_ge_u32 s29, 8
    s_cbranch_scc1 L_mega_kernel_rdy_180
    s_mov_b32 s57, 400000
L_mega_kernel_lp_181:
    ds_read_b32 v5, v4 offset:64
    s_waitcnt lgkmcnt(0)
    v_readfirstlane_b32 s29, v5
    s_sub_u32 s57, s57, 1
    s_cmp_ge_u32 s29, 8
    s_cbranch_scc1 L_mega_kernel_ok_182
    s_sleep 1
    s_cmp_lg_u32 s57, 0
    s_cbranch_scc1 L_mega_kernel_lp_181
L_mega_kernel_ok_182:
L_mega_kernel_rdy_180:
    s_cmp_ge_u32 s72, 8
    s_cbranch_scc1 L_mega_kernel_rdy_183
    s_mov_b32 s57, 400000
L_mega_kernel_lp_184:
    ds_read_b32 v5, v3 offset:112
    s_waitcnt lgkmcnt(0)
    v_readfirstlane_b32 s72, v5
    s_sub_u32 s57, s57, 1
    s_cmp_ge_u32 s72, 8
    s_cbranch_scc1 L_mega_kernel_ok_185
    s_sleep 1
    s_cmp_lg_u32 s57, 0
    s_cbranch_scc1 L_mega_kernel_lp_184
L_mega_kernel_ok_185:
L_mega_kernel_rdy_183:
    s_cmp_ge_u32 s73, 8
    s_cbranch_scc1 L_mega_kernel_rdy_186
    s_mov_b32 s57, 400000
L_mega_kernel_lp_187:
    ds_read_b32 v5, v3 offset:116
    s_waitcnt lgkmcnt(0)
    v_readfirstlane_b32 s73, v5
    s_sub_u32 s57, s57, 1
    s_cmp_ge_u32 s73, 8
    s_cbranch_scc1 L_mega_kernel_ok_188
    s_sleep 1
    s_cmp_lg_u32 s57, 0
    s_cbranch_scc1 L_mega_kernel_lp_187
L_mega_kernel_ok_188:
L_mega_kernel_rdy_186:
    s_waitcnt lgkmcnt(11)
    v_mfma_f32_16x16x32_bf16 v[8:11], v[128:131], v[152:155], v[8:11]
    v_mfma_f32_16x16x32_bf16 v[12:15], v[128:131], v[156:159], v[12:15]
    ds_read_b64_tr_b16 v[128:129], v163 offset:16384
    ds_read_b64_tr_b16 v[130:131], v163 offset:17408
    s_waitcnt lgkmcnt(11)
    v_mfma_f32_16x16x32_bf16 v[16:19], v[132:135], v[152:155], v[16:19]
    v_mfma_f32_16x16x32_bf16 v[20:23], v[132:135], v[156:159], v[20:23]
    ds_read_b64_tr_b16 v[132:133], v163 offset:20480
    ds_read_b64_tr_b16 v[134:135], v163 offset:21504
    ds_read_b128 v[144:147], v167 offset:0
    ds_read_b128 v[148:151], v167 offset:2048
    s_waitcnt lgkmcnt(13)
    v_mfma_f32_16x16x32_bf16 v[24:27], v[136:139], v[152:155], v[24:27]
    v_mfma_f32_16x16x32_bf16 v[28:31], v[136:139], v[156:159], v[28:31]
    ds_read_b64_tr_b16 v[136:137], v164 offset:16384
    ds_read_b64_tr_b16 v[138:139], v164 offset:17408
    s_waitcnt lgkmcnt(13)
    v_mfma_f32_16x16x32_bf16 v[32:35], v[140:143], v[152:155], v[32:35]
    v_mfma_f32_16x16x32_bf16 v[36:39], v[140:143], v[156:159], v[36:39]
    ds_read_b64_tr_b16 v[140:141], v164 offset:20480
    ds_read_b64_tr_b16 v[142:143], v164 offset:21504
    s_waitcnt lgkmcnt(13)
    v_mfma_f32_16x16x32_bf16 v[40:43], v[120:123], v[152:155], v[40:43]
    v_mfma_f32_16x16x32_bf16 v[44:47], v[120:123], v[156:159], v[44:47]
    ds_read_b64_tr_b16 v[120:121], v165 offset:16384
    ds_read_b64_tr_b16 v[122:123], v165 offset:17408
    s_waitcnt lgkmcnt(13)
    v_mfma_f32_16x16x32_bf16 v[48:51], v[124:127], v[152:155], v[48:51]
    v_mfma_f32_16x16x32_bf16 v[52:55], v[124:127], v[156:159], v[52:55]
    ds_read_b64_tr_b16 v[124:125], v165 offset:20480
    ds_read_b64_tr_b16 v[126:127], v165 offset:21504
    s_waitcnt lgkmcnt(12)
    v_mfma_f32_16x16x32_bf16 v[56:59], v[128:131], v[152:155], v[56:59]
    v_mfma_f32_16x16x32_bf16 v[60:63], v[128:131], v[156:159], v[60:63]
    ds_read_b64_tr_b16 v[128:129], v166 offset:16384
    ds_read_b64_tr_b16 v[130:131], v166 offset:17408
    ds_read_b64 v[6:7], v3 offset:120
    s_waitcnt lgkmcnt(13)
    v_mfma_f32_16x16x32_bf16 v[64:67], v[132:135], v[152:155], v[64:67]
    v_mfma_f32_16x16x32_bf16 v[68:71], v[132:135], v[156:159], v[68:71]
    ds_read_b64_tr_b16 v[132:133], v166 offset:20480
    ds_read_b64_tr_b16 v[134:135], v166 offset:21504
    s_waitcnt lgkmcnt(11)
    v_mfma_f32_16x16x32_bf16 v[72:75], v[136:139], v[152:155], v[72:75]
    v_mfma_f32_16x16x32_bf16 v[76:79], v[136:139], v[156:159], v[76:79]
    ds_read_b64_tr_b16 v[136:137], v160 offset:32768
    ds_read_b64_tr_b16 v[138:139], v160 offset:33792
    s_waitcnt lgkmcnt(11)
    v_mfma_f32_16x16x32_bf16 v[80:83], v[140:143], v[152:155], v[80:83]
    v_mfma_f32_16x16x32_bf16 v[84:87], v[140:143], v[156:159], v[84:87]
    ds_read_b64_tr_b16 v[140:141], v160 offset:36864
    ds_read_b64_tr_b16 v[142:143], v160 offset:37888
    s_waitcnt lgkmcnt(11)
    v_mfma_f32_16x16x32_bf16 v[88:91], v[120:123], v[152:155], v[88:91]
    v_mfma_f32_16x16x32_bf16 v[92:95], v[120:123], v[156:159], v[92:95]
    ds_read_b64_tr_b16 v[120:121], v161 offset:32768
    ds_read_b64_tr_b16 v[122:123], v161 offset:33792
    s_waitcnt lgkmcnt(11)
    v_mfma_f32_16x16x32_bf16 v[96:99], v[124:127], v[152:155], v[96:99]
    v_mfma_f32_16x16x32_bf16 v[100:103], v[124:127], v[156:159], v[100:103]
    ds_read_b64_tr_b16 v[124:125], v161 offset:36864
    ds_read_b64_tr_b16 v[126:127], v161 offset:37888
    s_waitcnt lgkmcnt(11)
    v_mfma_f32_16x16x32_bf16 v[104:107], v[128:131], v[152:155], v[104:107]
    v_mfma_f32_16x16x32_bf16 v[108:111], v[128:131], v[156:159], v[108:111]
    ds_read_b64_tr_b16 v[128:129], v162 offset:32768
    ds_read_b64_tr_b16 v[130:131], v162 offset:33792
    s_waitcnt lgkmcnt(10)
    v_mfma_f32_16x16x32_bf16 v[112:115], v[132:135], v[152:155], v[112:115]
    v_mfma_f32_16x16x32_bf16 v[116:119], v[132:135], v[156:159], v[116:119]
    ds_read_b64_tr_b16 v[132:133], v162 offset:36864
    ds_read_b64_tr_b16 v[134:135], v162 offset:37888
    s_mov_b64 exec, 4
    ds_add_u32 v4, v1
    s_mov_b64 exec, -1
    s_setprio 1
    v_readfirstlane_b32 s74, v6
    v_readfirstlane_b32 s75, v7
    s_setprio 0
    s_cmp_ge_u32 s74, 8
    s_cbranch_scc1 L_mega_kernel_rdy_189
    s_mov_b32 s57, 400000
L_mega_kernel_lp_190:
    ds_read_b32 v5, v3 offset:120
    s_waitcnt lgkmcnt(0)
    v_readfirstlane_b32 s74, v5
    s_sub_u32 s57, s57, 1
    s_cmp_ge_u32 s74, 8
    s_cbranch_scc1 L_mega_kernel_ok_191
    s_sleep 1
    s_cmp_lg_u32 s57, 0
    s_cbranch_scc1 L_mega_kernel_lp_190
L_mega_kernel_ok_191:
L_mega_kernel_rdy_189:
    s_cmp_ge_u32 s75, 8
    s_cbranch_scc1 L_mega_kernel_rdy_192
    s_mov_b32 s57, 400000
L_mega_kernel_lp_193:
    ds_read_b32 v5, v3 offset:124
    s_waitcnt lgkmcnt(0)
    v_readfirstlane_b32 s75, v5
    s_sub_u32 s57, s57, 1
    s_cmp_ge_u32 s75, 8
    s_cbranch_scc1 L_mega_kernel_ok_194
    s_sleep 1
    s_cmp_lg_u32 s57, 0
    s_cbranch_scc1 L_mega_kernel_lp_193
L_mega_kernel_ok_194:
L_mega_kernel_rdy_192:
    s_waitcnt lgkmcnt(11)
    v_mfma_f32_16x16x32_bf16 v[8:11], v[136:139], v[144:147], v[8:11]
    v_mfma_f32_16x16x32_bf16 v[12:15], v[136:139], v[148:151], v[12:15]
    ds_read_b64_tr_b16 v[136:137], v163 offset:32768
    ds_read_b64_tr_b16 v[138:139], v163 offset:33792
    s_waitcnt lgkmcnt(11)
    v_mfma_f32_16x16x32_bf16 v[16:19], v[140:143], v[144:147], v[16:19]
    v_mfma_f32_16x16x32_bf16 v[20:23], v[140:143], v[148:151], v[20:23]
    ds_read_b64_tr_b16 v[140:141], v163 offset:36864
    ds_read_b64_tr_b16 v[142:143], v163 offset:37888
    ds_read_b128 v[152:155], v0 offset:0
    ds_read_b128 v[156:159], v0 offset:2048
    s_waitcnt lgkmcnt(13)
    v_mfma_f32_16x16x32_bf16 v[24:27], v[120:123], v[144:147], v[24:27]
    v_mfma_f32_16x16x32_bf16 v[28:31], v[120:123], v[148:151], v[28:31]
    ds_read_b64_tr_b16 v[120:121], v164 offset:32768
    ds_read_b64_tr_b16 v[122:123], v164 offset:33792
    s_waitcnt lgkmcnt(13)
    v_mfma_f32_16x16x32_bf16 v[32:35], v[124:127], v[144:147], v[32:35]
    v_mfma_f32_16x16x32_bf16 v[36:39], v[124:127], v[148:151], v[36:39]
    ds_read_b64_tr_b16 v[124:125], v164 offset:36864
    ds_read_b64_tr_b16 v[126:127], v164 offset:37888
    s_waitcnt lgkmcnt(13)
    v_mfma_f32_16x16x32_bf16 v[40:43], v[128:131], v[144:147], v[40:43]
    v_mfma_f32_16x16x32_bf16 v[44:47], v[128:131], v[148:151], v[44:47]
    ds_read_b64_tr_b16 v[128:129], v165 offset:32768
    ds_read_b64_tr_b16 v[130:131], v165 offset:33792
    s_waitcnt lgkmcnt(13)
    v_mfma_f32_16x16x32_bf16 v[48:51], v[132:135], v[144:147], v[48:51]
    v_mfma_f32_16x16x32_bf16 v[52:55], v[132:135], v[148:151], v[52:55]
    ds_read_b64_tr_b16 v[132:133], v165 offset:36864
    ds_read_b64_tr_b16 v[134:135], v165 offset:37888
    s_waitcnt lgkmcnt(12)
    v_mfma_f32_16x16x32_bf16 v[56:59], v[136:139], v[144:147], v[56:59]
    v_mfma_f32_16x16x32_bf16 v[60:63], v[136:139], v[148:151], v[60:63]
    ds_read_b64_tr_b16 v[136:137], v166 offset:32768
    ds_read_b64_tr_b16 v[138:139], v166 offset:33792
    s_waitcnt lgkmcnt(12)
    v_mfma_f32_16x16x32_bf16 v[64:67], v[140:143], v[144:147], v[64:67]
    v_mfma_f32_16x16x32_bf16 v[68:71], v[140:143], v[148:151], v[68:71]
    ds_read_b64_tr_b16 v[140:141], v166 offset:36864
    ds_read_b64_tr_b16 v[142:143], v166 offset:37888
    s_waitcnt lgkmcnt(10)
    v_mfma_f32_16x16x32_bf16 v[72:75], v[120:123], v[144:147], v[72:75]
    v_mfma_f32_16x16x32_bf16 v[76:79], v[120:123], v[148:151], v[76:79]
    ds_read_b64_tr_b16 v[120:121], v160 offset:49152
    ds_read_b64_tr_b16 v[122:123], v160 offset:50176
    s_waitcnt lgkmcnt(10)
    v_mfma_f32_16x16x32_bf16 v[80:83], v[124:127], v[144:147], v[80:83]
    v_mfma_f32_16x16x32_bf16 v[84:87], v[124:127], v[148:151], v[84:87]
    ds_read_b64_tr_b16 v[124:125], v160 offset:53248
    ds_read_b64_tr_b16 v[126:127], v160 offset:54272
    s_waitcnt lgkmcnt(10)
    v_mfma_f32_16x16x32_bf16 v[88:91], v[128:131], v[144:147], v[88:91]
    v_mfma_f32_16x16x32_bf16 v[92:95], v[128:131], v[148:151], v[92:95]
    ds_read_b64_tr_b16 v[128:129], v161 offset:49152
    ds_read_b64_tr_b16 v[130:131], v161 offset:50176
    s_waitcnt lgkmcnt(10)
    v_mfma_f32_16x16x32_bf16 v[96:99], v[132:135], v[144:147], v[96:99]
    v_mfma_f32_16x16x32_bf16 v[100:103], v[132:135], v[148:151], v[100:103]
    ds_read_b64_tr_b16 v[132:133], v161 offset:53248
    ds_read_b64_tr_b16 v[134:135], v161 offset:54272
    s_waitcnt lgkmcnt(10)
    v_mfma_f32_16x16x32_bf16 v[104:107], v[136:139], v[144:147], v[104:107]
    v_mfma_f32_16x16x32_bf16 v[108:111], v[136:139], v[148:151], v[108:111]
    ds_read_b64_tr_b16 v[136:137], v162 offset:49152
    ds_read_b64_tr_b16 v[138:139], v162 offset:50176
    s_waitcnt lgkmcnt(10)
    v_mfma_f32_16x16x32_bf16 v[112:115], v[140:143], v[144:147], v[112:115]
    v_mfma_f32_16x16x32_bf16 v[116:119], v[140:143], v[148:151], v[116:119]
    ds_read_b64_tr_b16 v[140:141], v162 offset:53248
    ds_read_b64_tr_b16 v[142:143], v162 offset:54272
    s_mov_b64 exec, 4
    ds_add_u32 v4, v1
    s_mov_b64 exec, -1
    s_waitcnt lgkmcnt(11)
    v_mfma_f32_16x16x32_bf16 v[8:11], v[120:123], v[152:155], v[8:11]
    v_mfma_f32_16x16x32_bf16 v[12:15], v[120:123], v[156:159], v[12:15]
    ds_read_b64_tr_b16 v[120:121], v163 offset:49152
    ds_read_b64_tr_b16 v[122:123], v163 offset:50176
    s_waitcnt lgkmcnt(11)
    v_mfma_f32_16x16x32_bf16 v[16:19], v[124:127], v[152:155], v[16:19]
    v_mfma_f32_16x16x32_bf16 v[20:23], v[124:127], v[156:159], v[20:23]
    ds_read_b64_tr_b16 v[124:125], v163 offset:53248
    ds_read_b64_tr_b16 v[126:127], v163 offset:54272
    s_setprio 1
    v_and_b32 v167, 15, v1
    s_lshl_b32 s56, s27, 5
    v_add_u32 v0, s56, v167
    v_lshlrev_b32 v0, 3, v0
    v_add_u32 v0, 149760, v0
    ds_read_b32 v6, v3 offset:8
    ds_read_b32 v7, v3 offset:20
    ds_read_b64 v[160:161], v0
    ds_read_b64 v[162:163], v0 offset:128
    s_waitcnt lgkmcnt(15)
    v_mfma_f32_16x16x32_bf16 v[24:27], v[128:131], v[152:155], v[24:27]
    v_mfma_f32_16x16x32_bf16 v[28:31], v[128:131], v[156:159], v[28:31]
    ds_read_b64_tr_b16 v[128:129], v164 offset:49152
    ds_read_b64_tr_b16 v[130:131], v164 offset:50176
    s_waitcnt lgkmcnt(15)
    v_mfma_f32_16x16x32_bf16 v[32:35], v[132:135], v[152:155], v[32:35]
    v_mfma_f32_16x16x32_bf16 v[36:39], v[132:135], v[156:159], v[36:39]
    ds_read_b64_tr_b16 v[132:133], v164 offset:53248
    ds_read_b64_tr_b16 v[134:135], v164 offset:54272
    s_waitcnt lgkmcnt(15)
    v_mfma_f32_16x16x32_bf16 v[40:43], v[136:139], v[152:155], v[40:43]
    v_mfma_f32_16x16x32_bf16 v[44:47], v[136:139], v[156:159], v[44:47]
    ds_read_b64_tr_b16 v[136:137], v165 offset:49152
    ds_read_b64_tr_b16 v[138:139], v165 offset:50176
    s_waitcnt lgkmcnt(15)
    v_mfma_f32_16x16x32_bf16 v[48:51], v[140:143], v[152:155], v[48:51]
    v_mfma_f32_16x16x32_bf16 v[52:55], v[140:143], v[156:159], v[52:55]
    ds_read_b64_tr_b16 v[140:141], v165 offset:53248
    ds_read_b64_tr_b16 v[142:143], v165 offset:54272
    v_lshlrev_b32 v167, 2, v167
    v_mov_b32 v5, 128
    v_cmp_gt_u32 vcc, 16, v1
    v_add_u32 v0, 64, v167
    s_mov_b64 s[58:59], vcc
    v_cndmask_b32 v164, v5, v167, vcc
    v_add_u32 v164, 150784, v164
    s_waitcnt lgkmcnt(14)
    v_mfma_f32_16x16x32_bf16 v[56:59], v[120:123], v[152:155], v[56:59]
    v_mfma_f32_16x16x32_bf16 v[60:63], v[120:123], v[156:159], v[60:63]
    ds_read_b64_tr_b16 v[120:121], v166 offset:49152
    ds_read_b64_tr_b16 v[122:123], v166 offset:50176
    s_waitcnt lgkmcnt(10)
    v_readfirstlane_b32 s60, v6
    v_readfirstlane_b32 s61, v7
    v_mov_b32 v145, 0
    v_mov_b32 v146, 0
    v_mov_b32 v147, 0
    v_mov_b32 v149, 0
    v_mov_b32 v150, 0
    v_mov_b32 v151, 0
    s_min_u32 s60, s60, s61
    v_lshrrev_b32 v6, 16, v160
    v_or_b32 v6, v6, v160
    v_cndmask_b32 v144, 0, v6, s[58:59]
    v_mul_f32 v160, v161, v161
    v_lshrrev_b32 v6, 16, v162
    v_or_b32 v6, v6, v162
    v_cndmask_b32 v148, 0, v6, s[58:59]
    v_mul_f32 v162, v163, v163
    v_mfma_f32_16x16x32_bf16 v[64:67], v[124:127], v[152:155], v[64:67]
    v_mfma_f32_16x16x32_bf16 v[68:71], v[124:127], v[156:159], v[68:71]
    ds_read_b64_tr_b16 v[124:125], v166 offset:53248
    ds_read_b64_tr_b16 v[126:127], v166 offset:54272
    s_waitcnt lgkmcnt(10)
    v_mfma_f32_16x16x32_bf16 v[72:75], v[128:131], v[152:155], v[72:75]
    v_mfma_f32_16x16x32_bf16 v[76:79], v[128:131], v[156:159], v[76:79]
    v_cndmask_b32 v165, v5, v0, s[58:59]
    v_add_u32 v165, 150784, v165
    s_waitcnt lgkmcnt(8)
    v_mfma_f32_16x16x32_bf16 v[80:83], v[132:135], v[152:155], v[80:83]
    v_mfma_f32_16x16x32_bf16 v[84:87], v[132:135], v[156:159], v[84:87]
    v_mov_b32 v129, 0
    v_mov_b32 v130, 0
    v_mov_b32 v131, 0
    ds_read_b32 v128, v164 offset:0
    s_waitcnt lgkmcnt(7)
    v_mfma_f32_16x16x32_bf16 v[88:91], v[136:139], v[152:155], v[88:91]
    v_mfma_f32_16x16x32_bf16 v[92:95], v[136:139], v[156:159], v[92:95]
    v_mov_b32 v133, 0
    v_mov_b32 v134, 0
    v_mov_b32 v135, 0
    ds_read_b32 v132, v165 offset:0
    s_waitcnt lgkmcnt(6)
    v_mfma_f32_16x16x32_bf16 v[96:99], v[140:143], v[152:155], v[96:99]
    v_mfma_f32_16x16x32_bf16 v[100:103], v[140:143], v[156:159], v[100:103]
    v_mov_b32 v137, 0
    v_mov_b32 v138, 0
    v_mov_b32 v139, 0
    ds_read_b32 v136, v164 offset:256
    s_waitcnt lgkmcnt(5)
    v_mfma_f32_16x16x32_bf16 v[104:107], v[120:123], v[152:155], v[104:107]
    v_mfma_f32_16x16x32_bf16 v[108:111], v[120:123], v[156:159], v[108:111]
    v_mov_b32 v141, 0
    v_mov_b32 v142, 0
    v_mov_b32 v143, 0
    ds_read_b32 v140, v165 offset:256
    s_waitcnt lgkmcnt(4)
    v_mfma_f32_16x16x32_bf16 v[112:115], v[124:127], v[152:155], v[112:115]
    v_mfma_f32_16x16x32_bf16 v[116:119], v[124:127], v[156:159], v[116:119]
    s_mov_b64 exec, 4
    ds_add_u32 v4, v1
    s_mov_b64 exec, -1
    v_mov_b32 v121, 0
    v_mov_b32 v122, 0
    v_mov_b32 v123, 0
    ds_read_b32 v120, v164 offset:512
    s_setprio 1
    s_cmp_eq_u32 s60, 0
    s_cbranch_scc1 L_mega_kernel_eslow_195
    v_mov_b32 v125, 0
    v_mov_b32 v126, 0
    v_mov_b32 v127, 0
    ds_read_b32 v124, v165 offset:512
    s_lshl_b32 s56, s21, 2
    s_add_u32 s56, s56, s27
    s_mul_i32 s56, s56, 112
    s_mul_i32 s57, s22, 7
    s_lshr_b32 s57, s57, 1
    s_add_u32 s56, s56, s57
    s_lshl_b32 s56, s56, 10
    s_add_u32 s33, s56, 3145728
    s_add_u32 s34, s33, 57344
    v_add_u32 v5, 8, v2
    s_bitcmp1_b32 s22, 0
    s_cbranch_scc1 L_mega_kernel_hodd_197
    s_waitcnt lgkmcnt(6)
    v_mfma_f32_16x16x32_bf16 v[8:11], v[128:131], v[144:147], v[8:11]
    v_mfma_f32_16x16x32_bf16 v[12:15], v[128:131], v[148:151], v[12:15]
    ds_read_b32 v128, v164 offset:768
    s_waitcnt lgkmcnt(6)
    v_mfma_f32_16x16x32_bf16 v[16:19], v[132:135], v[144:147], v[16:19]
    v_mfma_f32_16x16x32_bf16 v[20:23], v[132:135], v[148:151], v[20:23]
    ds_read_b32 v132, v165 offset:768
    s_waitcnt lgkmcnt(6)
    v_mfma_f32_16x16x32_bf16 v[24:27], v[136:139], v[144:147], v[24:27]
    v_mfma_f32_16x16x32_bf16 v[28:31], v[136:139], v[148:151], v[28:31]
    ds_read_b32 v136, v164 offset:1024
    s_waitcnt lgkmcnt(6)
    v_mfma_f32_16x16x32_bf16 v[32:35], v[140:143], v[144:147], v[32:35]
    v_mfma_f32_16x16x32_bf16 v[36:39], v[140:143], v[148:151], v[36:39]
    ds_read_b32 v140, v165 offset:1024
    s_waitcnt lgkmcnt(5)
    v_mfma_f32_16x16x32_bf16 v[40:43], v[120:123], v[144:147], v[40:43]
    v_mfma_f32_16x16x32_bf16 v[44:47], v[120:123], v[148:151], v[44:47]
    ds_read_b32 v120, v164 offset:1280
    s_waitcnt lgkmcnt(5)
    v_mfma_f32_16x16x32_bf16 v[48:51], v[124:127], v[144:147], v[48:51]
    v_mfma_f32_16x16x32_bf16 v[52:55], v[124:127], v[148:151], v[52:55]
    ds_read_b32 v124, v165 offset:1280
    s_nop 3
    v_max_f32 v8, 0, v8
    v_max_f32 v9, 0, v9
    v_max_f32 v10, 0, v10
    v_max_f32 v11, 0, v11
    v_pk_mul_f32 v[8:9], v[8:9], v[16:17]
    v_pk_mul_f32 v[10:11], v[10:11], v[18:19]
    v_max_f32 v24, 0, v24
    v_max_f32 v25, 0, v25
    v_max_f32 v26, 0, v26
    v_max_f32 v27, 0, v27
    v_pk_mul_f32 v[24:25], v[24:25], v[32:33]
    v_pk_mul_f32 v[26:27], v[26:27], v[34:35]
    v_cvt_pk_bf16_f32 v8, v8, v9
    v_cvt_pk_bf16_f32 v9, v10, v11
    v_cvt_pk_bf16_f32 v10, v24, v25
    v_cvt_pk_bf16_f32 v11, v26, v27
    buffer_store_dwordx4 v[8:11], v2, s[4:7], s33 offen offset:0 sc1
    v_max_f32 v12, 0, v12
    v_max_f32 v13, 0, v13
    v_max_f32 v14, 0, v14
    v_max_f32 v15, 0, v15
    v_pk_mul_f32 v[12:13], v[12:13], v[20:21]
    v_pk_mul_f32 v[14:15], v[14:15], v[22:23]
    v_max_f32 v28, 0, v28
    v_max_f32 v29, 0, v29
    v_max_f32 v30, 0, v30
    v_max_f32 v31, 0, v31
    v_pk_mul_f32 v[28:29], v[28:29], v[36:37]
    v_pk_mul_f32 v[30:31], v[30:31], v[38:39]
    v_cvt_pk_bf16_f32 v12, v12, v13
    v_cvt_pk_bf16_f32 v13, v14, v15
    v_cvt_pk_bf16_f32 v14, v28, v29
    v_cvt_pk_bf16_f32 v15, v30, v31
    buffer_store_dwordx4 v[12:15], v2, s[4:7], s34 offen offset:0 sc1
    s_waitcnt lgkmcnt(5)
    v_mfma_f32_16x16x32_bf16 v[56:59], v[128:131], v[144:147], v[56:59]
    v_mfma_f32_16x16x32_bf16 v[60:63], v[128:131], v[148:151], v[60:63]
    ds_read_b32 v128, v164 offset:1536
    s_waitcnt lgkmcnt(5)
    v_mfma_f32_16x16x32_bf16 v[64:67], v[132:135], v[144:147], v[64:67]
    v_mfma_f32_16x16x32_bf16 v[68:71], v[132:135], v[148:151], v[68:71]
    ds_read_b32 v132, v165 offset:1536
    s_waitcnt lgkmcnt(5)
    v_mfma_f32_16x16x32_bf16 v[72:75], v[136:139], v[144:147], v[72:75]
    v_mfma_f32_16x16x32_bf16 v[76:79], v[136:139], v[148:151], v[76:79]
    s_waitcnt lgkmcnt(4)
    v_mfma_f32_16x16x32_bf16 v[80:83], v[140:143], v[144:147], v[80:83]
    v_mfma_f32_16x16x32_bf16 v[84:87], v[140:143], v[148:151], v[84:87]
    s_nop 3
    v_max_f32 v40, 0, v40
    v_max_f32 v41, 0, v41
    v_max_f32 v42, 0, v42
    v_max_f32 v43, 0, v43
    v_pk_mul_f32 v[40:41], v[40:41], v[48:49]
    v_pk_mul_f32 v[42:43], v[42:43], v[50:51]
    v_max_f32 v56, 0, v56
    v_max_f32 v57, 0, v57
    v_max_f32 v58, 0, v58
    v_max_f32 v59, 0, v59
    v_pk_mul_f32 v[56:57], v[56:57], v[64:65]
    v_pk_mul_f32 v[58:59], v[58:59], v[66:67]
    v_cvt_pk_bf16_f32 v40, v40, v41
    v_cvt_pk_bf16_f32 v41, v42, v43
    v_cvt_pk_bf16_f32 v42, v56, v57
    v_cvt_pk_bf16_f32 v43, v58, v59
    buffer_store_dwordx4 v[40:43], v2, s[4:7], s33 offen offset:1024 sc1
    v_max_f32 v44, 0, v44
    v_max_f32 v45, 0, v45
    v_max_f32 v46, 0, v46
    v_max_f32 v47, 0, v47
    v_pk_mul_f32 v[44:45], v[44:45], v[52:53]
    v_pk_mul_f32 v[46:47], v[46:47], v[54:55]
    v_max_f32 v60, 0, v60
    v_max_f32 v61, 0, v61
    v_max_f32 v62, 0, v62
    v_max_f32 v63, 0, v63
    v_pk_mul_f32 v[60:61], v[60:61], v[68:69]
    v_pk_mul_f32 v[62:63], v[62:63], v[70:71]
    v_cvt_pk_bf16_f32 v44, v44, v45
    v_cvt_pk_bf16_f32 v45, v46, v47
    v_cvt_pk_bf16_f32 v46, v60, v61
    v_cvt_pk_bf16_f32 v47, v62, v63
    buffer_store_dwordx4 v[44:47], v2, s[4:7], s34 offen offset:1024 sc1
    s_waitcnt lgkmcnt(3)
    v_mfma_f32_16x16x32_bf16 v[88:91], v[120:123], v[144:147], v[88:91]
    v_mfma_f32_16x16x32_bf16 v[92:95], v[120:123], v[148:151], v[92:95]
    s_waitcnt lgkmcnt(2)
    v_mfma_f32_16x16x32_bf16 v[96:99], v[124:127], v[144:147], v[96:99]
    v_mfma_f32_16x16x32_bf16 v[100:103], v[124:127], v[148:151], v[100:103]
    s_waitcnt lgkmcnt(1)
    v_mfma_f32_16x16x32_bf16 v[104:107], v[128:131], v[144:147], v[104:107]
    v_mfma_f32_16x16x32_bf16 v[108:111], v[128:131], v[148:151], v[108:111]
    s_waitcnt lgkmcnt(0)
    v_mfma_f32_16x16x32_bf16 v[112:115], v[132:135], v[144:147], v[112:115]
    v_mfma_f32_16x16x32_bf16 v[116:119], v[132:135], v[148:151], v[116:119]
    s_nop 3
    v_max_f32 v72, 0, v72
    v_max_f32 v73, 0, v73
    v_max_f32 v74, 0, v74
    v_max_f32 v75, 0, v75
    v_pk_mul_f32 v[72:73], v[72:73], v[80:81]
    v_pk_mul_f32 v[74:75], v[74:75], v[82:83]
    v_max_f32 v88, 0, v88
    v_max_f32 v89, 0, v89
    v_max_f32 v90, 0, v90
    v_max_f32 v91, 0, v91
    v_pk_mul_f32 v[88:89], v[88:89], v[96:97]
    v_pk_mul_f32 v[90:91], v[90:91], v[98:99]
    v_cvt_pk_bf16_f32 v72, v72, v73
    v_cvt_pk_bf16_f32 v73, v74, v75
    v_cvt_pk_bf16_f32 v74, v88, v89
    v_cvt_pk_bf16_f32 v75, v90, v91
    buffer_store_dwordx4 v[72:75], v2, s[4:7], s33 offen offset:2048 sc1
    v_max_f32 v76, 0, v76
    v_max_f32 v77, 0, v77
    v_max_f32 v78, 0, v78
    v_max_f32 v79, 0, v79
    v_pk_mul_f32 v[76:77], v[76:77], v[84:85]
    v_pk_mul_f32 v[78:79], v[78:79], v[86:87]
    v_max_f32 v92, 0, v92
    v_max_f32 v93, 0, v93
    v_max_f32 v94, 0, v94
    v_max_f32 v95, 0, v95
    v_pk_mul_f32 v[92:93], v[92:93], v[100:101]
    v_pk_mul_f32 v[94:95], v[94:95], v[102:103]
    v_cvt_pk_bf16_f32 v76, v76, v77
    v_cvt_pk_bf16_f32 v77, v78, v79
    v_cvt_pk_bf16_f32 v78, v92, v93
    v_cvt_pk_bf16_f32 v79, v94, v95
    buffer_store_dwordx4 v[76:79], v2, s[4:7], s34 offen offset:2048 sc1
    v_max_f32 v104, 0, v104
    v_max_f32 v105, 0, v105
    v_max_f32 v106, 0, v106
    v_max_f32 v107, 0, v107
    v_pk_mul_f32 v[104:105], v[104:105], v[112:113]
    v_pk_mul_f32 v[106:107], v[106:107], v[114:115]
    v_cvt_pk_bf16_f32 v104, v104, v105
    v_cvt_pk_bf16_f32 v105, v106, v107
    buffer_store_dwordx2 v[104:105], v2, s[4:7], s33 offen offset:3072 sc1
    v_max_f32 v108, 0, v108
    v_max_f32 v109, 0, v109
    v_max_f32 v110, 0, v110
    v_max_f32 v111, 0, v111
    v_pk_mul_f32 v[108:109], v[108:109], v[116:117]
    v_pk_mul_f32 v[110:111], v[110:111], v[118:119]
    v_cvt_pk_bf16_f32 v108, v108, v109
    v_cvt_pk_bf16_f32 v109, v110, v111
    buffer_store_dwordx2 v[108:109], v2, s[4:7], s34 offen offset:3072 sc1
    s_branch L_mega_kernel_hend_198
L_mega_kernel_hodd_197:
    s_waitcnt lgkmcnt(6)
    v_mfma_f32_16x16x32_bf16 v[8:11], v[128:131], v[144:147], v[8:11]
    v_mfma_f32_16x16x32_bf16 v[12:15], v[128:131], v[148:151], v[12:15]
    ds_read_b32 v128, v164 offset:768
    s_waitcnt lgkmcnt(6)
    v_mfma_f32_16x16x32_bf16 v[16:19], v[132:135], v[144:147], v[16:19]
    v_mfma_f32_16x16x32_bf16 v[20:23], v[132:135], v[148:151], v[20:23]
    ds_read_b32 v132, v165 offset:768
    s_waitcnt lgkmcnt(6)
    v_mfma_f32_16x16x32_bf16 v[24:27], v[136:139], v[144:147], v[24:27]
    v_mfma_f32_16x16x32_bf16 v[28:31], v[136:139], v[148:151], v[28:31]
    ds_read_b32 v136, v164 offset:1024
    s_waitcnt lgkmcnt(6)
    v_mfma_f32_16x16x32_bf16 v[32:35], v[140:143], v[144:147], v[32:35]
    v_mfma_f32_16x16x32_bf16 v[36:39], v[140:143], v[148:151], v[36:39]
    ds_read_b32 v140, v165 offset:1024
    s_waitcnt lgkmcnt(5)
    v_mfma_f32_16x16x32_bf16 v[40:43], v[120:123], v[144:147], v[40:43]
    v_mfma_f32_16x16x32_bf16 v[44:47], v[120:123], v[148:151], v[44:47]
    ds_read_b32 v120, v164 offset:1280
    s_waitcnt lgkmcnt(5)
    v_mfma_f32_16x16x32_bf16 v[48:51], v[124:127], v[144:147], v[48:51]
    v_mfma_f32_16x16x32_bf16 v[52:55], v[124:127], v[148:151], v[52:55]
    ds_read_b32 v124, v165 offset:1280
    s_nop 3
    v_max_f32 v8, 0, v8
    v_max_f32 v9, 0, v9
    v_max_f32 v10, 0, v10
    v_max_f32 v11, 0, v11
    v_pk_mul_f32 v[8:9], v[8:9], v[16:17]
    v_pk_mul_f32 v[10:11], v[10:11], v[18:19]
    v_cvt_pk_bf16_f32 v8, v8, v9
    v_cvt_pk_bf16_f32 v9, v10, v11
    buffer_store_dwordx2 v[8:9], v5, s[4:7], s33 offen offset:0 sc1
    v_max_f32 v12, 0, v12
    v_max_f32 v13, 0, v13
    v_max_f32 v14, 0, v14
    v_max_f32 v15, 0, v15
    v_pk_mul_f32 v[12:13], v[12:13], v[20:21]
    v_pk_mul_f32 v[14:15], v[14:15], v[22:23]
    v_cvt_pk_bf16_f32 v12, v12, v13
    v_cvt_pk_bf16_f32 v13, v14, v15
    buffer_store_dwordx2 v[12:13], v5, s[4:7], s34 offen offset:0 sc1
    s_waitcnt lgkmcnt(5)
    v_mfma_f32_16x16x32_bf16 v[56:59], v[128:131], v[144:147], v[56:59]
    v_mfma_f32_16x16x32_bf16 v[60:63], v[128:131], v[148:151], v[60:63]
    ds_read_b32 v128, v164 offset:1536
    s_waitcnt lgkmcnt(5)
    v_mfma_f32_16x16x32_bf16 v[64:67], v[132:135], v[144:147], v[64:67]
    v_mfma_f32_16x16x32_bf16 v[68:71], v[132:135], v[148:151], v[68:71]
    ds_read_b32 v132, v165 offset:1536
    s_waitcnt lgkmcnt(5)
    v_mfma_f32_16x16x32_bf16 v[72:75], v[136:139], v[144:147], v[72:75]
    v_mfma_f32_16x16x32_bf16 v[76:79], v[136:139], v[148:151], v[76:79]
    s_waitcnt lgkmcnt(4)
    v_mfma_f32_16x16x32_bf16 v[80:83], v[140:143], v[144:147], v[80:83]
    v_mfma_f32_16x16x32_bf16 v[84:87], v[140:143], v[148:151], v[84:87]
    s_nop 3
    v_max_f32 v24, 0, v24
    v_max_f32 v25, 0, v25
    v_max_f32 v26, 0, v26
    v_max_f32 v27, 0, v27
    v_pk_mul_f32 v[24:25], v[24:25], v[32:33]
    v_pk_mul_f32 v[26:27], v[26:27], v[34:35]
    v_max_f32 v40, 0, v40
    v_max_f32 v41, 0, v41
    v_max_f32 v42, 0, v42
    v_max_f32 v43, 0, v43
    v_pk_mul_f32 v[40:41], v[40:41], v[48:49]
    v_pk_mul_f32 v[42:43], v[42:43], v[50:51]
    v_cvt_pk_bf16_f32 v24, v24, v25
    v_cvt_pk_bf16_f32 v25, v26, v27
    v_cvt_pk_bf16_f32 v26, v40, v41
    v_cvt_pk_bf16_f32 v27, v42, v43
    buffer_store_dwordx4 v[24:27], v2, s[4:7], s33 offen offset:1024 sc1
    v_max_f32 v28, 0, v28
    v_max_f32 v29, 0, v29
    v_max_f32 v30, 0, v30
    v_max_f32 v31, 0, v31
    v_pk_mul_f32 v[28:29], v[28:29], v[36:37]
    v_pk_mul_f32 v[30:31], v[30:31], v[38:39]
    v_max_f32 v44, 0, v44
    v_max_f32 v45, 0, v45
    v_max_f32 v46, 0, v46
    v_max_f32 v47, 0, v47
    v_pk_mul_f32 v[44:45], v[44:45], v[52:53]
    v_pk_mul_f32 v[46:47], v[46:47], v[54:55]
    v_cvt_pk_bf16_f32 v28, v28, v29
    v_cvt_pk_bf16_f32 v29, v30, v31
    v_cvt_pk_bf16_f32 v30, v44, v45
    v_cvt_pk_bf16_f32 v31, v46, v47
    buffer_store_dwordx4 v[28:31], v2, s[4:7], s34 offen offset:1024 sc1
    s_waitcnt lgkmcnt(3)
    v_mfma_f32_16x16x32_bf16 v[88:91], v[120:123], v[144:147], v[88:91]
    v_mfma_f32_16x16x32_bf16 v[92:95], v[120:123], v[148:151], v[92:95]
    s_waitcnt lgkmcnt(2)
    v_mfma_f32_16x16x32_bf16 v[96:99], v[124:127], v[144:147], v[96:99]
    v_mfma_f32_16x16x32_bf16 v[100:103], v[124:127], v[148:151], v[100:103]
    s_waitcnt lgkmcnt(1)
    v_mfma_f32_16x16x32_bf16 v[104:107], v[128:131], v[144:147], v[104:107]
    v_mfma_f32_16x16x32_bf16 v[108:111], v[128:131], v[148:151], v[108:111]
    s_waitcnt lgkmcnt(0)
    v_mfma_f32_16x16x32_bf16 v[112:115], v[132:135], v[144:147], v[112:115]
    v_mfma_f32_16x16x32_bf16 v[116:119], v[132:135], v[148:151], v[116:119]
    s_nop 3
    v_max_f32 v56, 0, v56
    v_max_f32 v57, 0, v57
    v_max_f32 v58, 0, v58
    v_max_f32 v59, 0, v59
    v_pk_mul_f32 v[56:57], v[56:57], v[64:65]
    v_pk_mul_f32 v[58:59], v[58:59], v[66:67]
    v_max_f32 v72, 0, v72
    v_max_f32 v73, 0, v73
    v_max_f32 v74, 0, v74
    v_max_f32 v75, 0, v75
    v_pk_mul_f32 v[72:73], v[72:73], v[80:81]
    v_pk_mul_f32 v[74:75], v[74:75], v[82:83]
    v_cvt_pk_bf16_f32 v56, v56, v57
    v_cvt_pk_bf16_f32 v57, v58, v59
    v_cvt_pk_bf16_f32 v58, v72, v73
    v_cvt_pk_bf16_f32 v59, v74, v75
    buffer_store_dwordx4 v[56:59], v2, s[4:7], s33 offen offset:2048 sc1
    v_max_f32 v60, 0, v60
    v_max_f32 v61, 0, v61
    v_max_f32 v62, 0, v62
    v_max_f32 v63, 0, v63
    v_pk_mul_f32 v[60:61], v[60:61], v[68:69]
    v_pk_mul_f32 v[62:63], v[62:63], v[70:71]
    v_max_f32 v76, 0, v76
    v_max_f32 v77, 0, v77
    v_max_f32 v78, 0, v78
    v_max_f32 v79, 0, v79
    v_pk_mul_f32 v[76:77], v[76:77], v[84:85]
    v_pk_mul_f32 v[78:79], v[78:79], v[86:87]
    v_cvt_pk_bf16_f32 v60, v60, v61
    v_cvt_pk_bf16_f32 v61, v62, v63
    v_cvt_pk_bf16_f32 v62, v76, v77
    v_cvt_pk_bf16_f32 v63, v78, v79
    buffer_store_dwordx4 v[60:63], v2, s[4:7], s34 offen offset:2048 sc1
    v_max_f32 v88, 0, v88
    v_max_f32 v89, 0, v89
    v_max_f32 v90, 0, v90
    v_max_f32 v91, 0, v91
    v_pk_mul_f32 v[88:89], v[88:89], v[96:97]
    v_pk_mul_f32 v[90:91], v[90:91], v[98:99]
    v_max_f32 v104, 0, v104
    v_max_f32 v105, 0, v105
    v_max_f32 v106, 0, v106
    v_max_f32 v107, 0, v107
    v_pk_mul_f32 v[104:105], v[104:105], v[112:113]
    v_pk_mul_f32 v[106:107], v[106:107], v[114:115]
    v_cvt_pk_bf16_f32 v88, v88, v89
    v_cvt_pk_bf16_f32 v89, v90, v91
    v_cvt_pk_bf16_f32 v90, v104, v105
    v_cvt_pk_bf16_f32 v91, v106, v107
    buffer_store_dwordx4 v[88:91], v2, s[4:7], s33 offen offset:3072 sc1
    v_max_f32 v92, 0, v92
    v_max_f32 v93, 0, v93
    v_max_f32 v94, 0, v94
    v_max_f32 v95, 0, v95
    v_pk_mul_f32 v[92:93], v[92:93], v[100:101]
    v_pk_mul_f32 v[94:95], v[94:95], v[102:103]
    v_max_f32 v108, 0, v108
    v_max_f32 v109, 0, v109
    v_max_f32 v110, 0, v110
    v_max_f32 v111, 0, v111
    v_pk_mul_f32 v[108:109], v[108:109], v[116:117]
    v_pk_mul_f32 v[110:111], v[110:111], v[118:119]
    v_cvt_pk_bf16_f32 v92, v92, v93
    v_cvt_pk_bf16_f32 v93, v94, v95
    v_cvt_pk_bf16_f32 v94, v108, v109
    v_cvt_pk_bf16_f32 v95, v110, v111
    buffer_store_dwordx4 v[92:95], v2, s[4:7], s34 offen offset:3072 sc1
L_mega_kernel_hend_198:
L_mega_kernel_eend_196:
    s_mul_i32 s30, s27, 448
    s_lshl_b32 s56, s25, 2
    s_add_u32 s30, s30, s56
    s_lshl_b32 s30, s30, 10
    s_add_u32 s30, s30, 12582912
    s_lshl_b32 s56, s24, 2
    s_mul_i32 s28, s56, 56
    s_mul_i32 s57, s27, 14
    s_add_u32 s28, s28, s57
    s_lshl_b32 s28, s28, 10
    s_add_u32 s28, s28, 3145728
    s_add_u32 s29, s28, 57344
    s_add_u32 s31, s28, 114688
    s_add_u32 s32, s28, 172032
    s_waitcnt vmcnt(0)
    s_add_u32 s34, s23, 2
    v_mov_b32 v5, s34
    v_lshlrev_b32 v6, 13, v1
    s_and_b32 s57, s2, 1
    s_lshl_b32 s57, s57, 12
    s_lshl_b32 s56, s26, 2
    s_add_u32 s56, s56, s27
    s_lshl_b32 s56, s56, 2
    s_add_u32 s56, s56, s57
    s_add_u32 s56, s56, 2703360
    s_mov_b64 exec, 15
    buffer_store_dword v5, v6, s[4:7], s56 offen sc1
    s_mov_b64 exec, -1
    s_mov_b64 exec, 2
    ds_add_u32 v3, v1 offset:32
    s_mov_b64 exec, -1
    buffer_load_dwordx4 v[72:75], v2, s[4:7], s30 offen offset:0 sc1
    buffer_load_dwordx4 v[76:79], v2, s[4:7], s30 offen offset:1024 sc1
    buffer_load_dwordx4 v[80:83], v2, s[4:7], s30 offen offset:2048 sc1
    buffer_load_dwordx4 v[84:87], v2, s[4:7], s30 offen offset:3072 sc1
    s_add_u32 s30, s30, 32768
    buffer_load_dwordx4 v[104:107], v2, s[4:7], s30 offen offset:0 sc1
    buffer_load_dwordx4 v[108:111], v2, s[4:7], s30 offen offset:1024 sc1
    buffer_load_dwordx4 v[112:115], v2, s[4:7], s30 offen offset:2048 sc1
    buffer_load_dwordx4 v[116:119], v2, s[4:7], s30 offen offset:3072 sc1
    s_add_u32 s30, s30, 32768
    buffer_load_dwordx4 v[136:139], v2, s[4:7], s30 offen offset:0 sc1
    buffer_load_dwordx4 v[140:143], v2, s[4:7], s30 offen offset:1024 sc1
    buffer_load_dwordx4 v[144:147], v2, s[4:7], s30 offen offset:2048 sc1
    buffer_load_dwordx4 v[148:151], v2, s[4:7], s30 offen offset:3072 sc1
    s_add_u32 s30, s30, 32768
    s_mov_b32 s57, 400000
L_mega_kernel_lp_199:
    ds_read_b32 v5, v3 offset:32
    s_waitcnt lgkmcnt(0)
    v_readfirstlane_b32 s56, v5
    s_sub_u32 s57, s57, 1
    s_cmp_ge_u32 s56, 5
    s_cbranch_scc1 L_mega_kernel_ok_200
    s_sleep 2
    s_cmp_lg_u32 s57, 0
    s_cbranch_scc1 L_mega_kernel_lp_199
L_mega_kernel_ok_200:
    s_setprio 0
    buffer_load_dwordx4 v[88:91], v2, s[4:7], s28 offen offset:0 sc1
    buffer_load_dwordx4 v[92:95], v2, s[4:7], s29 offen offset:0 sc1
    buffer_load_dwordx4 v[96:99], v2, s[4:7], s31 offen offset:0 sc1
    buffer_load_dwordx4 v[100:103], v2, s[4:7], s32 offen offset:0 sc1
    buffer_load_dwordx4 v[120:123], v2, s[4:7], s28 offen offset:1024 sc1
    buffer_load_dwordx4 v[124:127], v2, s[4:7], s29 offen offset:1024 sc1
    buffer_load_dwordx4 v[128:131], v2, s[4:7], s31 offen offset:1024 sc1
    buffer_load_dwordx4 v[132:135], v2, s[4:7], s32 offen offset:1024 sc1
    buffer_load_dwordx4 v[152:155], v2, s[4:7], s28 offen offset:2048 sc1
    buffer_load_dwordx4 v[156:159], v2, s[4:7], s29 offen offset:2048 sc1
    buffer_load_dwordx4 v[160:163], v2, s[4:7], s31 offen offset:2048 sc1
    buffer_load_dwordx4 v[164:167], v2, s[4:7], s32 offen offset:2048 sc1
    s_waitcnt vmcnt(8)
    v_mfma_f32_16x16x32_bf16 v[8:11], v[72:75], v[88:91], 0
    v_mfma_f32_16x16x32_bf16 v[16:19], v[76:79], v[88:91], 0
    v_mfma_f32_16x16x32_bf16 v[24:27], v[80:83], v[88:91], 0
    v_mfma_f32_16x16x32_bf16 v[32:35], v[84:87], v[88:91], 0
    v_mfma_f32_16x16x32_bf16 v[12:15], v[72:75], v[92:95], 0
    v_mfma_f32_16x16x32_bf16 v[20:23], v[76:79], v[92:95], 0
    v_mfma_f32_16x16x32_bf16 v[28:31], v[80:83], v[92:95], 0
    v_mfma_f32_16x16x32_bf16 v[36:39], v[84:87], v[92:95], 0
    v_mfma_f32_16x16x32_bf16 v[40:43], v[72:75], v[96:99], 0
    v_mfma_f32_16x16x32_bf16 v[48:51], v[76:79], v[96:99], 0
    v_mfma_f32_16x16x32_bf16 v[56:59], v[80:83], v[96:99], 0
    v_mfma_f32_16x16x32_bf16 v[64:67], v[84:87], v[96:99], 0
    v_mfma_f32_16x16x32_bf16 v[44:47], v[72:75], v[100:103], 0
    v_mfma_f32_16x16x32_bf16 v[52:55], v[76:79], v[100:103], 0
    v_mfma_f32_16x16x32_bf16 v[60:63], v[80:83], v[100:103], 0
    v_mfma_f32_16x16x32_bf16 v[68:71], v[84:87], v[100:103], 0
    buffer_load_dwordx4 v[72:75], v2, s[4:7], s30 offen offset:0 sc1
    buffer_load_dwordx4 v[76:79], v2, s[4:7], s30 offen offset:1024 sc1
    buffer_load_dwordx4 v[80:83], v2, s[4:7], s30 offen offset:2048 sc1
    buffer_load_dwordx4 v[84:87], v2, s[4:7], s30 offen offset:3072 sc1
    s_add_u32 s30, s30, 32768
    buffer_load_dwordx4 v[88:91], v2, s[4:7], s28 offen offset:3072 sc1
    buffer_load_dwordx4 v[92:95], v2, s[4:7], s29 offen offset:3072 sc1
    buffer_load_dwordx4 v[96:99], v2, s[4:7], s31 offen offset:3072 sc1
    buffer_load_dwordx4 v[100:103], v2, s[4:7], s32 offen offset:3072 sc1
    s_add_u32 s28, s28, 4096
    s_add_u32 s29, s29, 4096
    s_add_u32 s31, s31, 4096
    s_add_u32 s32, s32, 4096
    s_waitcnt vmcnt(12)
    v_mfma_f32_16x16x32_bf16 v[8:11], v[104:107], v[120:123], v[8:11]
    v_mfma_f32_16x16x32_bf16 v[16:19], v[108:111], v[120:123], v[16:19]
    v_mfma_f32_16x16x32_bf16 v[24:27], v[112:115], v[120:123], v[24:27]
    v_mfma_f32_16x16x32_bf16 v[32:35], v[116:119], v[120:123], v[32:35]
    v_mfma_f32_16x16x32_bf16 v[12:15], v[104:107], v[124:127], v[12:15]
    v_mfma_f32_16x16x32_bf16 v[20:23], v[108:111], v[124:127], v[20:23]
    v_mfma_f32_16x16x32_bf16 v[28:31], v[112:115], v[124:127], v[28:31]
    v_mfma_f32_16x16x32_bf16 v[36:39], v[116:119], v[124:127], v[36:39]
    v_mfma_f32_16x16x32_bf16 v[40:43], v[104:107], v[128:131], v[40:43]
    v_mfma_f32_16x16x32_bf16 v[48:51], v[108:111], v[128:131], v[48:51]
    v_mfma_f32_16x16x32_bf16 v[56:59], v[112:115], v[128:131], v[56:59]
    v_mfma_f32_16x16x32_bf16 v[64:67], v[116:119], v[128:131], v[64:67]
    v_mfma_f32_16x16x32_bf16 v[44:47], v[104:107], v[132:135], v[44:47]
    v_mfma_f32_16x16x32_bf16 v[52:55], v[108:111], v[132:135], v[52:55]
    v_mfma_f32_16x16x32_bf16 v[60:63], v[112:115], v[132:135], v[60:63]
    v_mfma_f32_16x16x32_bf16 v[68:71], v[116:119], v[132:135], v[68:71]
    buffer_load_dwordx4 v[104:107], v2, s[4:7], s30 offen offset:0 sc1
    buffer_load_dwordx4 v[108:111], v2, s[4:7], s30 offen offset:1024 sc1
    buffer_load_dwordx4 v[112:115], v2, s[4:7], s30 offen offset:2048 sc1
    buffer_load_dwordx4 v[116:119], v2, s[4:7], s30 offen offset:3072 sc1
    s_add_u32 s30, s30, 32768
    buffer_load_dwordx4 v[120:123], v2, s[4:7], s28 offen offset:0 sc1
    buffer_load_dwordx4 v[124:127], v2, s[4:7], s29 offen offset:0 sc1
    buffer_load_dwordx4 v[128:131], v2, s[4:7], s31 offen offset:0 sc1
    buffer_load_dwordx4 v[132:135], v2, s[4:7], s32 offen offset:0 sc1
    s_waitcnt vmcnt(16)
    v_mfma_f32_16x16x32_bf16 v[8:11], v[136:139], v[152:155], v[8:11]
    v_mfma_f32_16x16x32_bf16 v[16:19], v[140:143], v[152:155], v[16:19]
    v_mfma_f32_16x16x32_bf16 v[24:27], v[144:147], v[152:155], v[24:27]
    v_mfma_f32_16x16x32_bf16 v[32:35], v[148:151], v[152:155], v[32:35]
    v_mfma_f32_16x16x32_bf16 v[12:15], v[136:139], v[156:159], v[12:15]
    v_mfma_f32_16x16x32_bf16 v[20:23], v[140:143], v[156:159], v[20:23]
    v_mfma_f32_16x16x32_bf16 v[28:31], v[144:147], v[156:159], v[28:31]
    v_mfma_f32_16x16x32_bf16 v[36:39], v[148:151], v[156:159], v[36:39]
    v_mfma_f32_16x16x32_bf16 v[40:43], v[136:139], v[160:163], v[40:43]
    v_mfma_f32_16x16x32_bf16 v[48:51], v[140:143], v[160:163], v[48:51]
    v_mfma_f32_16x16x32_bf16 v[56:59], v[144:147], v[160:163], v[56:59]
    v_mfma_f32_16x16x32_bf16 v[64:67], v[148:151], v[160:163], v[64:67]
    v_mfma_f32_16x16x32_bf16 v[44:47], v[136:139], v[164:167], v[44:47]
    v_mfma_f32_16x16x32_bf16 v[52:55], v[140:143], v[164:167], v[52:55]
    v_mfma_f32_16x16x32_bf16 v[60:63], v[144:147], v[164:167], v[60:63]
    v_mfma_f32_16x16x32_bf16 v[68:71], v[148:151], v[164:167], v[68:71]
    buffer_load_dwordx4 v[136:139], v2, s[4:7], s30 offen offset:0 sc1
    buffer_load_dwordx4 v[140:143], v2, s[4:7], s30 offen offset:1024 sc1
    buffer_load_dwordx4 v[144:147], v2, s[4:7], s30 offen offset:2048 sc1
    buffer_load_dwordx4 v[148:151], v2, s[4:7], s30 offen offset:3072 sc1
    s_add_u32 s30, s30, 32768
    buffer_load_dwordx4 v[152:155], v2, s[4:7], s28 offen offset:1024 sc1
    buffer_load_dwordx4 v[156:159], v2, s[4:7], s29 offen offset:1024 sc1
    buffer_load_dwordx4 v[160:163], v2, s[4:7], s31 offen offset:1024 sc1
    buffer_load_dwordx4 v[164:167], v2, s[4:7], s32 offen offset:1024 sc1
    s_waitcnt vmcnt(16)
    v_mfma_f32_16x16x32_bf16 v[8:11], v[72:75], v[88:91], v[8:11]
    v_mfma_f32_16x16x32_bf16 v[16:19], v[76:79], v[88:91], v[16:19]
    v_mfma_f32_16x16x32_bf16 v[24:27], v[80:83], v[88:91], v[24:27]
    v_mfma_f32_16x16x32_bf16 v[32:35], v[84:87], v[88:91], v[32:35]
    v_mfma_f32_16x16x32_bf16 v[12:15], v[72:75], v[92:95], v[12:15]
    v_mfma_f32_16x16x32_bf16 v[20:23], v[76:79], v[92:95], v[20:23]
    v_mfma_f32_16x16x32_bf16 v[28:31], v[80:83], v[92:95], v[28:31]
    v_mfma_f32_16x16x32_bf16 v[36:39], v[84:87], v[92:95], v[36:39]
    v_mfma_f32_16x16x32_bf16 v[40:43], v[72:75], v[96:99], v[40:43]
    v_mfma_f32_16x16x32_bf16 v[48:51], v[76:79], v[96:99], v[48:51]
    v_mfma_f32_16x16x32_bf16 v[56:59], v[80:83], v[96:99], v[56:59]
    v_mfma_f32_16x16x32_bf16 v[64:67], v[84:87], v[96:99], v[64:67]
    v_mfma_f32_16x16x32_bf16 v[44:47], v[72:75], v[100:103], v[44:47]
    v_mfma_f32_16x16x32_bf16 v[52:55], v[76:79], v[100:103], v[52:55]
    v_mfma_f32_16x16x32_bf16 v[60:63], v[80:83], v[100:103], v[60:63]
    v_mfma_f32_16x16x32_bf16 v[68:71], v[84:87], v[100:103], v[68:71]
    buffer_load_dwordx4 v[72:75], v2, s[4:7], s30 offen offset:0 sc1
    buffer_load_dwordx4 v[76:79], v2, s[4:7], s30 offen offset:1024 sc1
    buffer_load_dwordx4 v[80:83], v2, s[4:7], s30 offen offset:2048 sc1
    buffer_load_dwordx4 v[84:87], v2, s[4:7], s30 offen offset:3072 sc1
    s_add_u32 s30, s30, 32768
    buffer_load_dwordx4 v[88:91], v2, s[4:7], s28 offen offset:2048 sc1
    buffer_load_dwordx4 v[92:95], v2, s[4:7], s29 offen offset:2048 sc1
    buffer_load_dwordx4 v[96:99], v2, s[4:7], s31 offen offset:2048 sc1
    buffer_load_dwordx4 v[100:103], v2, s[4:7], s32 offen offset:2048 sc1
    s_waitcnt vmcnt(16)
    v_mfma_f32_16x16x32_bf16 v[8:11], v[104:107], v[120:123], v[8:11]
    v_mfma_f32_16x16x32_bf16 v[16:19], v[108:111], v[120:123], v[16:19]
    v_mfma_f32_16x16x32_bf16 v[24:27], v[112:115], v[120:123], v[24:27]
    v_mfma_f32_16x16x32_bf16 v[32:35], v[116:119], v[120:123], v[32:35]
    v_mfma_f32_16x16x32_bf16 v[12:15], v[104:107], v[124:127], v[12:15]
    v_mfma_f32_16x16x32_bf16 v[20:23], v[108:111], v[124:127], v[20:23]
    v_mfma_f32_16x16x32_bf16 v[28:31], v[112:115], v[124:127], v[28:31]
    v_mfma_f32_16x16x32_bf16 v[36:39], v[116:119], v[124:127], v[36:39]
    v_mfma_f32_16x16x32_bf16 v[40:43], v[104:107], v[128:131], v[40:43]
    v_mfma_f32_16x16x32_bf16 v[48:51], v[108:111], v[128:131], v[48:51]
    v_mfma_f32_16x16x32_bf16 v[56:59], v[112:115], v[128:131], v[56:59]
    v_mfma_f32_16x16x32_bf16 v[64:67], v[116:119], v[128:131], v[64:67]
    v_mfma_f32_16x16x32_bf16 v[44:47], v[104:107], v[132:135], v[44:47]
    v_mfma_f32_16x16x32_bf16 v[52:55], v[108:111], v[132:135], v[52:55]
    v_mfma_f32_16x16x32_bf16 v[60:63], v[112:115], v[132:135], v[60:63]
    v_mfma_f32_16x16x32_bf16 v[68:71], v[116:119], v[132:135], v[68:71]
    buffer_load_dwordx4 v[104:107], v2, s[4:7], s30 offen offset:0 sc1
    buffer_load_dwordx4 v[108:111], v2, s[4:7], s30 offen offset:1024 sc1
    buffer_load_dwordx4 v[112:115], v2, s[4:7], s30 offen offset:2048 sc1
    buffer_load_dwordx4 v[116:119], v2, s[4:7], s30 offen offset:3072 sc1
    s_add_u32 s30, s30, 32768
    buffer_load_dwordx4 v[120:123], v2, s[4:7], s28 offen offset:3072 sc1
    buffer_load_dwordx4 v[124:127], v2, s[4:7], s29 offen offset:3072 sc1
    buffer_load_dwordx4 v[128:131], v2, s[4:7], s31 offen offset:3072 sc1
    buffer_load_dwordx4 v[132:135], v2, s[4:7], s32 offen offset:3072 sc1
    s_add_u32 s28, s28, 4096
    s_add_u32 s29, s29, 4096
    s_add_u32 s31, s31, 4096
    s_add_u32 s32, s32, 4096
    s_waitcnt vmcnt(16)
    v_mfma_f32_16x16x32_bf16 v[8:11], v[136:139], v[152:155], v[8:11]
    v_mfma_f32_16x16x32_bf16 v[16:19], v[140:143], v[152:155], v[16:19]
    v_mfma_f32_16x16x32_bf16 v[24:27], v[144:147], v[152:155], v[24:27]
    v_mfma_f32_16x16x32_bf16 v[32:35], v[148:151], v[152:155], v[32:35]
    v_mfma_f32_16x16x32_bf16 v[12:15], v[136:139], v[156:159], v[12:15]
    v_mfma_f32_16x16x32_bf16 v[20:23], v[140:143], v[156:159], v[20:23]
    v_mfma_f32_16x16x32_bf16 v[28:31], v[144:147], v[156:159], v[28:31]
    v_mfma_f32_16x16x32_bf16 v[36:39], v[148:151], v[156:159], v[36:39]
    v_mfma_f32_16x16x32_bf16 v[40:43], v[136:139], v[160:163], v[40:43]
    v_mfma_f32_16x16x32_bf16 v[48:51], v[140:143], v[160:163], v[48:51]
    v_mfma_f32_16x16x32_bf16 v[56:59], v[144:147], v[160:163], v[56:59]
    v_mfma_f32_16x16x32_bf16 v[64:67], v[148:151], v[160:163], v[64:67]
    v_mfma_f32_16x16x32_bf16 v[44:47], v[136:139], v[164:167], v[44:47]
    v_mfma_f32_16x16x32_bf16 v[52:55], v[140:143], v[164:167], v[52:55]
    v_mfma_f32_16x16x32_bf16 v[60:63], v[144:147], v[164:167], v[60:63]
    v_mfma_f32_16x16x32_bf16 v[68:71], v[148:151], v[164:167], v[68:71]
    buffer_load_dwordx4 v[136:139], v2, s[4:7], s30 offen offset:0 sc1
    buffer_load_dwordx4 v[140:143], v2, s[4:7], s30 offen offset:1024 sc1
    buffer_load_dwordx4 v[144:147], v2, s[4:7], s30 offen offset:2048 sc1
    buffer_load_dwordx4 v[148:151], v2, s[4:7], s30 offen offset:3072 sc1
    s_add_u32 s30, s30, 32768
    buffer_load_dwordx4 v[152:155], v2, s[4:7], s28 offen offset:0 sc1
    buffer_load_dwordx4 v[156:159], v2, s[4:7], s29 offen offset:0 sc1
    buffer_load_dwordx4 v[160:163], v2, s[4:7], s31 offen offset:0 sc1
    buffer_load_dwordx4 v[164:167], v2, s[4:7], s32 offen offset:0 sc1
    s_waitcnt vmcnt(16)
    v_mfma_f32_16x16x32_bf16 v[8:11], v[72:75], v[88:91], v[8:11]
    v_mfma_f32_16x16x32_bf16 v[16:19], v[76:79], v[88:91], v[16:19]
    v_mfma_f32_16x16x32_bf16 v[24:27], v[80:83], v[88:91], v[24:27]
    v_mfma_f32_16x16x32_bf16 v[32:35], v[84:87], v[88:91], v[32:35]
    v_mfma_f32_16x16x32_bf16 v[12:15], v[72:75], v[92:95], v[12:15]
    v_mfma_f32_16x16x32_bf16 v[20:23], v[76:79], v[92:95], v[20:23]
    v_mfma_f32_16x16x32_bf16 v[28:31], v[80:83], v[92:95], v[28:31]
    v_mfma_f32_16x16x32_bf16 v[36:39], v[84:87], v[92:95], v[36:39]
    v_mfma_f32_16x16x32_bf16 v[40:43], v[72:75], v[96:99], v[40:43]
    v_mfma_f32_16x16x32_bf16 v[48:51], v[76:79], v[96:99], v[48:51]
    v_mfma_f32_16x16x32_bf16 v[56:59], v[80:83], v[96:99], v[56:59]
    v_mfma_f32_16x16x32_bf16 v[64:67], v[84:87], v[96:99], v[64:67]
    v_mfma_f32_16x16x32_bf16 v[44:47], v[72:75], v[100:103], v[44:47]
    v_mfma_f32_16x16x32_bf16 v[52:55], v[76:79], v[100:103], v[52:55]
    v_mfma_f32_16x16x32_bf16 v[60:63], v[80:83], v[100:103], v[60:63]
    v_mfma_f32_16x16x32_bf16 v[68:71], v[84:87], v[100:103], v[68:71]
    buffer_load_dwordx4 v[72:75], v2, s[4:7], s30 offen offset:0 sc1
    buffer_load_dwordx4 v[76:79], v2, s[4:7], s30 offen offset:1024 sc1
    buffer_load_dwordx4 v[80:83], v2, s[4:7], s30 offen offset:2048 sc1
    buffer_load_dwordx4 v[84:87], v2, s[4:7], s30 offen offset:3072 sc1
    s_add_u32 s30, s30, 32768
    buffer_load_dwordx4 v[88:91], v2, s[4:7], s28 offen offset:1024 sc1
    buffer_load_dwordx4 v[92:95], v2, s[4:7], s29 offen offset:1024 sc1
    buffer_load_dwordx4 v[96:99], v2, s[4:7], s31 offen offset:1024 sc1
    buffer_load_dwordx4 v[100:103], v2, s[4:7], s32 offen offset:1024 sc1
    s_waitcnt vmcnt(16)
    v_mfma_f32_16x16x32_bf16 v[8:11], v[104:107], v[120:123], v[8:11]
    v_mfma_f32_16x16x32_bf16 v[16:19], v[108:111], v[120:123], v[16:19]
    v_mfma_f32_16x16x32_bf16 v[24:27], v[112:115], v[120:123], v[24:27]
    v_mfma_f32_16x16x32_bf16 v[32:35], v[116:119], v[120:123], v[32:35]
    v_mfma_f32_16x16x32_bf16 v[12:15], v[104:107], v[124:127], v[12:15]
    v_mfma_f32_16x16x32_bf16 v[20:23], v[108:111], v[124:127], v[20:23]
    v_mfma_f32_16x16x32_bf16 v[28:31], v[112:115], v[124:127], v[28:31]
    v_mfma_f32_16x16x32_bf16 v[36:39], v[116:119], v[124:127], v[36:39]
    v_mfma_f32_16x16x32_bf16 v[40:43], v[104:107], v[128:131], v[40:43]
    v_mfma_f32_16x16x32_bf16 v[48:51], v[108:111], v[128:131], v[48:51]
    v_mfma_f32_16x16x32_bf16 v[56:59], v[112:115], v[128:131], v[56:59]
    v_mfma_f32_16x16x32_bf16 v[64:67], v[116:119], v[128:131], v[64:67]
    v_mfma_f32_16x16x32_bf16 v[44:47], v[104:107], v[132:135], v[44:47]
    v_mfma_f32_16x16x32_bf16 v[52:55], v[108:111], v[132:135], v[52:55]
    v_mfma_f32_16x16x32_bf16 v[60:63], v[112:115], v[132:135], v[60:63]
    v_mfma_f32_16x16x32_bf16 v[68:71], v[116:119], v[132:135], v[68:71]
    buffer_load_dwordx4 v[104:107], v2, s[4:7], s30 offen offset:0 sc1
    buffer_load_dwordx4 v[108:111], v2, s[4:7], s30 offen offset:1024 sc1
    buffer_load_dwordx4 v[112:115], v2, s[4:7], s30 offen offset:2048 sc1
    buffer_load_dwordx4 v[116:119], v2, s[4:7], s30 offen offset:3072 sc1
    s_add_u32 s30, s30, 32768
    buffer_load_dwordx4 v[120:123], v2, s[4:7], s28 offen offset:2048 sc1
    buffer_load_dwordx4 v[124:127], v2, s[4:7], s29 offen offset:2048 sc1
    buffer_load_dwordx4 v[128:131], v2, s[4:7], s31 offen offset:2048 sc1
    buffer_load_dwordx4 v[132:135], v2, s[4:7], s32 offen offset:2048 sc1
    s_waitcnt vmcnt(16)
    v_mfma_f32_16x16x32_bf16 v[8:11], v[136:139], v[152:155], v[8:11]
    v_mfma_f32_16x16x32_bf16 v[16:19], v[140:143], v[152:155], v[16:19]
    v_mfma_f32_16x16x32_bf16 v[24:27], v[144:147], v[152:155], v[24:27]
    v_mfma_f32_16x16x32_bf16 v[32:35], v[148:151], v[152:155], v[32:35]
    v_mfma_f32_16x16x32_bf16 v[12:15], v[136:139], v[156:159], v[12:15]
    v_mfma_f32_16x16x32_bf16 v[20:23], v[140:143], v[156:159], v[20:23]
    v_mfma_f32_16x16x32_bf16 v[28:31], v[144:147], v[156:159], v[28:31]
    v_mfma_f32_16x16x32_bf16 v[36:39], v[148:151], v[156:159], v[36:39]
    v_mfma_f32_16x16x32_bf16 v[40:43], v[136:139], v[160:163], v[40:43]
    v_mfma_f32_16x16x32_bf16 v[48:51], v[140:143], v[160:163], v[48:51]
    v_mfma_f32_16x16x32_bf16 v[56:59], v[144:147], v[160:163], v[56:59]
    v_mfma_f32_16x16x32_bf16 v[64:67], v[148:151], v[160:163], v[64:67]
    v_mfma_f32_16x16x32_bf16 v[44:47], v[136:139], v[164:167], v[44:47]
    v_mfma_f32_16x16x32_bf16 v[52:55], v[140:143], v[164:167], v[52:55]
    v_mfma_f32_16x16x32_bf16 v[60:63], v[144:147], v[164:167], v[60:63]
    v_mfma_f32_16x16x32_bf16 v[68:71], v[148:151], v[164:167], v[68:71]
    buffer_load_dwordx4 v[136:139], v2, s[4:7], s30 offen offset:0 sc1
    buffer_load_dwordx4 v[140:143], v2, s[4:7], s30 offen offset:1024 sc1
    buffer_load_dwordx4 v[144:147], v2, s[4:7], s30 offen offset:2048 sc1
    buffer_load_dwordx4 v[148:151], v2, s[4:7], s30 offen offset:3072 sc1
    s_add_u32 s30, s30, 32768
    buffer_load_dwordx4 v[152:155], v2, s[4:7], s28 offen offset:3072 sc1
    buffer_load_dwordx4 v[156:159], v2, s[4:7], s29 offen offset:3072 sc1
    buffer_load_dwordx4 v[160:163], v2, s[4:7], s31 offen offset:3072 sc1
    buffer_load_dwordx4 v[164:167], v2, s[4:7], s32 offen offset:3072 sc1
    s_add_u32 s28, s28, 4096
    s_add_u32 s29, s29, 4096
    s_add_u32 s31, s31, 4096
    s_add_u32 s32, s32, 4096
    s_waitcnt vmcnt(16)
    v_mfma_f32_16x16x32_bf16 v[8:11], v[72:75], v[88:91], v[8:11]
    v_mfma_f32_16x16x32_bf16 v[16:19], v[76:79], v[88:91], v[16:19]
    v_mfma_f32_16x16x32_bf16 v[24:27], v[80:83], v[88:91], v[24:27]
    v_mfma_f32_16x16x32_bf16 v[32:35], v[84:87], v[88:91], v[32:35]
    v_mfma_f32_16x16x32_bf16 v[12:15], v[72:75], v[92:95], v[12:15]
    v_mfma_f32_16x16x32_bf16 v[20:23], v[76:79], v[92:95], v[20:23]
    v_mfma_f32_16x16x32_bf16 v[28:31], v[80:83], v[92:95], v[28:31]
    v_mfma_f32_16x16x32_bf16 v[36:39], v[84:87], v[92:95], v[36:39]
    v_mfma_f32_16x16x32_bf16 v[40:43], v[72:75], v[96:99], v[40:43]
    v_mfma_f32_16x16x32_bf16 v[48:51], v[76:79], v[96:99], v[48:51]
    v_mfma_f32_16x16x32_bf16 v[56:59], v[80:83], v[96:99], v[56:59]
    v_mfma_f32_16x16x32_bf16 v[64:67], v[84:87], v[96:99], v[64:67]
    v_mfma_f32_16x16x32_bf16 v[44:47], v[72:75], v[100:103], v[44:47]
    v_mfma_f32_16x16x32_bf16 v[52:55], v[76:79], v[100:103], v[52:55]
    v_mfma_f32_16x16x32_bf16 v[60:63], v[80:83], v[100:103], v[60:63]
    v_mfma_f32_16x16x32_bf16 v[68:71], v[84:87], v[100:103], v[68:71]
    buffer_load_dwordx4 v[72:75], v2, s[4:7], s30 offen offset:0 sc1
    buffer_load_dwordx4 v[76:79], v2, s[4:7], s30 offen offset:1024 sc1
    buffer_load_dwordx4 v[80:83], v2, s[4:7], s30 offen offset:2048 sc1
    buffer_load_dwordx4 v[84:87], v2, s[4:7], s30 offen offset:3072 sc1
    s_add_u32 s30, s30, 32768
    buffer_load_dwordx4 v[88:91], v2, s[4:7], s28 offen offset:0 sc1
    buffer_load_dwordx4 v[92:95], v2, s[4:7], s29 offen offset:0 sc1
    buffer_load_dwordx4 v[96:99], v2, s[4:7], s31 offen offset:0 sc1
    buffer_load_dwordx4 v[100:103], v2, s[4:7], s32 offen offset:0 sc1
    s_waitcnt vmcnt(16)
    v_mfma_f32_16x16x32_bf16 v[8:11], v[104:107], v[120:123], v[8:11]
    v_mfma_f32_16x16x32_bf16 v[16:19], v[108:111], v[120:123], v[16:19]
    v_mfma_f32_16x16x32_bf16 v[24:27], v[112:115], v[120:123], v[24:27]
    v_mfma_f32_16x16x32_bf16 v[32:35], v[116:119], v[120:123], v[32:35]
    v_mfma_f32_16x16x32_bf16 v[12:15], v[104:107], v[124:127], v[12:15]
    v_mfma_f32_16x16x32_bf16 v[20:23], v[108:111], v[124:127], v[20:23]
    v_mfma_f32_16x16x32_bf16 v[28:31], v[112:115], v[124:127], v[28:31]
    v_mfma_f32_16x16x32_bf16 v[36:39], v[116:119], v[124:127], v[36:39]
    v_mfma_f32_16x16x32_bf16 v[40:43], v[104:107], v[128:131], v[40:43]
    v_mfma_f32_16x16x32_bf16 v[48:51], v[108:111], v[128:131], v[48:51]
    v_mfma_f32_16x16x32_bf16 v[56:59], v[112:115], v[128:131], v[56:59]
    v_mfma_f32_16x16x32_bf16 v[64:67], v[116:119], v[128:131], v[64:67]
    v_mfma_f32_16x16x32_bf16 v[44:47], v[104:107], v[132:135], v[44:47]
    v_mfma_f32_16x16x32_bf16 v[52:55], v[108:111], v[132:135], v[52:55]
    v_mfma_f32_16x16x32_bf16 v[60:63], v[112:115], v[132:135], v[60:63]
    v_mfma_f32_16x16x32_bf16 v[68:71], v[116:119], v[132:135], v[68:71]
    buffer_load_dwordx4 v[104:107], v2, s[4:7], s30 offen offset:0 sc1
    buffer_load_dwordx4 v[108:111], v2, s[4:7], s30 offen offset:1024 sc1
    buffer_load_dwordx4 v[112:115], v2, s[4:7], s30 offen offset:2048 sc1
    buffer_load_dwordx4 v[116:119], v2, s[4:7], s30 offen offset:3072 sc1
    s_add_u32 s30, s30, 32768
    buffer_load_dwordx4 v[120:123], v2, s[4:7], s28 offen offset:1024 sc1
    buffer_load_dwordx4 v[124:127], v2, s[4:7], s29 offen offset:1024 sc1
    buffer_load_dwordx4 v[128:131], v2, s[4:7], s31 offen offset:1024 sc1
    buffer_load_dwordx4 v[132:135], v2, s[4:7], s32 offen offset:1024 sc1
    s_waitcnt vmcnt(16)
    v_mfma_f32_16x16x32_bf16 v[8:11], v[136:139], v[152:155], v[8:11]
    v_mfma_f32_16x16x32_bf16 v[16:19], v[140:143], v[152:155], v[16:19]
    v_mfma_f32_16x16x32_bf16 v[24:27], v[144:147], v[152:155], v[24:27]
    v_mfma_f32_16x16x32_bf16 v[32:35], v[148:151], v[152:155], v[32:35]
    v_mfma_f32_16x16x32_bf16 v[12:15], v[136:139], v[156:159], v[12:15]
    v_mfma_f32_16x16x32_bf16 v[20:23], v[140:143], v[156:159], v[20:23]
    v_mfma_f32_16x16x32_bf16 v[28:31], v[144:147], v[156:159], v[28:31]
    v_mfma_f32_16x16x32_bf16 v[36:39], v[148:151], v[156:159], v[36:39]
    v_mfma_f32_16x16x32_bf16 v[40:43], v[136:139], v[160:163], v[40:43]
    v_mfma_f32_16x16x32_bf16 v[48:51], v[140:143], v[160:163], v[48:51]
    v_mfma_f32_16x16x32_bf16 v[56:59], v[144:147], v[160:163], v[56:59]
    v_mfma_f32_16x16x32_bf16 v[64:67], v[148:151], v[160:163], v[64:67]
    v_mfma_f32_16x16x32_bf16 v[44:47], v[136:139], v[164:167], v[44:47]
    v_mfma_f32_16x16x32_bf16 v[52:55], v[140:143], v[164:167], v[52:55]
    v_mfma_f32_16x16x32_bf16 v[60:63], v[144:147], v[164:167], v[60:63]
    v_mfma_f32_16x16x32_bf16 v[68:71], v[148:151], v[164:167], v[68:71]
    s_waitcnt vmcnt(8)
    v_mfma_f32_16x16x32_bf16 v[8:11], v[72:75], v[88:91], v[8:11]
    v_mfma_f32_16x16x32_bf16 v[16:19], v[76:79], v[88:91], v[16:19]
    v_mfma_f32_16x16x32_bf16 v[24:27], v[80:83], v[88:91], v[24:27]
    v_mfma_f32_16x16x32_bf16 v[32:35], v[84:87], v[88:91], v[32:35]
    v_mfma_f32_16x16x32_bf16 v[12:15], v[72:75], v[92:95], v[12:15]
    v_mfma_f32_16x16x32_bf16 v[20:23], v[76:79], v[92:95], v[20:23]
    v_mfma_f32_16x16x32_bf16 v[28:31], v[80:83], v[92:95], v[28:31]
    v_mfma_f32_16x16x32_bf16 v[36:39], v[84:87], v[92:95], v[36:39]
    v_mfma_f32_16x16x32_bf16 v[40:43], v[72:75], v[96:99], v[40:43]
    v_mfma_f32_16x16x32_bf16 v[48:51], v[76:79], v[96:99], v[48:51]
    v_mfma_f32_16x16x32_bf16 v[56:59], v[80:83], v[96:99], v[56:59]
    v_mfma_f32_16x16x32_bf16 v[64:67], v[84:87], v[96:99], v[64:67]
    v_mfma_f32_16x16x32_bf16 v[44:47], v[72:75], v[100:103], v[44:47]
    v_mfma_f32_16x16x32_bf16 v[52:55], v[76:79], v[100:103], v[52:55]
    v_mfma_f32_16x16x32_bf16 v[60:63], v[80:83], v[100:103], v[60:63]
    v_mfma_f32_16x16x32_bf16 v[68:71], v[84:87], v[100:103], v[68:71]
    s_and_b32 s58, s27, 1
    s_lshr_b32 s59, s27, 1
    v_and_b32 v6, 15, v1
    v_lshlrev_b32 v6, 10, v6
    v_lshrrev_b32 v5, 4, v1
    v_lshl_add_u32 v136, v5, 3, v6
    v_and_b32 v137, 1, v5
    v_lshl_add_u32 v137, v137, 5, v6
    v_lshrrev_b32 v5, 1, v5
    v_lshl_add_u32 v137, v5, 4, v137
    s_lshl_b32 s56, s24, 16
    s_lshl_b32 s57, s59, 15
    s_add_u32 s56, s56, s57
    s_lshl_b32 s57, s25, 7
    s_add_u32 s56, s56, s57
    s_lshl_b32 s57, s58, 6
    s_add_u32 s31, s56, s57
    s_add_u32 s32, s31, 16384
    buffer_load_dwordx2 v[88:89], v136, s[8:11], s31 offen offset:0
    buffer_load_dwordx2 v[90:91], v136, s[8:11], s32 offen offset:0
    buffer_load_dwordx2 v[92:93], v136, s[8:11], s31 offen offset:32
    buffer_load_dwordx2 v[94:95], v136, s[8:11], s32 offen offset:32
    s_waitcnt vmcnt(4)
    v_mfma_f32_16x16x32_bf16 v[8:11], v[104:107], v[120:123], v[8:11]
    v_mfma_f32_16x16x32_bf16 v[16:19], v[108:111], v[120:123], v[16:19]
    v_mfma_f32_16x16x32_bf16 v[24:27], v[112:115], v[120:123], v[24:27]
    v_mfma_f32_16x16x32_bf16 v[32:35], v[116:119], v[120:123], v[32:35]
    v_mfma_f32_16x16x32_bf16 v[12:15], v[104:107], v[124:127], v[12:15]
    v_mfma_f32_16x16x32_bf16 v[20:23], v[108:111], v[124:127], v[20:23]
    v_mfma_f32_16x16x32_bf16 v[28:31], v[112:115], v[124:127], v[28:31]
    v_mfma_f32_16x16x32_bf16 v[36:39], v[116:119], v[124:127], v[36:39]
    v_mfma_f32_16x16x32_bf16 v[40:43], v[104:107], v[128:131], v[40:43]
    v_mfma_f32_16x16x32_bf16 v[48:51], v[108:111], v[128:131], v[48:51]
    v_mfma_f32_16x16x32_bf16 v[56:59], v[112:115], v[128:131], v[56:59]
    v_mfma_f32_16x16x32_bf16 v[64:67], v[116:119], v[128:131], v[64:67]
    v_mfma_f32_16x16x32_bf16 v[44:47], v[104:107], v[132:135], v[44:47]
    v_mfma_f32_16x16x32_bf16 v[52:55], v[108:111], v[132:135], v[52:55]
    v_mfma_f32_16x16x32_bf16 v[60:63], v[112:115], v[132:135], v[60:63]
    v_mfma_f32_16x16x32_bf16 v[68:71], v[116:119], v[132:135], v[68:71]
    s_setprio 1
    s_nop 4
    s_cmp_eq_u32 s27, 0
    s_cbranch_scc1 L_mega_kernel_redw_201
    s_sub_u32 s56, s27, 1
    s_and_b32 s56, s56, 3
    s_lshl_b32 s56, s56, 12
    s_add_u32 s56, s56, 0
    v_add_u32 v5, s56, v2
    ds_write_b128 v5, v[8:11] offset:0
    ds_write_b128 v5, v[12:15] offset:1024
    ds_write_b128 v5, v[16:19] offset:2048
    ds_write_b128 v5, v[20:23] offset:3072
    s_branch L_mega_kernel_redwe_202
L_mega_kernel_redw_201:
    v_mov_b32 v72, v8
    v_mov_b32 v73, v9
    v_mov_b32 v74, v10
    v_mov_b32 v75, v11
    v_mov_b32 v76, v12
    v_mov_b32 v77, v13
    v_mov_b32 v78, v14
    v_mov_b32 v79, v15
    v_mov_b32 v80, v16
    v_mov_b32 v81, v17
    v_mov_b32 v82, v18
    v_mov_b32 v83, v19
    v_mov_b32 v84, v20
    v_mov_b32 v85, v21
    v_mov_b32 v86, v22
    v_mov_b32 v87, v23
L_mega_kernel_redwe_202:
    s_cmp_eq_u32 s27, 1
    s_cbranch_scc1 L_mega_kernel_redw_203
    s_sub_u32 s56, s27, 2
    s_and_b32 s56, s56, 3
    s_lshl_b32 s56, s56, 12
    s_add_u32 s56, s56, 12288
    v_add_u32 v5, s56, v2
    ds_write_b128 v5, v[24:27] offset:0
    ds_write_b128 v5, v[28:31] offset:1024
    ds_write_b128 v5, v[32:35] offset:2048
    ds_write_b128 v5, v[36:39] offset:3072
    s_branch L_mega_kernel_redwe_204
L_mega_kernel_redw_203:
    v_mov_b32 v72, v24
    v_mov_b32 v73, v25
    v_mov_b32 v74, v26
    v_mov_b32 v75, v27
    v_mov_b32 v76, v28
    v_mov_b32 v77, v29
    v_mov_b32 v78, v30
    v_mov_b32 v79, v31
    v_mov_b32 v80, v32
    v_mov_b32 v81, v33
    v_mov_b32 v82, v34
    v_mov_b32 v83, v35
    v_mov_b32 v84, v36
    v_mov_b32 v85, v37
    v_mov_b32 v86, v38
    v_mov_b32 v87, v39
L_mega_kernel_redwe_204:
    s_cmp_eq_u32 s27, 2
    s_cbranch_scc1 L_mega_kernel_redw_205
    s_sub_u32 s56, s27, 3
    s_and_b32 s56, s56, 3
    s_lshl_b32 s56, s56, 12
    s_add_u32 s56, s56, 24576
    v_add_u32 v5, s56, v2
    ds_write_b128 v5, v[40:43] offset:0
    ds_write_b128 v5, v[44:47] offset:1024
    ds_write_b128 v5, v[48:51] offset:2048
    ds_write_b128 v5, v[52:55] offset:3072
    s_branch L_mega_kernel_redwe_206
L_mega_kernel_redw_205:
    v_mov_b32 v72, v40
    v_mov_b32 v73, v41
    v_mov_b32 v74, v42
    v_mov_b32 v75, v43
    v_mov_b32 v76, v44
    v_mov_b32 v77, v45
    v_mov_b32 v78, v46
    v_mov_b32 v79, v47
    v_mov_b32 v80, v48
    v_mov_b32 v81, v49
    v_mov_b32 v82, v50
    v_mov_b32 v83, v51
    v_mov_b32 v84, v52
    v_mov_b32 v85, v53
    v_mov_b32 v86, v54
    v_mov_b32 v87, v55
L_mega_kernel_redwe_206:
    s_cmp_eq_u32 s27, 3
    s_cbranch_scc1 L_mega_kernel_redw_207
    s_sub_u32 s56, s27, 4
    s_and_b32 s56, s56, 3
    s_lshl_b32 s56, s56, 12
    s_add_u32 s56, s56, 36864
    v_add_u32 v5, s56, v2
    ds_write_b128 v5, v[56:59] offset:0
    ds_write_b128 v5, v[60:63] offset:1024
    ds_write_b128 v5, v[64:67] offset:2048
    ds_write_b128 v5, v[68:71] offset:3072
    s_branch L_mega_kernel_redwe_208
L_mega_kernel_redw_207:
    v_mov_b32 v72, v56
    v_mov_b32 v73, v57
    v_mov_b32 v74, v58
    v_mov_b32 v75, v59
    v_mov_b32 v76, v60
    v_mov_b32 v77, v61
    v_mov_b32 v78, v62
    v_mov_b32 v79, v63
    v_mov_b32 v80, v64
    v_mov_b32 v81, v65
    v_mov_b32 v82, v66
    v_mov_b32 v83, v67
    v_mov_b32 v84, v68
    v_mov_b32 v85, v69
    v_mov_b32 v86, v70
    v_mov_b32 v87, v71
L_mega_kernel_redwe_208:
    s_mov_b64 exec, 2
    ds_add_u32 v3, v1 offset:28
    s_mov_b64 exec, -1
    s_lshl_b32 s56, s24, 1
    s_add_u32 s56, s56, s59
    s_lshl_b32 s56, s56, 5
    s_lshl_b32 s57, s58, 4
    s_add_u32 s56, s56, s57
    s_lshl_b32 s56, s56, 10
    s_add_u32 s28, s56, 10485760
    v_lshrrev_b32 v5, 4, v1
    v_and_b32 v138, 15, v1
    v_lshlrev_b32 v138, 4, v138
    v_lshl_add_u32 v138, v5, 9, v138
    s_mov_b32 s12, s54
    s_mov_b32 s13, s55
    s_mov_b32 s14, 2097152
    s_mov_b32 s15, 0x20000
    s_mul_i32 s56, s58, 34816
    s_add_u32 s56, s56, 49152
    v_add_u32 v139, s56, v2
    s_mul_i32 s56, s58, 30720
    s_add_u32 s56, s56, 51200
    v_add_u32 v164, s56, v2
    s_and_b32 s56, s24, 1
    s_lshl_b32 s56, s56, 1
    s_add_u32 s56, s56, s59
    s_lshl_b32 s56, s56, 8
    s_add_u32 s56, s56, 149760
    v_and_b32 v5, 15, v1
    v_lshlrev_b32 v5, 3, v5
    v_add_u32 v5, s56, v5
    ds_read_b64 v[166:167], v5
    ds_read_b64 v[6:7], v5 offset:128
    s_mov_b32 s57, 400000
L_mega_kernel_lp_209:
    ds_read_b32 v5, v3 offset:164
    s_waitcnt lgkmcnt(0)
    v_readfirstlane_b32 s56, v5
    s_sub_u32 s57, s57, 1
    s_cmp_ge_u32 s56, 1
    s_cbranch_scc1 L_mega_kernel_ok_210
    s_sleep 2
    s_cmp_lg_u32 s57, 0
    s_cbranch_scc1 L_mega_kernel_lp_209
L_mega_kernel_ok_210:
    s_waitcnt vmcnt(0) lgkmcnt(0)
    v_mul_f32 v167, v167, v167
    v_mul_f32 v7, v7, v7
    v_lshlrev_b32 v148, 16, v88
    v_and_b32 v149, 0xffff0000, v88
    v_lshlrev_b32 v150, 16, v89
    v_and_b32 v151, 0xffff0000, v89
    v_lshlrev_b32 v152, 16, v90
    v_and_b32 v153, 0xffff0000, v90
    v_lshlrev_b32 v154, 16, v91
    v_and_b32 v155, 0xffff0000, v91
    v_lshlrev_b32 v156, 16, v92
    v_and_b32 v157, 0xffff0000, v92
    v_lshlrev_b32 v158, 16, v93
    v_and_b32 v159, 0xffff0000, v93
    v_lshlrev_b32 v160, 16, v94
    v_and_b32 v161, 0xffff0000, v94
    v_lshlrev_b32 v162, 16, v95
    v_and_b32 v163, 0xffff0000, v95
    s_mul_i32 s56, s27, 12288
    s_add_u32 s56, s56, 0
    v_add_u32 v136, s56, v2
    s_mov_b32 s57, 400000
L_mega_kernel_lp_211:
    ds_read_b32 v5, v3 offset:28
    s_waitcnt lgkmcnt(0)
    v_readfirstlane_b32 s56, v5
    s_sub_u32 s57, s57, 1
    s_cmp_ge_u32 s56, 4
    s_cbranch_scc1 L_mega_kernel_ok_212
    s_cmp_lg_u32 s57, 0
    s_cbranch_scc1 L_mega_kernel_lp_211
L_mega_kernel_ok_212:
    ds_read_b128 v[96:99], v136 offset:0
    ds_read_b128 v[100:103], v136 offset:1024
    ds_read_b128 v[104:107], v136 offset:2048
    ds_read_b128 v[108:111], v136 offset:3072
    ds_read_b128 v[112:115], v136 offset:4096
    ds_read_b128 v[116:119], v136 offset:5120
    ds_read_b128 v[120:123], v136 offset:6144
    ds_read_b128 v[124:127], v136 offset:7168
    ds_read_b128 v[128:131], v136 offset:8192
    ds_read_b128 v[132:135], v136 offset:9216
    ds_read_b128 v[140:143], v136 offset:10240
    ds_read_b128 v[144:147], v136 offset:11264
    ds_read_b128 v[24:27], v139 offset:0
    ds_read_b128 v[32:35], v164 offset:0
    ds_read_b128 v[28:31], v139 offset:1024
    ds_read_b128 v[36:39], v164 offset:1024
    s_waitcnt lgkmcnt(8)
    v_pk_add_f32 v[96:97], v[96:97], v[112:113]
    v_pk_add_f32 v[98:99], v[98:99], v[114:115]
    v_pk_add_f32 v[100:101], v[100:101], v[116:117]
    v_pk_add_f32 v[102:103], v[102:103], v[118:119]
    v_pk_add_f32 v[104:105], v[104:105], v[120:121]
    v_pk_add_f32 v[106:107], v[106:107], v[122:123]
    v_pk_add_f32 v[108:109], v[108:109], v[124:125]
    v_pk_add_f32 v[110:111], v[110:111], v[126:127]
    s_waitcnt lgkmcnt(4)
    v_pk_add_f32 v[72:73], v[72:73], v[128:129]
    v_pk_add_f32 v[74:75], v[74:75], v[130:131]
    v_pk_add_f32 v[76:77], v[76:77], v[132:133]
    v_pk_add_f32 v[78:79], v[78:79], v[134:135]
    v_pk_add_f32 v[80:81], v[80:81], v[140:141]
    v_pk_add_f32 v[82:83], v[82:83], v[142:143]
    v_pk_add_f32 v[84:85], v[84:85], v[144:145]
    v_pk_add_f32 v[86:87], v[86:87], v[146:147]
    v_pk_add_f32 v[72:73], v[72:73], v[96:97]
    v_pk_add_f32 v[74:75], v[74:75], v[98:99]
    v_pk_add_f32 v[76:77], v[76:77], v[100:101]
    v_pk_add_f32 v[78:79], v[78:79], v[102:103]
    v_pk_add_f32 v[80:81], v[80:81], v[104:105]
    v_pk_add_f32 v[82:83], v[82:83], v[106:107]
    v_pk_add_f32 v[84:85], v[84:85], v[108:109]
    v_pk_add_f32 v[86:87], v[86:87], v[110:111]
    v_pk_fma_f32 v[72:73], v[72:73], v[166:167], v[148:149] op_sel:[0,1,0] op_sel_hi:[1,1,1]
    v_pk_fma_f32 v[74:75], v[74:75], v[166:167], v[150:151] op_sel:[0,1,0] op_sel_hi:[1,1,1]
    v_pk_fma_f32 v[76:77], v[76:77], v[6:7], v[152:153] op_sel:[0,1,0] op_sel_hi:[1,1,1]
    v_pk_fma_f32 v[78:79], v[78:79], v[6:7], v[154:155] op_sel:[0,1,0] op_sel_hi:[1,1,1]
    v_pk_fma_f32 v[80:81], v[80:81], v[166:167], v[156:157] op_sel:[0,1,0] op_sel_hi:[1,1,1]
    v_pk_fma_f32 v[82:83], v[82:83], v[166:167], v[158:159] op_sel:[0,1,0] op_sel_hi:[1,1,1]
    v_pk_fma_f32 v[84:85], v[84:85], v[6:7], v[160:161] op_sel:[0,1,0] op_sel_hi:[1,1,1]
    v_pk_fma_f32 v[86:87], v[86:87], v[6:7], v[162:163] op_sel:[0,1,0] op_sel_hi:[1,1,1]
    s_mov_b32 s57, 400000
L_mega_kernel_lp_213:
    ds_read_b32 v5, v3 offset:24
    s_waitcnt lgkmcnt(0)
    v_readfirstlane_b32 s56, v5
    s_sub_u32 s57, s57, 1
    s_cmp_ge_u32 s56, 4
    s_cbranch_scc1 L_mega_kernel_ok_214
    s_sleep 2
    s_cmp_lg_u32 s57, 0
    s_cbranch_scc1 L_mega_kernel_lp_213
L_mega_kernel_ok_214:
    s_add_u32 s56, s28, 0
    buffer_load_dwordx4 v[96:99], v138, s[4:7], s56 offen offset:0 sc1
    s_add_u32 s56, s28, 0
    buffer_load_dwordx4 v[100:103], v138, s[4:7], s56 offen offset:256 sc1
    s_add_u32 s56, s28, 2048
    buffer_load_dwordx4 v[104:107], v138, s[4:7], s56 offen offset:0 sc1
    s_add_u32 s56, s28, 2048
    buffer_load_dwordx4 v[108:111], v138, s[4:7], s56 offen offset:256 sc1
    s_add_u32 s56, s28, 4096
    buffer_load_dwordx4 v[112:115], v138, s[4:7], s56 offen offset:0 sc1
    s_add_u32 s56, s28, 4096
    buffer_load_dwordx4 v[116:119], v138, s[4:7], s56 offen offset:256 sc1
    s_add_u32 s56, s28, 6144
    buffer_load_dwordx4 v[120:123], v138, s[4:7], s56 offen offset:0 sc1
    s_add_u32 s56, s28, 6144
    buffer_load_dwordx4 v[124:127], v138, s[4:7], s56 offen offset:256 sc1
    s_add_u32 s56, s28, 8192
    buffer_load_dwordx4 v[128:131], v138, s[4:7], s56 offen offset:0 sc1
    s_add_u32 s56, s28, 8192
    buffer_load_dwordx4 v[132:135], v138, s[4:7], s56 offen offset:256 sc1
    s_add_u32 s56, s28, 10240
    buffer_load_dwordx4 v[140:143], v138, s[4:7], s56 offen offset:0 sc1
    s_add_u32 s56, s28, 10240
    buffer_load_dwordx4 v[144:147], v138, s[4:7], s56 offen offset:256 sc1
    s_add_u32 s56, s28, 12288
    buffer_load_dwordx4 v[148:151], v138, s[4:7], s56 offen offset:0 sc1
    s_add_u32 s56, s28, 12288
    buffer_load_dwordx4 v[152:155], v138, s[4:7], s56 offen offset:256 sc1
    s_add_u32 s56, s28, 14336
    buffer_load_dwordx4 v[156:159], v138, s[4:7], s56 offen offset:0 sc1
    s_add_u32 s56, s28, 14336
    buffer_load_dwordx4 v[160:163], v138, s[4:7], s56 offen offset:256 sc1
    s_mov_b32 s62, 100000
    s_waitcnt vmcnt(14)
    v_max3_u32 v5, v96, v97, v98
    v_max3_u32 v6, v100, v101, v102
    v_max3_u32 v5, v99, v103, v5
    v_max_u32 v5, v6, v5
    v_cmp_eq_u32 vcc, -1, v5
    ds_read_b128 v[40:43], v139 offset:4096
    ds_read_b128 v[48:51], v164 offset:4096
    ds_read_b128 v[44:47], v139 offset:5120
    ds_read_b128 v[52:55], v164 offset:5120
    s_cmp_lg_u64 vcc, 0
    s_cbranch_scc1 L_mega_kernel_retry_215
L_mega_kernel_cont_217:
    s_waitcnt lgkmcnt(4)
    v_mfma_f32_16x16x32_bf16 v[72:75], v[24:27], v[96:99], v[72:75]
    v_mfma_f32_16x16x32_bf16 v[8:11], v[32:35], v[96:99], 0
    v_mfma_f32_16x16x32_bf16 v[76:79], v[24:27], v[100:103], v[76:79]
    v_mfma_f32_16x16x32_bf16 v[12:15], v[32:35], v[100:103], 0
    v_mfma_f32_16x16x32_bf16 v[80:83], v[28:31], v[96:99], v[80:83]
    v_mfma_f32_16x16x32_bf16 v[16:19], v[36:39], v[96:99], 0
    v_mfma_f32_16x16x32_bf16 v[84:87], v[28:31], v[100:103], v[84:87]
    v_mfma_f32_16x16x32_bf16 v[20:23], v[36:39], v[100:103], 0
    s_waitcnt vmcnt(12)
    v_max3_u32 v5, v104, v105, v106
    v_max3_u32 v6, v108, v109, v110
    v_max3_u32 v5, v107, v111, v5
    v_max_u32 v5, v6, v5
    v_cmp_eq_u32 vcc, -1, v5
    ds_read_b128 v[24:27], v139 offset:8192
    ds_read_b128 v[32:35], v164 offset:8192
    ds_read_b128 v[28:31], v139 offset:9216
    ds_read_b128 v[36:39], v164 offset:9216
    s_cmp_lg_u64 vcc, 0
    s_cbranch_scc1 L_mega_kernel_retry_218
L_mega_kernel_cont_220:
    s_waitcnt lgkmcnt(4)
    v_mfma_f32_16x16x32_bf16 v[72:75], v[40:43], v[104:107], v[72:75]
    v_mfma_f32_16x16x32_bf16 v[8:11], v[48:51], v[104:107], v[8:11]
    v_mfma_f32_16x16x32_bf16 v[76:79], v[40:43], v[108:111], v[76:79]
    v_mfma_f32_16x16x32_bf16 v[12:15], v[48:51], v[108:111], v[12:15]
    v_mfma_f32_16x16x32_bf16 v[80:83], v[44:47], v[104:107], v[80:83]
    v_mfma_f32_16x16x32_bf16 v[16:19], v[52:55], v[104:107], v[16:19]
    v_mfma_f32_16x16x32_bf16 v[84:87], v[44:47], v[108:111], v[84:87]
    v_mfma_f32_16x16x32_bf16 v[20:23], v[52:55], v[108:111], v[20:23]
    s_waitcnt vmcnt(10)
    v_max3_u32 v5, v112, v113, v114
    v_max3_u32 v6, v116, v117, v118
    v_max3_u32 v5, v115, v119, v5
    v_max_u32 v5, v6, v5
    v_cmp_eq_u32 vcc, -1, v5
    ds_read_b128 v[40:43], v139 offset:12288
    ds_read_b128 v[48:51], v164 offset:12288
    ds_read_b128 v[44:47], v139 offset:13312
    ds_read_b128 v[52:55], v164 offset:13312
    s_cmp_lg_u64 vcc, 0
    s_cbranch_scc1 L_mega_kernel_retry_221
L_mega_kernel_cont_223:
    s_waitcnt lgkmcnt(4)
    v_mfma_f32_16x16x32_bf16 v[72:75], v[24:27], v[112:115], v[72:75]
    v_mfma_f32_16x16x32_bf16 v[8:11], v[32:35], v[112:115], v[8:11]
    v_mfma_f32_16x16x32_bf16 v[76:79], v[24:27], v[116:119], v[76:79]
    v_mfma_f32_16x16x32_bf16 v[12:15], v[32:35], v[116:119], v[12:15]
    v_mfma_f32_16x16x32_bf16 v[80:83], v[28:31], v[112:115], v[80:83]
    v_mfma_f32_16x16x32_bf16 v[16:19], v[36:39], v[112:115], v[16:19]
    v_mfma_f32_16x16x32_bf16 v[84:87], v[28:31], v[116:119], v[84:87]
    v_mfma_f32_16x16x32_bf16 v[20:23], v[36:39], v[116:119], v[20:23]
    s_waitcnt vmcnt(8)
    v_max3_u32 v5, v120, v121, v122
    v_max3_u32 v6, v124, v125, v126
    v_max3_u32 v5, v123, v127, v5
    v_max_u32 v5, v6, v5
    v_cmp_eq_u32 vcc, -1, v5
    ds_read_b128 v[24:27], v139 offset:16384
    ds_read_b128 v[32:35], v164 offset:16384
    ds_read_b128 v[28:31], v139 offset:17408
    ds_read_b128 v[36:39], v164 offset:17408
    s_cmp_lg_u64 vcc, 0
    s_cbranch_scc1 L_mega_kernel_retry_224
L_mega_kernel_cont_226:
    s_waitcnt lgkmcnt(4)
    v_mfma_f32_16x16x32_bf16 v[72:75], v[40:43], v[120:123], v[72:75]
    v_mfma_f32_16x16x32_bf16 v[8:11], v[48:51], v[120:123], v[8:11]
    v_mfma_f32_16x16x32_bf16 v[76:79], v[40:43], v[124:127], v[76:79]
    v_mfma_f32_16x16x32_bf16 v[12:15], v[48:51], v[124:127], v[12:15]
    v_mfma_f32_16x16x32_bf16 v[80:83], v[44:47], v[120:123], v[80:83]
    v_mfma_f32_16x16x32_bf16 v[16:19], v[52:55], v[120:123], v[16:19]
    v_mfma_f32_16x16x32_bf16 v[84:87], v[44:47], v[124:127], v[84:87]
    v_mfma_f32_16x16x32_bf16 v[20:23], v[52:55], v[124:127], v[20:23]
    s_waitcnt vmcnt(6)
    v_max3_u32 v5, v128, v129, v130
    v_max3_u32 v6, v132, v133, v134
    v_max3_u32 v5, v131, v135, v5
    v_max_u32 v5, v6, v5
    v_cmp_eq_u32 vcc, -1, v5
    ds_read_b128 v[40:43], v139 offset:20480
    ds_read_b128 v[48:51], v164 offset:20480
    ds_read_b128 v[44:47], v139 offset:21504
    ds_read_b128 v[52:55], v164 offset:21504
    s_cmp_lg_u64 vcc, 0
    s_cbranch_scc1 L_mega_kernel_retry_227
L_mega_kernel_cont_229:
    s_waitcnt lgkmcnt(4)
    v_mfma_f32_16x16x32_bf16 v[72:75], v[24:27], v[128:131], v[72:75]
    v_mfma_f32_16x16x32_bf16 v[8:11], v[32:35], v[128:131], v[8:11]
    v_mfma_f32_16x16x32_bf16 v[76:79], v[24:27], v[132:135], v[76:79]
    v_mfma_f32_16x16x32_bf16 v[12:15], v[32:35], v[132:135], v[12:15]
    v_mfma_f32_16x16x32_bf16 v[80:83], v[28:31], v[128:131], v[80:83]
    v_mfma_f32_16x16x32_bf16 v[16:19], v[36:39], v[128:131], v[16:19]
    v_mfma_f32_16x16x32_bf16 v[84:87], v[28:31], v[132:135], v[84:87]
    v_mfma_f32_16x16x32_bf16 v[20:23], v[36:39], v[132:135], v[20:23]
    s_waitcnt vmcnt(4)
    v_max3_u32 v5, v140, v141, v142
    v_max3_u32 v6, v144, v145, v146
    v_max3_u32 v5, v143, v147, v5
    v_max_u32 v5, v6, v5
    v_cmp_eq_u32 vcc, -1, v5
    ds_read_b128 v[24:27], v139 offset:24576
    ds_read_b128 v[32:35], v164 offset:24576
    ds_read_b128 v[28:31], v139 offset:25600
    ds_read_b128 v[36:39], v164 offset:25600
    s_cmp_lg_u64 vcc, 0
    s_cbranch_scc1 L_mega_kernel_retry_230
L_mega_kernel_cont_232:
    s_waitcnt lgkmcnt(4)
    v_mfma_f32_16x16x32_bf16 v[72:75], v[40:43], v[140:143], v[72:75]
    v_mfma_f32_16x16x32_bf16 v[8:11], v[48:51], v[140:143], v[8:11]
    v_mfma_f32_16x16x32_bf16 v[76:79], v[40:43], v[144:147], v[76:79]
    v_mfma_f32_16x16x32_bf16 v[12:15], v[48:51], v[144:147], v[12:15]
    v_mfma_f32_16x16x32_bf16 v[80:83], v[44:47], v[140:143], v[80:83]
    v_mfma_f32_16x16x32_bf16 v[16:19], v[52:55], v[140:143], v[16:19]
    v_mfma_f32_16x16x32_bf16 v[84:87], v[44:47], v[144:147], v[84:87]
    v_mfma_f32_16x16x32_bf16 v[20:23], v[52:55], v[144:147], v[20:23]
    s_waitcnt vmcnt(2)
    v_max3_u32 v5, v148, v149, v150
    v_max3_u32 v6, v152, v153, v154
    v_max3_u32 v5, v151, v155, v5
    v_max_u32 v5, v6, v5
    v_cmp_eq_u32 vcc, -1, v5
    ds_read_b128 v[40:43], v139 offset:28672
    ds_read_b128 v[48:51], v164 offset:28672
    ds_read_b128 v[44:47], v139 offset:29696
    ds_read_b128 v[52:55], v164 offset:29696
    s_cmp_lg_u64 vcc, 0
    s_cbranch_scc1 L_mega_kernel_retry_233
L_mega_kernel_cont_235:
    s_waitcnt lgkmcnt(4)
    v_mfma_f32_16x16x32_bf16 v[72:75], v[24:27], v[148:151], v[72:75]
    v_mfma_f32_16x16x32_bf16 v[8:11], v[32:35], v[148:151], v[8:11]
    v_mfma_f32_16x16x32_bf16 v[76:79], v[24:27], v[152:155], v[76:79]
    v_mfma_f32_16x16x32_bf16 v[12:15], v[32:35], v[152:155], v[12:15]
    v_mfma_f32_16x16x32_bf16 v[80:83], v[28:31], v[148:151], v[80:83]
    v_mfma_f32_16x16x32_bf16 v[16:19], v[36:39], v[148:151], v[16:19]
    v_mfma_f32_16x16x32_bf16 v[84:87], v[28:31], v[152:155], v[84:87]
    v_mfma_f32_16x16x32_bf16 v[20:23], v[36:39], v[152:155], v[20:23]
    s_waitcnt vmcnt(0)
    v_max3_u32 v5, v156, v157, v158
    v_max3_u32 v6, v160, v161, v162
    v_max3_u32 v5, v159, v163, v5
    v_max_u32 v5, v6, v5
    v_cmp_eq_u32 vcc, -1, v5
    s_nop 0
    s_cmp_lg_u64 vcc, 0
    s_cbranch_scc1 L_mega_kernel_retry_236
L_mega_kernel_cont_238:
    s_waitcnt lgkmcnt(0)
    v_mfma_f32_16x16x32_bf16 v[72:75], v[40:43], v[156:159], v[72:75]
    v_mfma_f32_16x16x32_bf16 v[8:11], v[48:51], v[156:159], v[8:11]
    v_mfma_f32_16x16x32_bf16 v[76:79], v[40:43], v[160:163], v[76:79]
    v_mfma_f32_16x16x32_bf16 v[12:15], v[48:51], v[160:163], v[12:15]
    v_mfma_f32_16x16x32_bf16 v[80:83], v[44:47], v[156:159], v[80:83]
    v_mfma_f32_16x16x32_bf16 v[16:19], v[52:55], v[156:159], v[16:19]
    v_mfma_f32_16x16x32_bf16 v[84:87], v[44:47], v[160:163], v[84:87]
    v_mfma_f32_16x16x32_bf16 v[20:23], v[52:55], v[160:163], v[20:23]
    s_lshl_b32 s56, s27, 12
    s_add_u32 s56, s56, 114688
    v_add_u32 v5, s56, v2
    s_xor_b32 s56, s27, 1
    s_lshl_b32 s56, s56, 12
    s_add_u32 s56, s56, 114688
    v_add_u32 v6, s56, v2
    s_nop 7
    ds_write_b128 v5, v[8:11] offset:0
    ds_write_b128 v5, v[12:15] offset:1024
    ds_write_b128 v5, v[16:19] offset:2048
    ds_write_b128 v5, v[20:23] offset:3072
    s_mov_b64 exec, 2
    ds_add_u32 v3, v1 offset:168
    s_mov_b64 exec, -1
    s_mov_b32 s57, 400000
L_mega_kernel_lp_239:
    ds_read_b32 v5, v3 offset:168
    s_waitcnt lgkmcnt(0)
    v_readfirstlane_b32 s56, v5
    s_sub_u32 s57, s57, 1
    s_cmp_ge_u32 s56, 4
    s_cbranch_scc1 L_mega_kernel_ok_240
    s_cmp_lg_u32 s57, 0
    s_cbranch_scc1 L_mega_kernel_lp_239
L_mega_kernel_ok_240:
    ds_read_b128 v[24:27], v6 offset:0
    ds_read_b128 v[28:31], v6 offset:1024
    ds_read_b128 v[32:35], v6 offset:2048
    ds_read_b128 v[36:39], v6 offset:3072
    s_waitcnt lgkmcnt(0)
    v_pk_add_f32 v[72:73], v[72:73], v[24:25]
    v_pk_add_f32 v[74:75], v[74:75], v[26:27]
    v_pk_add_f32 v[76:77], v[76:77], v[28:29]
    v_pk_add_f32 v[78:79], v[78:79], v[30:31]
    v_pk_add_f32 v[80:81], v[80:81], v[32:33]
    v_pk_add_f32 v[82:83], v[82:83], v[34:35]
    v_pk_add_f32 v[84:85], v[84:85], v[36:37]
    v_pk_add_f32 v[86:87], v[86:87], v[38:39]
    v_cvt_pk_bf16_f32 v96, v72, v73
    v_cvt_pk_bf16_f32 v97, v74, v75
    v_cvt_pk_bf16_f32 v98, v80, v81
    v_cvt_pk_bf16_f32 v99, v82, v83
    v_cvt_pk_bf16_f32 v100, v76, v77
    v_cvt_pk_bf16_f32 v101, v78, v79
    v_cvt_pk_bf16_f32 v102, v84, v85
    v_cvt_pk_bf16_f32 v103, v86, v87
    s_nop 1
    v_permlane16_swap_b32 v96, v98
    v_permlane16_swap_b32 v97, v99
    v_permlane16_swap_b32 v100, v102
    v_permlane16_swap_b32 v101, v103
    s_nop 1
    buffer_store_dwordx4 v[96:99], v137, s[12:15], s31 offen
    buffer_store_dwordx4 v[100:103], v137, s[12:15], s32 offen
    s_endpgm
L_mega_kernel_retry_215:
    s_mov_b32 s63, 0
    s_branch L_mega_kernel_reload_241
L_mega_kernel_retry_218:
    s_mov_b32 s63, 1
    s_branch L_mega_kernel_reload_241
L_mega_kernel_retry_221:
    s_mov_b32 s63, 2
    s_branch L_mega_kernel_reload_241
L_mega_kernel_retry_224:
    s_mov_b32 s63, 3
    s_branch L_mega_kernel_reload_241
L_mega_kernel_retry_227:
    s_mov_b32 s63, 4
    s_branch L_mega_kernel_reload_241
L_mega_kernel_retry_230:
    s_mov_b32 s63, 5
    s_branch L_mega_kernel_reload_241
L_mega_kernel_retry_233:
    s_mov_b32 s63, 6
    s_branch L_mega_kernel_reload_241
L_mega_kernel_retry_236:
    s_mov_b32 s63, 7
    s_branch L_mega_kernel_reload_241
L_mega_kernel_reload_241:
    s_sub_u32 s62, s62, 1
    s_add_u32 s56, s28, 0
    buffer_load_dwordx4 v[96:99], v138, s[4:7], s56 offen offset:0 sc1
    s_add_u32 s56, s28, 0
    buffer_load_dwordx4 v[100:103], v138, s[4:7], s56 offen offset:256 sc1
    s_add_u32 s56, s28, 2048
    buffer_load_dwordx4 v[104:107], v138, s[4:7], s56 offen offset:0 sc1
    s_add_u32 s56, s28, 2048
    buffer_load_dwordx4 v[108:111], v138, s[4:7], s56 offen offset:256 sc1
    s_add_u32 s56, s28, 4096
    buffer_load_dwordx4 v[112:115], v138, s[4:7], s56 offen offset:0 sc1
    s_add_u32 s56, s28, 4096
    buffer_load_dwordx4 v[116:119], v138, s[4:7], s56 offen offset:256 sc1
    s_add_u32 s56, s28, 6144
    buffer_load_dwordx4 v[120:123], v138, s[4:7], s56 offen offset:0 sc1
    s_add_u32 s56, s28, 6144
    buffer_load_dwordx4 v[124:127], v138, s[4:7], s56 offen offset:256 sc1
    s_add_u32 s56, s28, 8192
    buffer_load_dwordx4 v[128:131], v138, s[4:7], s56 offen offset:0 sc1
    s_add_u32 s56, s28, 8192
    buffer_load_dwordx4 v[132:135], v138, s[4:7], s56 offen offset:256 sc1
    s_add_u32 s56, s28, 10240
    buffer_load_dwordx4 v[140:143], v138, s[4:7], s56 offen offset:0 sc1
    s_add_u32 s56, s28, 10240
    buffer_load_dwordx4 v[144:147], v138, s[4:7], s56 offen offset:256 sc1
    s_add_u32 s56, s28, 12288
    buffer_load_dwordx4 v[148:151], v138, s[4:7], s56 offen offset:0 sc1
    s_add_u32 s56, s28, 12288
    buffer_load_dwordx4 v[152:155], v138, s[4:7], s56 offen offset:256 sc1
    s_add_u32 s56, s28, 14336
    buffer_load_dwordx4 v[156:159], v138, s[4:7], s56 offen offset:0 sc1
    s_add_u32 s56, s28, 14336
    buffer_load_dwordx4 v[160:163], v138, s[4:7], s56 offen offset:256 sc1
    s_waitcnt vmcnt(0)
    s_cmp_eq_u32 s63, 0
    s_cbranch_scc1 L_mega_kernel_back_216_r
    s_cmp_eq_u32 s63, 1
    s_cbranch_scc1 L_mega_kernel_back_219_r
    s_cmp_eq_u32 s63, 2
    s_cbranch_scc1 L_mega_kernel_back_222_r
    s_cmp_eq_u32 s63, 3
    s_cbranch_scc1 L_mega_kernel_back_225_r
    s_cmp_eq_u32 s63, 4
    s_cbranch_scc1 L_mega_kernel_back_228_r
    s_cmp_eq_u32 s63, 5
    s_cbranch_scc1 L_mega_kernel_back_231_r
    s_cmp_eq_u32 s63, 6
    s_cbranch_scc1 L_mega_kernel_back_234_r
    s_cmp_eq_u32 s63, 7
    s_cbranch_scc1 L_mega_kernel_back_237_r
L_mega_kernel_back_216_r:
    v_max3_u32 v5, v96, v97, v98
    v_max3_u32 v6, v100, v101, v102
    v_max3_u32 v5, v99, v103, v5
    v_max_u32 v5, v6, v5
    v_cmp_eq_u32 vcc, -1, v5
    s_cmp_eq_u32 s62, 0
    s_cbranch_scc1 L_mega_kernel_cont_217
    s_cmp_lg_u64 vcc, 0
    s_cbranch_scc1 L_mega_kernel_retry_215
    s_branch L_mega_kernel_cont_217
L_mega_kernel_back_219_r:
    v_max3_u32 v5, v104, v105, v106
    v_max3_u32 v6, v108, v109, v110
    v_max3_u32 v5, v107, v111, v5
    v_max_u32 v5, v6, v5
    v_cmp_eq_u32 vcc, -1, v5
    s_cmp_eq_u32 s62, 0
    s_cbranch_scc1 L_mega_kernel_cont_220
    s_cmp_lg_u64 vcc, 0
    s_cbranch_scc1 L_mega_kernel_retry_218
    s_branch L_mega_kernel_cont_220
L_mega_kernel_back_222_r:
    v_max3_u32 v5, v112, v113, v114
    v_max3_u32 v6, v116, v117, v118
    v_max3_u32 v5, v115, v119, v5
    v_max_u32 v5, v6, v5
    v_cmp_eq_u32 vcc, -1, v5
    s_cmp_eq_u32 s62, 0
    s_cbranch_scc1 L_mega_kernel_cont_223
    s_cmp_lg_u64 vcc, 0
    s_cbranch_scc1 L_mega_kernel_retry_221
    s_branch L_mega_kernel_cont_223
L_mega_kernel_back_225_r:
    v_max3_u32 v5, v120, v121, v122
    v_max3_u32 v6, v124, v125, v126
    v_max3_u32 v5, v123, v127, v5
    v_max_u32 v5, v6, v5
    v_cmp_eq_u32 vcc, -1, v5
    s_cmp_eq_u32 s62, 0
    s_cbranch_scc1 L_mega_kernel_cont_226
    s_cmp_lg_u64 vcc, 0
    s_cbranch_scc1 L_mega_kernel_retry_224
    s_branch L_mega_kernel_cont_226
L_mega_kernel_back_228_r:
    v_max3_u32 v5, v128, v129, v130
    v_max3_u32 v6, v132, v133, v134
    v_max3_u32 v5, v131, v135, v5
    v_max_u32 v5, v6, v5
    v_cmp_eq_u32 vcc, -1, v5
    s_cmp_eq_u32 s62, 0
    s_cbranch_scc1 L_mega_kernel_cont_229
    s_cmp_lg_u64 vcc, 0
    s_cbranch_scc1 L_mega_kernel_retry_227
    s_branch L_mega_kernel_cont_229
L_mega_kernel_back_231_r:
    v_max3_u32 v5, v140, v141, v142
    v_max3_u32 v6, v144, v145, v146
    v_max3_u32 v5, v143, v147, v5
    v_max_u32 v5, v6, v5
    v_cmp_eq_u32 vcc, -1, v5
    s_cmp_eq_u32 s62, 0
    s_cbranch_scc1 L_mega_kernel_cont_232
    s_cmp_lg_u64 vcc, 0
    s_cbranch_scc1 L_mega_kernel_retry_230
    s_branch L_mega_kernel_cont_232
L_mega_kernel_back_234_r:
    v_max3_u32 v5, v148, v149, v150
    v_max3_u32 v6, v152, v153, v154
    v_max3_u32 v5, v151, v155, v5
    v_max_u32 v5, v6, v5
    v_cmp_eq_u32 vcc, -1, v5
    s_cmp_eq_u32 s62, 0
    s_cbranch_scc1 L_mega_kernel_cont_235
    s_cmp_lg_u64 vcc, 0
    s_cbranch_scc1 L_mega_kernel_retry_233
    s_branch L_mega_kernel_cont_235
L_mega_kernel_back_237_r:
    v_max3_u32 v5, v156, v157, v158
    v_max3_u32 v6, v160, v161, v162
    v_max3_u32 v5, v159, v163, v5
    v_max_u32 v5, v6, v5
    v_cmp_eq_u32 vcc, -1, v5
    s_cmp_eq_u32 s62, 0
    s_cbranch_scc1 L_mega_kernel_cont_238
    s_cmp_lg_u64 vcc, 0
    s_cbranch_scc1 L_mega_kernel_retry_236
    s_branch L_mega_kernel_cont_238
L_mega_kernel_eslow_195:
    s_waitcnt lgkmcnt(0)
    s_mov_b32 s57, 400000
L_mega_kernel_lp_242:
    ds_read_b32 v5, v3 offset:8
    s_waitcnt lgkmcnt(0)
    v_readfirstlane_b32 s56, v5
    s_sub_u32 s57, s57, 1
    s_cmp_ge_u32 s56, 1
    s_cbranch_scc1 L_mega_kernel_ok_243
    s_sleep 1
    s_cmp_lg_u32 s57, 0
    s_cbranch_scc1 L_mega_kernel_lp_242
L_mega_kernel_ok_243:
    s_mov_b32 s57, 400000
L_mega_kernel_lp_244:
    ds_read_b32 v5, v3 offset:20
    s_waitcnt lgkmcnt(0)
    v_readfirstlane_b32 s56, v5
    s_sub_u32 s57, s57, 1
    s_cmp_ge_u32 s56, 1
    s_cbranch_scc1 L_mega_kernel_ok_245
    s_sleep 1
    s_cmp_lg_u32 s57, 0
    s_cbranch_scc1 L_mega_kernel_lp_244
L_mega_kernel_ok_245:
    v_and_b32 v6, 15, v1
    s_lshl_b32 s56, s27, 5
    v_add_u32 v7, s56, v6
    v_lshlrev_b32 v7, 3, v7
    v_add_u32 v7, 149760, v7
    ds_read_b64 v[160:161], v7
    ds_read_b64 v[162:163], v7 offset:128
    v_lshlrev_b32 v6, 2, v6
    v_mov_b32 v5, 128
    v_cmp_gt_u32 vcc, 16, v1
    v_add_u32 v7, 64, v6
    s_nop 0
    v_cndmask_b32 v164, v5, v6, vcc
    v_cndmask_b32 v165, v5, v7, vcc
    v_add_u32 v164, 150784, v164
    v_add_u32 v165, 150784, v165
    s_mov_b64 s[58:59], vcc
    v_mov_b32 v121, 0
    v_mov_b32 v122, 0
    v_mov_b32 v123, 0
    v_mov_b32 v125, 0
    v_mov_b32 v126, 0
    v_mov_b32 v127, 0
    v_mov_b32 v129, 0
    v_mov_b32 v130, 0
    v_mov_b32 v131, 0
    v_mov_b32 v133, 0
    v_mov_b32 v134, 0
    v_mov_b32 v135, 0
    v_mov_b32 v137, 0
    v_mov_b32 v138, 0
    v_mov_b32 v139, 0
    v_mov_b32 v141, 0
    v_mov_b32 v142, 0
    v_mov_b32 v143, 0
    v_mov_b32 v145, 0
    v_mov_b32 v146, 0
    v_mov_b32 v147, 0
    v_mov_b32 v149, 0
    v_mov_b32 v150, 0
    v_mov_b32 v151, 0
    ds_read_b32 v120, v164 offset:0
    ds_read_b32 v124, v165 offset:0
    ds_read_b32 v128, v164 offset:256
    ds_read_b32 v132, v165 offset:256
    ds_read_b32 v136, v164 offset:512
    ds_read_b32 v140, v165 offset:512
    s_waitcnt lgkmcnt(6)
    v_lshrrev_b32 v5, 16, v160
    v_or_b32 v5, v5, v160
    v_cndmask_b32 v144, 0, v5, s[58:59]
    v_mul_f32 v160, v161, v161
    v_lshrrev_b32 v5, 16, v162
    v_or_b32 v5, v5, v162
    v_cndmask_b32 v148, 0, v5, s[58:59]
    v_mul_f32 v162, v163, v163
    s_nop 1
    s_waitcnt lgkmcnt(5)
    v_mfma_f32_16x16x32_bf16 v[8:11], v[120:123], v[144:147], v[8:11]
    v_mfma_f32_16x16x32_bf16 v[12:15], v[120:123], v[148:151], v[12:15]
    ds_read_b32 v120, v164 offset:768
    s_waitcnt lgkmcnt(5)
    v_mfma_f32_16x16x32_bf16 v[16:19], v[124:127], v[144:147], v[16:19]
    v_mfma_f32_16x16x32_bf16 v[20:23], v[124:127], v[148:151], v[20:23]
    ds_read_b32 v124, v165 offset:768
    s_waitcnt lgkmcnt(5)
    v_mfma_f32_16x16x32_bf16 v[24:27], v[128:131], v[144:147], v[24:27]
    v_mfma_f32_16x16x32_bf16 v[28:31], v[128:131], v[148:151], v[28:31]
    ds_read_b32 v128, v164 offset:1024
    s_waitcnt lgkmcnt(5)
    v_mfma_f32_16x16x32_bf16 v[32:35], v[132:135], v[144:147], v[32:35]
    v_mfma_f32_16x16x32_bf16 v[36:39], v[132:135], v[148:151], v[36:39]
    ds_read_b32 v132, v165 offset:1024
    s_waitcnt lgkmcnt(5)
    v_mfma_f32_16x16x32_bf16 v[40:43], v[136:139], v[144:147], v[40:43]
    v_mfma_f32_16x16x32_bf16 v[44:47], v[136:139], v[148:151], v[44:47]
    ds_read_b32 v136, v164 offset:1280
    s_waitcnt lgkmcnt(5)
    v_mfma_f32_16x16x32_bf16 v[48:51], v[140:143], v[144:147], v[48:51]
    v_mfma_f32_16x16x32_bf16 v[52:55], v[140:143], v[148:151], v[52:55]
    ds_read_b32 v140, v165 offset:1280
    s_waitcnt lgkmcnt(5)
    v_mfma_f32_16x16x32_bf16 v[56:59], v[120:123], v[144:147], v[56:59]
    v_mfma_f32_16x16x32_bf16 v[60:63], v[120:123], v[148:151], v[60:63]
    ds_read_b32 v120, v164 offset:1536
    s_waitcnt lgkmcnt(5)
    v_mfma_f32_16x16x32_bf16 v[64:67], v[124:127], v[144:147], v[64:67]
    v_mfma_f32_16x16x32_bf16 v[68:71], v[124:127], v[148:151], v[68:71]
    ds_read_b32 v124, v165 offset:1536
    s_waitcnt lgkmcnt(5)
    v_mfma_f32_16x16x32_bf16 v[72:75], v[128:131], v[144:147], v[72:75]
    v_mfma_f32_16x16x32_bf16 v[76:79], v[128:131], v[148:151], v[76:79]
    s_waitcnt lgkmcnt(4)
    v_mfma_f32_16x16x32_bf16 v[80:83], v[132:135], v[144:147], v[80:83]
    v_mfma_f32_16x16x32_bf16 v[84:87], v[132:135], v[148:151], v[84:87]
    s_waitcnt lgkmcnt(3)
    v_mfma_f32_16x16x32_bf16 v[88:91], v[136:139], v[144:147], v[88:91]
    v_mfma_f32_16x16x32_bf16 v[92:95], v[136:139], v[148:151], v[92:95]
    s_waitcnt lgkmcnt(2)
    v_mfma_f32_16x16x32_bf16 v[96:99], v[140:143], v[144:147], v[96:99]
    v_mfma_f32_16x16x32_bf16 v[100:103], v[140:143], v[148:151], v[100:103]
    s_waitcnt lgkmcnt(1)
    v_mfma_f32_16x16x32_bf16 v[104:107], v[120:123], v[144:147], v[104:107]
    v_mfma_f32_16x16x32_bf16 v[108:111], v[120:123], v[148:151], v[108:111]
    s_waitcnt lgkmcnt(0)
    v_mfma_f32_16x16x32_bf16 v[112:115], v[124:127], v[144:147], v[112:115]
    v_mfma_f32_16x16x32_bf16 v[116:119], v[124:127], v[148:151], v[116:119]
    s_lshl_b32 s56, s21, 2
    s_add_u32 s56, s56, s27
    s_mul_i32 s56, s56, 112
    s_mul_i32 s57, s22, 7
    s_lshr_b32 s57, s57, 1
    s_add_u32 s56, s56, s57
    s_lshl_b32 s56, s56, 10
    s_add_u32 s33, s56, 3145728
    s_add_u32 s34, s33, 57344
    v_add_u32 v5, 8, v2
    s_nop 4
    s_bitcmp1_b32 s22, 0
    s_cbranch_scc1 L_mega_kernel_hodd_246
    v_max_f32 v8, 0, v8
    v_max_f32 v9, 0, v9
    v_max_f32 v10, 0, v10
    v_max_f32 v11, 0, v11
    v_pk_mul_f32 v[8:9], v[8:9], v[16:17]
    v_pk_mul_f32 v[10:11], v[10:11], v[18:19]
    v_max_f32 v24, 0, v24
    v_max_f32 v25, 0, v25
    v_max_f32 v26, 0, v26
    v_max_f32 v27, 0, v27
    v_pk_mul_f32 v[24:25], v[24:25], v[32:33]
    v_pk_mul_f32 v[26:27], v[26:27], v[34:35]
    v_cvt_pk_bf16_f32 v8, v8, v9
    v_cvt_pk_bf16_f32 v9, v10, v11
    v_cvt_pk_bf16_f32 v10, v24, v25
    v_cvt_pk_bf16_f32 v11, v26, v27
    buffer_store_dwordx4 v[8:11], v2, s[4:7], s33 offen offset:0 sc1
    v_max_f32 v12, 0, v12
    v_max_f32 v13, 0, v13
    v_max_f32 v14, 0, v14
    v_max_f32 v15, 0, v15
    v_pk_mul_f32 v[12:13], v[12:13], v[20:21]
    v_pk_mul_f32 v[14:15], v[14:15], v[22:23]
    v_max_f32 v28, 0, v28
    v_max_f32 v29, 0, v29
    v_max_f32 v30, 0, v30
    v_max_f32 v31, 0, v31
    v_pk_mul_f32 v[28:29], v[28:29], v[36:37]
    v_pk_mul_f32 v[30:31], v[30:31], v[38:39]
    v_cvt_pk_bf16_f32 v12, v12, v13
    v_cvt_pk_bf16_f32 v13, v14, v15
    v_cvt_pk_bf16_f32 v14, v28, v29
    v_cvt_pk_bf16_f32 v15, v30, v31
    buffer_store_dwordx4 v[12:15], v2, s[4:7], s34 offen offset:0 sc1
    v_max_f32 v40, 0, v40
    v_max_f32 v41, 0, v41
    v_max_f32 v42, 0, v42
    v_max_f32 v43, 0, v43
    v_pk_mul_f32 v[40:41], v[40:41], v[48:49]
    v_pk_mul_f32 v[42:43], v[42:43], v[50:51]
    v_max_f32 v56, 0, v56
    v_max_f32 v57, 0, v57
    v_max_f32 v58, 0, v58
    v_max_f32 v59, 0, v59
    v_pk_mul_f32 v[56:57], v[56:57], v[64:65]
    v_pk_mul_f32 v[58:59], v[58:59], v[66:67]
    v_cvt_pk_bf16_f32 v40, v40, v41
    v_cvt_pk_bf16_f32 v41, v42, v43
    v_cvt_pk_bf16_f32 v42, v56, v57
    v_cvt_pk_bf16_f32 v43, v58, v59
    buffer_store_dwordx4 v[40:43], v2, s[4:7], s33 offen offset:1024 sc1
    v_max_f32 v44, 0, v44
    v_max_f32 v45, 0, v45
    v_max_f32 v46, 0, v46
    v_max_f32 v47, 0, v47
    v_pk_mul_f32 v[44:45], v[44:45], v[52:53]
    v_pk_mul_f32 v[46:47], v[46:47], v[54:55]
    v_max_f32 v60, 0, v60
    v_max_f32 v61, 0, v61
    v_max_f32 v62, 0, v62
    v_max_f32 v63, 0, v63
    v_pk_mul_f32 v[60:61], v[60:61], v[68:69]
    v_pk_mul_f32 v[62:63], v[62:63], v[70:71]
    v_cvt_pk_bf16_f32 v44, v44, v45
    v_cvt_pk_bf16_f32 v45, v46, v47
    v_cvt_pk_bf16_f32 v46, v60, v61
    v_cvt_pk_bf16_f32 v47, v62, v63
    buffer_store_dwordx4 v[44:47], v2, s[4:7], s34 offen offset:1024 sc1
    v_max_f32 v72, 0, v72
    v_max_f32 v73, 0, v73
    v_max_f32 v74, 0, v74
    v_max_f32 v75, 0, v75
    v_pk_mul_f32 v[72:73], v[72:73], v[80:81]
    v_pk_mul_f32 v[74:75], v[74:75], v[82:83]
    v_max_f32 v88, 0, v88
    v_max_f32 v89, 0, v89
    v_max_f32 v90, 0, v90
    v_max_f32 v91, 0, v91
    v_pk_mul_f32 v[88:89], v[88:89], v[96:97]
    v_pk_mul_f32 v[90:91], v[90:91], v[98:99]
    v_cvt_pk_bf16_f32 v72, v72, v73
    v_cvt_pk_bf16_f32 v73, v74, v75
    v_cvt_pk_bf16_f32 v74, v88, v89
    v_cvt_pk_bf16_f32 v75, v90, v91
    buffer_store_dwordx4 v[72:75], v2, s[4:7], s33 offen offset:2048 sc1
    v_max_f32 v76, 0, v76
    v_max_f32 v77, 0, v77
    v_max_f32 v78, 0, v78
    v_max_f32 v79, 0, v79
    v_pk_mul_f32 v[76:77], v[76:77], v[84:85]
    v_pk_mul_f32 v[78:79], v[78:79], v[86:87]
    v_max_f32 v92, 0, v92
    v_max_f32 v93, 0, v93
    v_max_f32 v94, 0, v94
    v_max_f32 v95, 0, v95
    v_pk_mul_f32 v[92:93], v[92:93], v[100:101]
    v_pk_mul_f32 v[94:95], v[94:95], v[102:103]
    v_cvt_pk_bf16_f32 v76, v76, v77
    v_cvt_pk_bf16_f32 v77, v78, v79
    v_cvt_pk_bf16_f32 v78, v92, v93
    v_cvt_pk_bf16_f32 v79, v94, v95
    buffer_store_dwordx4 v[76:79], v2, s[4:7], s34 offen offset:2048 sc1
    v_max_f32 v104, 0, v104
    v_max_f32 v105, 0, v105
    v_max_f32 v106, 0, v106
    v_max_f32 v107, 0, v107
    v_pk_mul_f32 v[104:105], v[104:105], v[112:113]
    v_pk_mul_f32 v[106:107], v[106:107], v[114:115]
    v_cvt_pk_bf16_f32 v104, v104, v105
    v_cvt_pk_bf16_f32 v105, v106, v107
    buffer_store_dwordx2 v[104:105], v2, s[4:7], s33 offen offset:3072 sc1
    v_max_f32 v108, 0, v108
    v_max_f32 v109, 0, v109
    v_max_f32 v110, 0, v110
    v_max_f32 v111, 0, v111
    v_pk_mul_f32 v[108:109], v[108:109], v[116:117]
    v_pk_mul_f32 v[110:111], v[110:111], v[118:119]
    v_cvt_pk_bf16_f32 v108, v108, v109
    v_cvt_pk_bf16_f32 v109, v110, v111
    buffer_store_dwordx2 v[108:109], v2, s[4:7], s34 offen offset:3072 sc1
    s_branch L_mega_kernel_hend_247
L_mega_kernel_hodd_246:
    v_max_f32 v8, 0, v8
    v_max_f32 v9, 0, v9
    v_max_f32 v10, 0, v10
    v_max_f32 v11, 0, v11
    v_pk_mul_f32 v[8:9], v[8:9], v[16:17]
    v_pk_mul_f32 v[10:11], v[10:11], v[18:19]
    v_cvt_pk_bf16_f32 v8, v8, v9
    v_cvt_pk_bf16_f32 v9, v10, v11
    buffer_store_dwordx2 v[8:9], v5, s[4:7], s33 offen offset:0 sc1
    v_max_f32 v12, 0, v12
    v_max_f32 v13, 0, v13
    v_max_f32 v14, 0, v14
    v_max_f32 v15, 0, v15
    v_pk_mul_f32 v[12:13], v[12:13], v[20:21]
    v_pk_mul_f32 v[14:15], v[14:15], v[22:23]
    v_cvt_pk_bf16_f32 v12, v12, v13
    v_cvt_pk_bf16_f32 v13, v14, v15
    buffer_store_dwordx2 v[12:13], v5, s[4:7], s34 offen offset:0 sc1
    v_max_f32 v24, 0, v24
    v_max_f32 v25, 0, v25
    v_max_f32 v26, 0, v26
    v_max_f32 v27, 0, v27
    v_pk_mul_f32 v[24:25], v[24:25], v[32:33]
    v_pk_mul_f32 v[26:27], v[26:27], v[34:35]
    v_max_f32 v40, 0, v40
    v_max_f32 v41, 0, v41
    v_max_f32 v42, 0, v42
    v_max_f32 v43, 0, v43
    v_pk_mul_f32 v[40:41], v[40:41], v[48:49]
    v_pk_mul_f32 v[42:43], v[42:43], v[50:51]
    v_cvt_pk_bf16_f32 v24, v24, v25
    v_cvt_pk_bf16_f32 v25, v26, v27
    v_cvt_pk_bf16_f32 v26, v40, v41
    v_cvt_pk_bf16_f32 v27, v42, v43
    buffer_store_dwordx4 v[24:27], v2, s[4:7], s33 offen offset:1024 sc1
    v_max_f32 v28, 0, v28
    v_max_f32 v29, 0, v29
    v_max_f32 v30, 0, v30
    v_max_f32 v31, 0, v31
    v_pk_mul_f32 v[28:29], v[28:29], v[36:37]
    v_pk_mul_f32 v[30:31], v[30:31], v[38:39]
    v_max_f32 v44, 0, v44
    v_max_f32 v45, 0, v45
    v_max_f32 v46, 0, v46
    v_max_f32 v47, 0, v47
    v_pk_mul_f32 v[44:45], v[44:45], v[52:53]
    v_pk_mul_f32 v[46:47], v[46:47], v[54:55]
    v_cvt_pk_bf16_f32 v28, v28, v29
    v_cvt_pk_bf16_f32 v29, v30, v31
    v_cvt_pk_bf16_f32 v30, v44, v45
    v_cvt_pk_bf16_f32 v31, v46, v47
    buffer_store_dwordx4 v[28:31], v2, s[4:7], s34 offen offset:1024 sc1
    v_max_f32 v56, 0, v56
    v_max_f32 v57, 0, v57
    v_max_f32 v58, 0, v58
    v_max_f32 v59, 0, v59
    v_pk_mul_f32 v[56:57], v[56:57], v[64:65]
    v_pk_mul_f32 v[58:59], v[58:59], v[66:67]
    v_max_f32 v72, 0, v72
    v_max_f32 v73, 0, v73
    v_max_f32 v74, 0, v74
    v_max_f32 v75, 0, v75
    v_pk_mul_f32 v[72:73], v[72:73], v[80:81]
    v_pk_mul_f32 v[74:75], v[74:75], v[82:83]
    v_cvt_pk_bf16_f32 v56, v56, v57
    v_cvt_pk_bf16_f32 v57, v58, v59
    v_cvt_pk_bf16_f32 v58, v72, v73
    v_cvt_pk_bf16_f32 v59, v74, v75
    buffer_store_dwordx4 v[56:59], v2, s[4:7], s33 offen offset:2048 sc1
    v_max_f32 v60, 0, v60
    v_max_f32 v61, 0, v61
    v_max_f32 v62, 0, v62
    v_max_f32 v63, 0, v63
    v_pk_mul_f32 v[60:61], v[60:61], v[68:69]
    v_pk_mul_f32 v[62:63], v[62:63], v[70:71]
    v_max_f32 v76, 0, v76
    v_max_f32 v77, 0, v77
    v_max_f32 v78, 0, v78
    v_max_f32 v79, 0, v79
    v_pk_mul_f32 v[76:77], v[76:77], v[84:85]
    v_pk_mul_f32 v[78:79], v[78:79], v[86:87]
    v_cvt_pk_bf16_f32 v60, v60, v61
    v_cvt_pk_bf16_f32 v61, v62, v63
    v_cvt_pk_bf16_f32 v62, v76, v77
    v_cvt_pk_bf16_f32 v63, v78, v79
    buffer_store_dwordx4 v[60:63], v2, s[4:7], s34 offen offset:2048 sc1
    v_max_f32 v88, 0, v88
    v_max_f32 v89, 0, v89
    v_max_f32 v90, 0, v90
    v_max_f32 v91, 0, v91
    v_pk_mul_f32 v[88:89], v[88:89], v[96:97]
    v_pk_mul_f32 v[90:91], v[90:91], v[98:99]
    v_max_f32 v104, 0, v104
    v_max_f32 v105, 0, v105
    v_max_f32 v106, 0, v106
    v_max_f32 v107, 0, v107
    v_pk_mul_f32 v[104:105], v[104:105], v[112:113]
    v_pk_mul_f32 v[106:107], v[106:107], v[114:115]
    v_cvt_pk_bf16_f32 v88, v88, v89
    v_cvt_pk_bf16_f32 v89, v90, v91
    v_cvt_pk_bf16_f32 v90, v104, v105
    v_cvt_pk_bf16_f32 v91, v106, v107
    buffer_store_dwordx4 v[88:91], v2, s[4:7], s33 offen offset:3072 sc1
    v_max_f32 v92, 0, v92
    v_max_f32 v93, 0, v93
    v_max_f32 v94, 0, v94
    v_max_f32 v95, 0, v95
    v_pk_mul_f32 v[92:93], v[92:93], v[100:101]
    v_pk_mul_f32 v[94:95], v[94:95], v[102:103]
    v_max_f32 v108, 0, v108
    v_max_f32 v109, 0, v109
    v_max_f32 v110, 0, v110
    v_max_f32 v111, 0, v111
    v_pk_mul_f32 v[108:109], v[108:109], v[116:117]
    v_pk_mul_f32 v[110:111], v[110:111], v[118:119]
    v_cvt_pk_bf16_f32 v92, v92, v93
    v_cvt_pk_bf16_f32 v93, v94, v95
    v_cvt_pk_bf16_f32 v94, v108, v109
    v_cvt_pk_bf16_f32 v95, v110, v111
    buffer_store_dwordx4 v[92:95], v2, s[4:7], s34 offen offset:3072 sc1
L_mega_kernel_hend_247:
    s_branch L_mega_kernel_eend_196
L_mega_kernel_roleP_7:
    s_sub_u32 s27, s20, 8
    v_mov_b32 v3, 149504
    s_setprio 2
    s_cmp_lg_u32 s27, 0
    s_cbranch_scc1 L_mega_kernel_nz_248
    v_lshlrev_b32 v8, 2, v1
    v_add_u32 v8, 149504, v8
    v_mov_b32 v9, 0
    ds_write_b32 v8, v9
    s_waitcnt lgkmcnt(0)
L_mega_kernel_nz_248:
    v_lshrrev_b32 v8, 3, v1
    v_lshlrev_b32 v8, 10, v8
    v_lshrrev_b32 v9, 4, v1
    v_and_b32 v10, 7, v1
    v_xor_b32 v11, v9, v10
    v_lshlrev_b32 v11, 4, v11
    v_add_u32 v6, v8, v11
    v_add_u32 v12, 4, v9
    v_xor_b32 v11, v12, v10
    v_lshlrev_b32 v11, 4, v11
    v_add_u32 v7, v8, v11
    v_and_b32 v9, 1, v9
    v_lshlrev_b32 v9, 2, v9
    v_xor_b32 v11, v9, v10
    v_lshlrev_b32 v11, 4, v11
    v_add_u32 v24, v8, v11
    s_lshl_b32 s56, s27, 2
    s_add_u32 s57, s56, 149600
    v_mov_b32 v27, s57
    s_add_u32 s57, s56, 149616
    v_mov_b32 v28, s57
    v_min_u32 v5, 3, v1
    v_lshlrev_b32 v5, 2, v5
    v_add_u32 v29, 149584, v5
    v_add_u32 v5, 149568, v5
    s_getpc_b64 s[80:81]
L_mega_kernel_tabpc_249:
    s_add_u32 s3, s80, L_mega_kernel_tab_2-L_mega_kernel_tabpc_249
    s_addc_u32 s81, s81, 0
    v_mov_b32 v15, s81
    s_waitcnt lgkmcnt(0)
    s_mov_b32 s6, 268435456
    s_mov_b32 s7, 0x20000
    s_mov_b32 s8, s36
    s_mov_b32 s9, s37
    s_mov_b32 s10, 2097152
    s_mov_b32 s11, 0x20000
    s_mov_b32 s16, s38
    s_mov_b32 s17, s39
    s_mov_b32 s18, 524288
    s_mov_b32 s19, 0x20000
    s_lshl_b32 s39, s27, 2
    s_add_u32 s39, s39, 149504
    s_and_b32 s56, s22, 3
    s_lshl_b32 s56, s56, 1
    s_add_u32 s28, s21, s56
    s_and_b32 s28, s28, 7
    s_lshl_b32 s29, s24, 16
    s_lshl_b32 s30, s25, 7
    s_lshl_b32 s63, s27, 11
    s_lshl_b32 s56, s27, 14
    s_add_u32 s29, s29, s56
    s_add_u32 s30, s30, s56
    s_barrier
    s_add_u32 s59, s28, 0
    s_and_b32 s59, s59, 7
    s_lshl_b32 s60, s59, 7
    s_add_u32 s60, s60, s29
    s_lshl_b32 s61, s59, 16
    s_add_u32 s61, s61, s30
    s_add_u32 m0, s63, 81920
    s_add_u32 s56, s60, 0
    buffer_load_dwordx4 v6, s[8:11], s56 offen lds
    s_add_u32 m0, s63, 82944
    s_add_u32 s56, s60, 8192
    buffer_load_dwordx4 v7, s[8:11], s56 offen lds
    s_add_u32 m0, s63, 90112
    s_add_u32 s56, s61, 0
    buffer_load_dwordx4 v24, s[16:19], s56 offen lds
    s_add_u32 m0, s63, 91136
    s_add_u32 s56, s61, 8192
    buffer_load_dwordx4 v24, s[16:19], s56 offen lds
    s_add_u32 m0, s39, 96
    s_add_u32 s82, s3, 4
    s_mov_b64 exec, 1
    v_mov_b32 v14, s82
    global_load_lds_dword v[14:15], off
    s_mov_b64 exec, -1
    s_add_u32 s59, s28, 1
    s_and_b32 s59, s59, 7
    s_lshl_b32 s60, s59, 7
    s_add_u32 s60, s60, s29
    s_lshl_b32 s61, s59, 16
    s_add_u32 s61, s61, s30
    s_add_u32 m0, s63, 0
    s_add_u32 s56, s60, 0
    buffer_load_dwordx4 v6, s[8:11], s56 offen lds
    s_add_u32 m0, s63, 1024
    s_add_u32 s56, s60, 8192
    buffer_load_dwordx4 v7, s[8:11], s56 offen lds
    s_add_u32 m0, s63, 8192
    s_add_u32 s56, s61, 0
    buffer_load_dwordx4 v24, s[16:19], s56 offen lds
    s_add_u32 m0, s63, 9216
    s_add_u32 s56, s61, 8192
    buffer_load_dwordx4 v24, s[16:19], s56 offen lds
    s_add_u32 m0, s39, 96
    s_add_u32 s82, s3, 8
    s_mov_b64 exec, 1
    v_mov_b32 v14, s82
    global_load_lds_dword v[14:15], off
    s_mov_b64 exec, -1
    s_add_u32 s59, s28, 2
    s_and_b32 s59, s59, 7
    s_lshl_b32 s60, s59, 7
    s_add_u32 s60, s60, s29
    s_lshl_b32 s61, s59, 16
    s_add_u32 s61, s61, s30
    s_add_u32 m0, s63, 16384
    s_add_u32 s56, s60, 0
    buffer_load_dwordx4 v6, s[8:11], s56 offen lds
    s_add_u32 m0, s63, 17408
    s_add_u32 s56, s60, 8192
    buffer_load_dwordx4 v7, s[8:11], s56 offen lds
    s_add_u32 m0, s63, 24576
    s_add_u32 s56, s61, 0
    buffer_load_dwordx4 v24, s[16:19], s56 offen lds
    s_add_u32 m0, s63, 25600
    s_add_u32 s56, s61, 8192
    buffer_load_dwordx4 v24, s[16:19], s56 offen lds
    s_add_u32 m0, s39, 96
    s_add_u32 s82, s3, 12
    s_mov_b64 exec, 1
    v_mov_b32 v14, s82
    global_load_lds_dword v[14:15], off
    s_mov_b64 exec, -1
    s_add_u32 s59, s28, 3
    s_and_b32 s59, s59, 7
    s_lshl_b32 s60, s59, 7
    s_add_u32 s60, s60, s29
    s_lshl_b32 s61, s59, 16
    s_add_u32 s61, s61, s30
    s_add_u32 m0, s63, 98304
    s_add_u32 s56, s60, 0
    buffer_load_dwordx4 v6, s[8:11], s56 offen lds
    s_add_u32 m0, s63, 99328
    s_add_u32 s56, s60, 8192
    buffer_load_dwordx4 v7, s[8:11], s56 offen lds
    s_add_u32 m0, s63, 106496
    s_add_u32 s56, s61, 0
    buffer_load_dwordx4 v24, s[16:19], s56 offen lds
    s_add_u32 m0, s63, 107520
    s_add_u32 s56, s61, 8192
    buffer_load_dwordx4 v24, s[16:19], s56 offen lds
    s_add_u32 m0, s39, 96
    s_add_u32 s82, s3, 16
    s_mov_b64 exec, 1
    v_mov_b32 v14, s82
    global_load_lds_dword v[14:15], off
    s_mov_b64 exec, -1
    s_add_u32 s59, s28, 4
    s_and_b32 s59, s59, 7
    s_lshl_b32 s60, s59, 7
    s_add_u32 s60, s60, s29
    s_lshl_b32 s61, s59, 16
    s_add_u32 s61, s61, s30
    s_add_u32 m0, s63, 32768
    s_add_u32 s56, s60, 0
    buffer_load_dwordx4 v6, s[8:11], s56 offen lds
    s_add_u32 m0, s63, 33792
    s_add_u32 s56, s60, 8192
    buffer_load_dwordx4 v7, s[8:11], s56 offen lds
    s_add_u32 m0, s63, 40960
    s_add_u32 s56, s61, 0
    buffer_load_dwordx4 v24, s[16:19], s56 offen lds
    s_add_u32 m0, s63, 41984
    s_add_u32 s56, s61, 8192
    buffer_load_dwordx4 v24, s[16:19], s56 offen lds
    s_add_u32 m0, s39, 96
    s_add_u32 s82, s3, 20
    s_mov_b64 exec, 1
    v_mov_b32 v14, s82
    global_load_lds_dword v[14:15], off
    s_mov_b64 exec, -1
    s_add_u32 s59, s28, 5
    s_and_b32 s59, s59, 7
    s_lshl_b32 s60, s59, 7
    s_add_u32 s60, s60, s29
    s_lshl_b32 s61, s59, 16
    s_add_u32 s61, s61, s30
    s_add_u32 m0, s63, 49152
    s_add_u32 s56, s60, 0
    buffer_load_dwordx4 v6, s[8:11], s56 offen lds
    s_add_u32 m0, s63, 50176
    s_add_u32 s56, s60, 8192
    buffer_load_dwordx4 v7, s[8:11], s56 offen lds
    s_add_u32 m0, s63, 57344
    s_add_u32 s56, s61, 0
    buffer_load_dwordx4 v24, s[16:19], s56 offen lds
    s_add_u32 m0, s63, 58368
    s_add_u32 s56, s61, 8192
    buffer_load_dwordx4 v24, s[16:19], s56 offen lds
    s_add_u32 m0, s39, 96
    s_add_u32 s82, s3, 24
    s_mov_b64 exec, 1
    v_mov_b32 v14, s82
    global_load_lds_dword v[14:15], off
    s_mov_b64 exec, -1
    s_add_u32 s59, s28, 6
    s_and_b32 s59, s59, 7
    s_lshl_b32 s60, s59, 7
    s_add_u32 s60, s60, s29
    s_lshl_b32 s61, s59, 16
    s_add_u32 s61, s61, s30
    s_add_u32 m0, s63, 65536
    s_add_u32 s56, s60, 0
    buffer_load_dwordx4 v6, s[8:11], s56 offen lds
    s_add_u32 m0, s63, 66560
    s_add_u32 s56, s60, 8192
    buffer_load_dwordx4 v7, s[8:11], s56 offen lds
    s_add_u32 m0, s63, 73728
    s_add_u32 s56, s61, 0
    buffer_load_dwordx4 v24, s[16:19], s56 offen lds
    s_add_u32 m0, s63, 74752
    s_add_u32 s56, s61, 8192
    buffer_load_dwordx4 v24, s[16:19], s56 offen lds
    s_add_u32 m0, s39, 96
    s_add_u32 s82, s3, 28
    s_mov_b64 exec, 1
    v_mov_b32 v14, s82
    global_load_lds_dword v[14:15], off
    s_mov_b64 exec, -1
    s_mov_b32 s57, 400000
L_mega_kernel_lp4_250:
    ds_read_b32 v4, v29
    s_waitcnt lgkmcnt(0)
    v_cmp_gt_u32 vcc, 1, v4
    s_sub_u32 s57, s57, 1
    s_cmp_eq_u64 vcc, 0
    s_cbranch_scc1 L_mega_kernel_ok4_251
    s_sleep 1
    s_cmp_lg_u32 s57, 0
    s_cbranch_scc1 L_mega_kernel_lp4_250
L_mega_kernel_ok4_251:
    s_add_u32 s59, s28, 7
    s_and_b32 s59, s59, 7
    s_lshl_b32 s60, s59, 7
    s_add_u32 s60, s60, s29
    s_lshl_b32 s61, s59, 16
    s_add_u32 s61, s61, s30
    s_add_u32 m0, s63, 81920
    s_add_u32 s56, s60, 0
    buffer_load_dwordx4 v6, s[8:11], s56 offen lds
    s_add_u32 m0, s63, 82944
    s_add_u32 s56, s60, 8192
    buffer_load_dwordx4 v7, s[8:11], s56 offen lds
    s_add_u32 m0, s63, 90112
    s_add_u32 s56, s61, 0
    buffer_load_dwordx4 v24, s[16:19], s56 offen lds
    s_add_u32 m0, s63, 91136
    s_add_u32 s56, s61, 8192
    buffer_load_dwordx4 v24, s[16:19], s56 offen lds
    s_add_u32 m0, s39, 96
    s_add_u32 s82, s3, 32
    s_mov_b64 exec, 1
    v_mov_b32 v14, s82
    global_load_lds_dword v[14:15], off
    s_mov_b64 exec, -1
    s_mov_b64 exec, 2
    ds_add_u32 v3, v1 offset:40
    s_mov_b64 exec, -1
    s_mov_b32 s12, s48
    s_mov_b32 s13, s49
    s_mov_b32 s14, 1835008
    s_mov_b32 s15, 0x20000
    s_mov_b32 s16, s50
    s_mov_b32 s17, s51
    s_mov_b32 s18, 1835008
    s_mov_b32 s19, 0x20000
    v_lshrrev_b32 v8, 4, v1
    v_and_b32 v9, 15, v1
    v_lshrrev_b32 v10, 1, v9
    v_and_b32 v9, 1, v9
    v_lshlrev_b32 v11, 1, v8
    v_add_u32 v11, 0, v11
    v_xor_b32 v10, v10, v11
    v_mul_u32_u24 v11, 3584, v8
    v_lshlrev_b32 v12, 5, v10
    v_add_u32 v11, v11, v12
    v_lshlrev_b32 v12, 4, v9
    v_add_u32 v11, v11, v12
    s_mul_i32 s58, s22, 224
    v_add_u32 v11, s58, v11
    v_mov_b32 v12, 0x7ff00000
    v_cmp_eq_u32 vcc, 7, v10
    v_cndmask_b32 v25, v11, v12, vcc
    v_lshrrev_b32 v8, 4, v1
    v_and_b32 v9, 15, v1
    v_lshrrev_b32 v10, 1, v9
    v_and_b32 v9, 1, v9
    v_lshlrev_b32 v11, 1, v8
    v_add_u32 v11, 1, v11
    v_xor_b32 v10, v10, v11
    v_mul_u32_u24 v11, 3584, v8
    v_lshlrev_b32 v12, 5, v10
    v_add_u32 v11, v11, v12
    v_lshlrev_b32 v12, 4, v9
    v_add_u32 v11, v11, v12
    s_mul_i32 s58, s22, 224
    v_add_u32 v11, s58, v11
    v_mov_b32 v12, 0x7ff00000
    v_cmp_eq_u32 vcc, 7, v10
    v_cndmask_b32 v26, v11, v12, vcc
    s_lshl_b32 s29, s21, 17
    s_lshl_b32 s56, s27, 15
    s_add_u32 s29, s29, s56
    s_mov_b32 s30, 1
    s_mov_b32 s34, 132096
    s_and_b32 s33, s2, 7
    s_mov_b32 s57, 400000
L_mega_kernel_lp4_252:
    ds_read_b32 v4, v29
    s_waitcnt lgkmcnt(0)
    v_cmp_gt_u32 vcc, 4, v4
    s_sub_u32 s57, s57, 1
    s_cmp_eq_u64 vcc, 0
    s_cbranch_scc1 L_mega_kernel_ok4_253
    s_sleep 1
    s_cmp_lg_u32 s57, 0
    s_cbranch_scc1 L_mega_kernel_lp4_252
L_mega_kernel_ok4_253:
    s_add_u32 s59, s28, 0
    s_and_b32 s59, s59, 7
    s_lshl_b32 s60, s59, 7
    s_add_u32 s60, s60, s29
    s_lshl_b32 s61, s59, 2
    s_add_u32 s61, s61, s27
    s_mul_i32 s61, s61, 57344
    s_lshl_b32 s62, s27, 13
    s_lshl_b32 s63, s27, 12
    s_add_u32 m0, s62, 0
    s_add_u32 s56, s61, 0
    buffer_load_dwordx4 v25, s[12:15], s56 offen lds
    s_add_u32 m0, s62, 1024
    s_add_u32 s56, s61, 14336
    buffer_load_dwordx4 v25, s[12:15], s56 offen lds
    ds_read_b32 v4, v3
    s_waitcnt lgkmcnt(0)
    s_add_u32 m0, s62, 2048
    s_add_u32 s56, s61, 28672
    buffer_load_dwordx4 v26, s[12:15], s56 offen lds
    s_add_u32 m0, s62, 3072
    s_add_u32 s56, s61, 43008
    buffer_load_dwordx4 v26, s[12:15], s56 offen lds
    ds_read_b32 v4, v3
    s_waitcnt lgkmcnt(0)
    s_add_u32 m0, s62, 4096
    s_add_u32 s56, s61, 0
    buffer_load_dwordx4 v25, s[16:19], s56 offen lds
    s_add_u32 m0, s62, 5120
    s_add_u32 s56, s61, 14336
    buffer_load_dwordx4 v25, s[16:19], s56 offen lds
    ds_read_b32 v4, v3
    s_waitcnt lgkmcnt(0)
    s_add_u32 m0, s62, 6144
    s_add_u32 s56, s61, 28672
    buffer_load_dwordx4 v26, s[16:19], s56 offen lds
    s_add_u32 m0, s62, 7168
    s_add_u32 s56, s61, 43008
    buffer_load_dwordx4 v26, s[16:19], s56 offen lds
    ds_read_b32 v4, v3
    s_waitcnt lgkmcnt(0)
    s_add_u32 m0, s39, 112
    s_add_u32 s82, s3, 4
    s_mov_b64 exec, 1
    v_mov_b32 v14, s82
    global_load_lds_dword v[14:15], off
    s_mov_b64 exec, -1
    s_add_u32 s59, s28, 0
    s_and_b32 s59, s59, 7
    s_lshl_b32 s60, s59, 7
    s_add_u32 s60, s60, s29
    s_lshl_b32 s63, s27, 12
    s_add_u32 m0, s63, 98304
    s_add_u32 s56, s60, 0
    buffer_load_dwordx4 v6, s[8:11], s56 offen lds
    s_add_u32 m0, s63, 99328
    s_add_u32 s56, s60, 8192
    buffer_load_dwordx4 v7, s[8:11], s56 offen lds
    ds_read_b32 v4, v3
    s_waitcnt lgkmcnt(0)
    s_add_u32 m0, s63, 100352
    s_add_u32 s56, s60, 16384
    buffer_load_dwordx4 v6, s[8:11], s56 offen lds
    s_add_u32 m0, s63, 101376
    s_add_u32 s56, s60, 24576
    buffer_load_dwordx4 v7, s[8:11], s56 offen lds
    ds_read_b32 v4, v3
    s_waitcnt lgkmcnt(0)
    s_add_u32 m0, s39, 128
    s_add_u32 s82, s3, 4
    s_mov_b64 exec, 1
    v_mov_b32 v14, s82
    global_load_lds_dword v[14:15], off
    s_mov_b64 exec, -1
    s_mov_b32 s57, 400000
L_mega_kernel_lp4_254:
    ds_read_b32 v4, v29
    s_waitcnt lgkmcnt(0)
    v_cmp_gt_u32 vcc, 7, v4
    s_sub_u32 s57, s57, 1
    s_cmp_eq_u64 vcc, 0
    s_cbranch_scc1 L_mega_kernel_ok4_255
    s_sleep 1
    s_cmp_lg_u32 s57, 0
    s_cbranch_scc1 L_mega_kernel_lp4_254
L_mega_kernel_ok4_255:
    s_add_u32 s59, s28, 1
    s_and_b32 s59, s59, 7
    s_lshl_b32 s60, s59, 7
    s_add_u32 s60, s60, s29
    s_lshl_b32 s63, s27, 12
    s_add_u32 m0, s63, 65536
    s_add_u32 s56, s60, 0
    buffer_load_dwordx4 v6, s[8:11], s56 offen lds
    s_add_u32 m0, s63, 66560
    s_add_u32 s56, s60, 8192
    buffer_load_dwordx4 v7, s[8:11], s56 offen lds
    ds_read_b32 v4, v3
    s_waitcnt lgkmcnt(0)
    s_add_u32 m0, s63, 67584
    s_add_u32 s56, s60, 16384
    buffer_load_dwordx4 v6, s[8:11], s56 offen lds
    s_add_u32 m0, s63, 68608
    s_add_u32 s56, s60, 24576
    buffer_load_dwordx4 v7, s[8:11], s56 offen lds
    ds_read_b32 v4, v3
    s_waitcnt lgkmcnt(0)
    s_add_u32 m0, s39, 128
    s_add_u32 s82, s3, 8
    s_mov_b64 exec, 1
    v_mov_b32 v14, s82
    global_load_lds_dword v[14:15], off
    s_mov_b64 exec, -1
    s_cmp_lg_u32 s27, 1
    s_cbranch_scc1 L_mega_kernel_nofl_256
    s_and_b32 s36, s2, 7
    s_lshl_b32 s36, s36, 15
    s_add_u32 s36, s36, 2424832
    v_lshlrev_b32 v8, 7, v1
    s_add_u32 s56, s36, 0
    buffer_load_dwordx2 v[64:65], v8, s[4:7], s56 offen sc1
    s_add_u32 s56, s36, 8192
    buffer_load_dwordx2 v[66:67], v8, s[4:7], s56 offen sc1
    s_add_u32 s56, s36, 16384
    buffer_load_dwordx2 v[68:69], v8, s[4:7], s56 offen sc1
    s_add_u32 s56, s36, 24576
    buffer_load_dwordx2 v[70:71], v8, s[4:7], s56 offen sc1
L_mega_kernel_nofl_256:
    s_add_u32 s59, s28, 1
    s_and_b32 s59, s59, 7
    s_lshl_b32 s60, s59, 7
    s_add_u32 s60, s60, s29
    s_lshl_b32 s61, s59, 2
    s_add_u32 s61, s61, s27
    s_mul_i32 s61, s61, 57344
    s_lshl_b32 s62, s27, 13
    s_lshl_b32 s63, s27, 12
    s_add_u32 m0, s62, 32768
    s_add_u32 s56, s61, 0
    buffer_load_dwordx4 v25, s[12:15], s56 offen lds
    s_add_u32 m0, s62, 33792
    s_add_u32 s56, s61, 14336
    buffer_load_dwordx4 v25, s[12:15], s56 offen lds
    ds_read_b32 v4, v3
    s_waitcnt lgkmcnt(0)
    s_add_u32 m0, s62, 34816
    s_add_u32 s56, s61, 28672
    buffer_load_dwordx4 v26, s[12:15], s56 offen lds
    s_add_u32 m0, s62, 35840
    s_add_u32 s56, s61, 43008
    buffer_load_dwordx4 v26, s[12:15], s56 offen lds
    ds_read_b32 v4, v3
    s_waitcnt lgkmcnt(0)
    s_add_u32 m0, s62, 36864
    s_add_u32 s56, s61, 0
    buffer_load_dwordx4 v25, s[16:19], s56 offen lds
    s_add_u32 m0, s62, 37888
    s_add_u32 s56, s61, 14336
    buffer_load_dwordx4 v25, s[16:19], s56 offen lds
    ds_read_b32 v4, v3
    s_waitcnt lgkmcnt(0)
    s_add_u32 m0, s62, 38912
    s_add_u32 s56, s61, 28672
    buffer_load_dwordx4 v26, s[16:19], s56 offen lds
    s_add_u32 m0, s62, 39936
    s_add_u32 s56, s61, 43008
    buffer_load_dwordx4 v26, s[16:19], s56 offen lds
    ds_read_b32 v4, v3
    s_waitcnt lgkmcnt(0)
    s_add_u32 m0, s39, 112
    s_add_u32 s82, s3, 8
    s_mov_b64 exec, 1
    v_mov_b32 v14, s82
    global_load_lds_dword v[14:15], off
    s_mov_b64 exec, -1
    s_mov_b32 s57, 400000
L_mega_kernel_lp4_257:
    ds_read_b32 v4, v29
    s_waitcnt lgkmcnt(0)
    v_cmp_gt_u32 vcc, 8, v4
    s_sub_u32 s57, s57, 1
    s_cmp_eq_u64 vcc, 0
    s_cbranch_scc1 L_mega_kernel_ok4_258
    s_sleep 1
    s_cmp_lg_u32 s57, 0
    s_cbranch_scc1 L_mega_kernel_lp4_257
L_mega_kernel_ok4_258:
    s_add_u32 s59, s28, 2
    s_and_b32 s59, s59, 7
    s_lshl_b32 s60, s59, 7
    s_add_u32 s60, s60, s29
    s_lshl_b32 s63, s27, 12
    s_add_u32 m0, s63, 81920
    s_add_u32 s56, s60, 0
    buffer_load_dwordx4 v6, s[8:11], s56 offen lds
    s_add_u32 m0, s63, 82944
    s_add_u32 s56, s60, 8192
    buffer_load_dwordx4 v7, s[8:11], s56 offen lds
    ds_read_b32 v4, v3
    s_waitcnt lgkmcnt(0)
    s_add_u32 m0, s63, 83968
    s_add_u32 s56, s60, 16384
    buffer_load_dwordx4 v6, s[8:11], s56 offen lds
    s_add_u32 m0, s63, 84992
    s_add_u32 s56, s60, 24576
    buffer_load_dwordx4 v7, s[8:11], s56 offen lds
    ds_read_b32 v4, v3
    s_waitcnt lgkmcnt(0)
    s_add_u32 m0, s39, 128
    s_add_u32 s82, s3, 12
    s_mov_b64 exec, 1
    v_mov_b32 v14, s82
    global_load_lds_dword v[14:15], off
    s_mov_b64 exec, -1
    s_cmp_lg_u32 s27, 1
    s_cbranch_scc1 L_mega_kernel_nofl_259
    ds_read_b32 v10, v3 offset:60
    s_waitcnt vmcnt(14) lgkmcnt(0)
    v_readfirstlane_b32 s23, v10
    s_add_u32 s37, s23, 1
    s_mov_b32 s62, 100000
L_mega_kernel_flr_260:
    v_xor_b32 v64, s37, v64
    v_xor_b32 v65, s37, v65
    v_xor_b32 v66, s37, v66
    v_xor_b32 v67, s37, v67
    v_xor_b32 v68, s37, v68
    v_xor_b32 v69, s37, v69
    v_xor_b32 v70, s37, v70
    v_xor_b32 v71, s37, v71
    v_or3_b32 v64, v64, v65, v66
    v_or3_b32 v67, v67, v68, v69
    v_or3_b32 v64, v64, v70, v71
    v_or_b32 v64, v64, v67
    v_cmp_ne_u32 vcc, 0, v64
    s_sub_u32 s62, s62, 1
    s_cmp_eq_u64 vcc, 0
    s_cbranch_scc1 L_mega_kernel_flok_261
    s_cmp_eq_u32 s62, 0
    s_cbranch_scc1 L_mega_kernel_flok_261
    s_sleep 4
    s_and_b32 s36, s2, 7
    s_lshl_b32 s36, s36, 15
    s_add_u32 s36, s36, 2424832
    v_lshlrev_b32 v8, 7, v1
    s_add_u32 s56, s36, 0
    buffer_load_dwordx2 v[64:65], v8, s[4:7], s56 offen sc1
    s_add_u32 s56, s36, 8192
    buffer_load_dwordx2 v[66:67], v8, s[4:7], s56 offen sc1
    s_add_u32 s56, s36, 16384
    buffer_load_dwordx2 v[68:69], v8, s[4:7], s56 offen sc1
    s_add_u32 s56, s36, 24576
    buffer_load_dwordx2 v[70:71], v8, s[4:7], s56 offen sc1
    s_waitcnt vmcnt(0)
    s_branch L_mega_kernel_flr_260
L_mega_kernel_flok_261:
    s_cmp_lg_u32 s26, 0
    s_cbranch_scc1 L_mega_kernel_noep_262
    s_add_u32 s56, s23, 2
    v_mov_b32 v8, s56
    v_mov_b32 v9, 0
    s_mov_b32 s56, 2752512
    s_mov_b64 exec, 1
    buffer_store_dword v8, v9, s[4:7], s56 offen sc1
    s_mov_b64 exec, -1
L_mega_kernel_noep_262:
    s_mov_b32 s57, 2260992
    buffer_load_dwordx4 v[72:75], v2, s[4:7], s57 offen sc1
    s_lshl_b32 s56, s21, 10
    s_add_u32 s56, s56, 2293760
    s_mov_b32 m0, 149760
    s_nop 0
    buffer_load_dwordx4 v2, s[4:7], s56 offen sc1 lds
    s_mov_b32 m0, 149512
    s_add_u32 s82, s3, 4
    s_mov_b64 exec, 1
    v_mov_b32 v14, s82
    global_load_lds_dword v[14:15], off
    s_mov_b64 exec, -1
L_mega_kernel_nofl_259:
    s_cmp_lg_u32 s27, 2
    s_cbranch_scc1 L_mega_kernel_nowd_263
    v_lshrrev_b32 v10, 1, v1
    v_lshlrev_b32 v10, 10, v10
    v_and_b32 v11, 1, v1
    v_lshl_add_u32 v10, v11, 4, v10
    s_mul_i32 s72, s2, 9
    s_add_u32 s64, s72, 0
    s_lshr_b32 s65, s64, 5
    s_and_b32 s66, s64, 31
    s_cmp_lt_u32 s65, 56
    s_cselect_b32 s68, s52, s44
    s_cselect_b32 s69, s53, s45
    s_mov_b32 s70, 524288
    s_cselect_b32 s70, 1835008, s70
    s_cselect_b32 s67, 0, 56
    s_sub_u32 s65, s65, s67
    s_lshl_b32 s65, s65, 15
    s_lshl_b32 s66, s66, 5
    s_add_u32 s65, s65, s66
    s_mov_b32 s71, 0x20000
    s_mov_b32 m0, 153600
    s_nop 0
    buffer_load_dwordx4 v10, s[68:71], s65 offen lds
    s_add_u32 s64, s72, 1
    s_lshr_b32 s65, s64, 5
    s_and_b32 s66, s64, 31
    s_cmp_lt_u32 s65, 56
    s_cselect_b32 s68, s52, s44
    s_cselect_b32 s69, s53, s45
    s_mov_b32 s70, 524288
    s_cselect_b32 s70, 1835008, s70
    s_cselect_b32 s67, 0, 56
    s_sub_u32 s65, s65, s67
    s_lshl_b32 s65, s65, 15
    s_lshl_b32 s66, s66, 5
    s_add_u32 s65, s65, s66
    s_mov_b32 s71, 0x20000
    s_mov_b32 m0, 154624
    s_nop 0
    buffer_load_dwordx4 v10, s[68:71], s65 offen lds
    s_add_u32 s64, s72, 2
    s_lshr_b32 s65, s64, 5
    s_and_b32 s66, s64, 31
    s_cmp_lt_u32 s65, 56
    s_cselect_b32 s68, s52, s44
    s_cselect_b32 s69, s53, s45
    s_mov_b32 s70, 524288
    s_cselect_b32 s70, 1835008, s70
    s_cselect_b32 s67, 0, 56
    s_sub_u32 s65, s65, s67
    s_lshl_b32 s65, s65, 15
    s_lshl_b32 s66, s66, 5
    s_add_u32 s65, s65, s66
    s_mov_b32 s71, 0x20000
    s_mov_b32 m0, 155648
    s_nop 0
    buffer_load_dwordx4 v10, s[68:71], s65 offen lds
    s_add_u32 s64, s72, 3
    s_lshr_b32 s65, s64, 5
    s_and_b32 s66, s64, 31
    s_cmp_lt_u32 s65, 56
    s_cselect_b32 s68, s52, s44
    s_cselect_b32 s69, s53, s45
    s_mov_b32 s70, 524288
    s_cselect_b32 s70, 1835008, s70
    s_cselect_b32 s67, 0, 56
    s_sub_u32 s65, s65, s67
    s_lshl_b32 s65, s65, 15
    s_lshl_b32 s66, s66, 5
    s_add_u32 s65, s65, s66
    s_mov_b32 s71, 0x20000
    s_mov_b32 m0, 156672
    s_nop 0
    buffer_load_dwordx4 v10, s[68:71], s65 offen lds
    s_add_u32 s64, s72, 4
    s_lshr_b32 s65, s64, 5
    s_and_b32 s66, s64, 31
    s_cmp_lt_u32 s65, 56
    s_cselect_b32 s68, s52, s44
    s_cselect_b32 s69, s53, s45
    s_mov_b32 s70, 524288
    s_cselect_b32 s70, 1835008, s70
    s_cselect_b32 s67, 0, 56
    s_sub_u32 s65, s65, s67
    s_lshl_b32 s65, s65, 15
    s_lshl_b32 s66, s66, 5
    s_add_u32 s65, s65, s66
    s_mov_b32 s71, 0x20000
    s_mov_b32 m0, 157696
    s_nop 0
    buffer_load_dwordx4 v10, s[68:71], s65 offen lds
    s_add_u32 s64, s72, 5
    s_lshr_b32 s65, s64, 5
    s_and_b32 s66, s64, 31
    s_cmp_lt_u32 s65, 56
    s_cselect_b32 s68, s52, s44
    s_cselect_b32 s69, s53, s45
    s_mov_b32 s70, 524288
    s_cselect_b32 s70, 1835008, s70
    s_cselect_b32 s67, 0, 56
    s_sub_u32 s65, s65, s67
    s_lshl_b32 s65, s65, 15
    s_lshl_b32 s66, s66, 5
    s_add_u32 s65, s65, s66
    s_mov_b32 s71, 0x20000
    s_mov_b32 m0, 158720
    s_nop 0
    buffer_load_dwordx4 v10, s[68:71], s65 offen lds
    s_add_u32 s64, s72, 6
    s_lshr_b32 s65, s64, 5
    s_and_b32 s66, s64, 31
    s_cmp_lt_u32 s65, 56
    s_cselect_b32 s68, s52, s44
    s_cselect_b32 s69, s53, s45
    s_mov_b32 s70, 524288
    s_cselect_b32 s70, 1835008, s70
    s_cselect_b32 s67, 0, 56
    s_sub_u32 s65, s65, s67
    s_lshl_b32 s65, s65, 15
    s_lshl_b32 s66, s66, 5
    s_add_u32 s65, s65, s66
    s_mov_b32 s71, 0x20000
    s_mov_b32 m0, 159744
    s_nop 0
    buffer_load_dwordx4 v10, s[68:71], s65 offen lds
    s_add_u32 s64, s72, 7
    s_lshr_b32 s65, s64, 5
    s_and_b32 s66, s64, 31
    s_cmp_lt_u32 s65, 56
    s_cselect_b32 s68, s52, s44
    s_cselect_b32 s69, s53, s45
    s_mov_b32 s70, 524288
    s_cselect_b32 s70, 1835008, s70
    s_cselect_b32 s67, 0, 56
    s_sub_u32 s65, s65, s67
    s_lshl_b32 s65, s65, 15
    s_lshl_b32 s66, s66, 5
    s_add_u32 s65, s65, s66
    s_mov_b32 s71, 0x20000
    s_mov_b32 m0, 160768
    s_nop 0
    buffer_load_dwordx4 v10, s[68:71], s65 offen lds
    s_add_u32 s64, s72, 8
    s_lshr_b32 s65, s64, 5
    s_and_b32 s66, s64, 31
    s_cmp_lt_u32 s65, 56
    s_cselect_b32 s68, s52, s44
    s_cselect_b32 s69, s53, s45
    s_mov_b32 s70, 524288
    s_cselect_b32 s70, 1835008, s70
    s_cselect_b32 s67, 0, 56
    s_sub_u32 s65, s65, s67
    s_lshl_b32 s65, s65, 15
    s_lshl_b32 s66, s66, 5
    s_add_u32 s65, s65, s66
    s_mov_b32 s71, 0x20000
    s_mov_b32 m0, 161792
    s_nop 0
    buffer_load_dwordx4 v10, s[68:71], s65 offen lds
    v_mov_b32 v16, -1
    v_mov_b32 v17, -1
    v_mov_b32 v18, -1
    v_mov_b32 v19, -1
    s_lshl_b32 s56, s24, 6
    s_lshl_b32 s57, s25, 2
    s_add_u32 s56, s56, s57
    s_lshl_b32 s56, s56, 10
    s_add_u32 s56, s56, 10485760
    s_add_u32 s57, s56, 32768
    buffer_store_dwordx4 v[16:19], v2, s[4:7], s56 offen offset:0 sc1
    buffer_store_dwordx4 v[16:19], v2, s[4:7], s56 offen offset:1024 sc1
    buffer_store_dwordx4 v[16:19], v2, s[4:7], s56 offen offset:2048 sc1
    buffer_store_dwordx4 v[16:19], v2, s[4:7], s56 offen offset:3072 sc1
    buffer_store_dwordx4 v[16:19], v2, s[4:7], s57 offen offset:0 sc1
    buffer_store_dwordx4 v[16:19], v2, s[4:7], s57 offen offset:1024 sc1
    buffer_store_dwordx4 v[16:19], v2, s[4:7], s57 offen offset:2048 sc1
    buffer_store_dwordx4 v[16:19], v2, s[4:7], s57 offen offset:3072 sc1
L_mega_kernel_nowd_263:
    s_cmp_lg_u32 s27, 1
    s_cbranch_scc1 L_mega_kernel_noc1_264
    s_mov_b32 s57, 400000
L_mega_kernel_lp4_265:
    ds_read_b32 v4, v29
    s_waitcnt lgkmcnt(0)
    v_cmp_gt_u32 vcc, 8, v4
    s_sub_u32 s57, s57, 1
    s_cmp_eq_u64 vcc, 0
    s_cbranch_scc1 L_mega_kernel_ok4_266
    s_sleep 1
    s_cmp_lg_u32 s57, 0
    s_cbranch_scc1 L_mega_kernel_lp4_265
L_mega_kernel_ok4_266:
L_mega_kernel_noc1_264:
    s_cmp_lg_u32 s27, 1
    s_cbranch_scc1 L_mega_kernel_nokv_267
    s_cmp_ge_u32 s30, 8
    s_cbranch_scc1 L_mega_kernel_nokv_267
    ds_read_b32 v4, v29
    s_add_u32 s65, s30, 7
    s_waitcnt lgkmcnt(0)
    v_cmp_gt_u32 vcc, s65, v4
    s_nop 0
    s_cmp_lg_u64 vcc, 0
    s_cbranch_scc1 L_mega_kernel_nokv_267
    s_sub_u32 s56, s33, s30
    s_and_b32 s56, s56, 7
    s_mul_i32 s57, s56, 17408
    s_add_u32 s57, s57, 2097152
    s_add_u32 m0, s34, 0
    s_add_u32 s60, s57, 0
    buffer_load_dwordx4 v2, s[4:7], s60 offen sc1 lds
    s_add_u32 m0, s34, 1024
    s_add_u32 s60, s57, 1024
    buffer_load_dwordx4 v2, s[4:7], s60 offen sc1 lds
    ds_read_b32 v4, v3
    s_waitcnt lgkmcnt(0)
    s_add_u32 m0, s34, 2048
    s_add_u32 s60, s57, 2048
    buffer_load_dwordx4 v2, s[4:7], s60 offen sc1 lds
    s_add_u32 m0, s34, 3072
    s_add_u32 s60, s57, 3072
    buffer_load_dwordx4 v2, s[4:7], s60 offen sc1 lds
    ds_read_b32 v4, v3
    s_waitcnt lgkmcnt(0)
    s_add_u32 m0, s34, 4096
    s_add_u32 s60, s57, 4096
    buffer_load_dwordx4 v2, s[4:7], s60 offen sc1 lds
    s_add_u32 m0, s34, 5120
    s_add_u32 s60, s57, 5120
    buffer_load_dwordx4 v2, s[4:7], s60 offen sc1 lds
    ds_read_b32 v4, v3
    s_waitcnt lgkmcnt(0)
    s_add_u32 m0, s34, 6144
    s_add_u32 s60, s57, 6144
    buffer_load_dwordx4 v2, s[4:7], s60 offen sc1 lds
    s_add_u32 m0, s34, 7168
    s_add_u32 s60, s57, 7168
    buffer_load_dwordx4 v2, s[4:7], s60 offen sc1 lds
    ds_read_b32 v4, v3
    s_waitcnt lgkmcnt(0)
    s_add_u32 m0, s34, 8192
    s_add_u32 s60, s57, 8192
    buffer_load_dwordx4 v2, s[4:7], s60 offen sc1 lds
    s_add_u32 m0, s34, 9216
    s_add_u32 s60, s57, 9216
    buffer_load_dwordx4 v2, s[4:7], s60 offen sc1 lds
    ds_read_b32 v4, v3
    s_waitcnt lgkmcnt(0)
    s_add_u32 m0, s34, 10240
    s_add_u32 s60, s57, 10240
    buffer_load_dwordx4 v2, s[4:7], s60 offen sc1 lds
    s_add_u32 m0, s34, 11264
    s_add_u32 s60, s57, 11264
    buffer_load_dwordx4 v2, s[4:7], s60 offen sc1 lds
    ds_read_b32 v4, v3
    s_waitcnt lgkmcnt(0)
    s_add_u32 m0, s34, 12288
    s_add_u32 s60, s57, 12288
    buffer_load_dwordx4 v2, s[4:7], s60 offen sc1 lds
    s_add_u32 m0, s34, 13312
    s_add_u32 s60, s57, 13312
    buffer_load_dwordx4 v2, s[4:7], s60 offen sc1 lds
    ds_read_b32 v4, v3
    s_waitcnt lgkmcnt(0)
    s_add_u32 m0, s34, 14336
    s_add_u32 s60, s57, 14336
    buffer_load_dwordx4 v2, s[4:7], s60 offen sc1 lds
    s_add_u32 m0, s34, 15360
    s_add_u32 s60, s57, 15360
    buffer_load_dwordx4 v2, s[4:7], s60 offen sc1 lds
    ds_read_b32 v4, v3
    s_waitcnt lgkmcnt(0)
    s_add_u32 m0, s34, 16384
    s_add_u32 s60, s57, 16384
    buffer_load_dwordx4 v2, s[4:7], s60 offen sc1 lds
    s_add_u32 s65, s30, 1
    s_mov_b32 m0, 149664
    s_lshl_b32 s82, s65, 2
    s_add_u32 s82, s82, s3
    s_mov_b64 exec, 1
    v_mov_b32 v14, s82
    global_load_lds_dword v[14:15], off
    s_mov_b64 exec, -1
    s_add_u32 s34, s34, 17408
    s_cmp_eq_u32 s34, 149504
    s_cselect_b32 s34, 114688, s34
    s_add_u32 s30, s30, 1
L_mega_kernel_nokv_267:
    s_add_u32 s65, s27, 1
    s_mov_b32 s57, 400000
L_mega_kernel_lp4_268:
    ds_read_b32 v4, v5
    s_waitcnt lgkmcnt(0)
    v_cmp_gt_u32 vcc, s65, v4
    s_sub_u32 s57, s57, 1
    s_cmp_eq_u64 vcc, 0
    s_cbranch_scc1 L_mega_kernel_ok4_269
    s_sleep 4
    s_cmp_lg_u32 s57, 0
    s_cbranch_scc1 L_mega_kernel_lp4_268
L_mega_kernel_ok4_269:
    s_add_u32 s59, s28, 2
    s_and_b32 s59, s59, 7
    s_lshl_b32 s60, s59, 7
    s_add_u32 s60, s60, s29
    s_lshl_b32 s61, s59, 2
    s_add_u32 s61, s61, s27
    s_mul_i32 s61, s61, 57344
    s_lshl_b32 s62, s27, 13
    s_lshl_b32 s63, s27, 12
    s_add_u32 m0, s62, 0
    s_add_u32 s56, s61, 0
    buffer_load_dwordx4 v25, s[12:15], s56 offen lds
    ds_read_b32 v4, v3
    s_waitcnt lgkmcnt(0)
    s_add_u32 m0, s62, 1024
    s_add_u32 s56, s61, 14336
    buffer_load_dwordx4 v25, s[12:15], s56 offen lds
    s_add_u32 m0, s62, 2048
    s_add_u32 s56, s61, 28672
    buffer_load_dwordx4 v26, s[12:15], s56 offen lds
    ds_read_b32 v4, v3
    s_waitcnt lgkmcnt(0)
    s_add_u32 m0, s62, 3072
    s_add_u32 s56, s61, 43008
    buffer_load_dwordx4 v26, s[12:15], s56 offen lds
    s_add_u32 m0, s62, 4096
    s_add_u32 s56, s61, 0
    buffer_load_dwordx4 v25, s[16:19], s56 offen lds
    ds_read_b32 v4, v3
    s_waitcnt lgkmcnt(0)
    s_add_u32 m0, s62, 5120
    s_add_u32 s56, s61, 14336
    buffer_load_dwordx4 v25, s[16:19], s56 offen lds
    s_add_u32 m0, s62, 6144
    s_add_u32 s56, s61, 28672
    buffer_load_dwordx4 v26, s[16:19], s56 offen lds
    ds_read_b32 v4, v3
    s_waitcnt lgkmcnt(0)
    s_add_u32 m0, s62, 7168
    s_add_u32 s56, s61, 43008
    buffer_load_dwordx4 v26, s[16:19], s56 offen lds
    s_add_u32 m0, s39, 112
    s_add_u32 s82, s3, 12
    s_mov_b64 exec, 1
    v_mov_b32 v14, s82
    global_load_lds_dword v[14:15], off
    s_mov_b64 exec, -1
    s_mov_b32 s57, 400000
L_mega_kernel_lp4_270:
    ds_read_b32 v4, v5
    s_waitcnt lgkmcnt(0)
    v_cmp_gt_u32 vcc, 4, v4
    s_sub_u32 s57, s57, 1
    s_cmp_eq_u64 vcc, 0
    s_cbranch_scc1 L_mega_kernel_ok4_271
    s_sleep 4
    s_cmp_lg_u32 s57, 0
    s_cbranch_scc1 L_mega_kernel_lp4_270
L_mega_kernel_ok4_271:
    s_add_u32 s59, s28, 3
    s_and_b32 s59, s59, 7
    s_lshl_b32 s60, s59, 7
    s_add_u32 s60, s60, s29
    s_lshl_b32 s63, s27, 12
    s_add_u32 m0, s63, 98304
    s_add_u32 s56, s60, 0
    buffer_load_dwordx4 v6, s[8:11], s56 offen lds
    ds_read_b32 v4, v3
    s_waitcnt lgkmcnt(0)
    s_add_u32 m0, s63, 99328
    s_add_u32 s56, s60, 8192
    buffer_load_dwordx4 v7, s[8:11], s56 offen lds
    s_add_u32 m0, s63, 100352
    s_add_u32 s56, s60, 16384
    buffer_load_dwordx4 v6, s[8:11], s56 offen lds
    ds_read_b32 v4, v3
    s_waitcnt lgkmcnt(0)
    s_add_u32 m0, s63, 101376
    s_add_u32 s56, s60, 24576
    buffer_load_dwordx4 v7, s[8:11], s56 offen lds
    s_add_u32 m0, s39, 128
    s_add_u32 s82, s3, 16
    s_mov_b64 exec, 1
    v_mov_b32 v14, s82
    global_load_lds_dword v[14:15], off
    s_mov_b64 exec, -1
    s_cmp_lg_u32 s27, 1
    s_cbranch_scc1 L_mega_kernel_nofl_272
    s_waitcnt vmcnt(14)
    v_max3_f32 v72, v72, v73, v74
    v_max_f32 v72, v72, v75
    s_nop 1
    v_max_f32_dpp v72, v72, v72 quad_perm:[1,0,3,2] row_mask:0xf bank_mask:0xf
    s_nop 1
    v_max_f32_dpp v72, v72, v72 quad_perm:[2,3,0,1] row_mask:0xf bank_mask:0xf
    s_nop 1
    v_max_f32_dpp v72, v72, v72 row_half_mirror row_mask:0xf bank_mask:0xf
    s_nop 1
    v_max_f32_dpp v72, v72, v72 row_mirror row_mask:0xf bank_mask:0xf
    s_nop 1
    v_mov_b32 v74, v72
    s_nop 1
    v_permlane16_swap_b32 v72, v74
    s_nop 1
    v_max_f32 v72, v72, v74
    v_mov_b32 v74, v72
    s_nop 1
    v_permlane32_swap_b32 v72, v74
    s_nop 1
    v_max_f32 v72, v72, v74
    v_mov_b32 v73, 1
    s_mov_b64 exec, 1
    ds_write_b64 v3, v[72:73] offset:144
    s_mov_b64 exec, -1
L_mega_kernel_nofl_272:
    s_cmp_lg_u32 s27, 2
    s_cbranch_scc1 L_mega_kernel_nowd_273
    v_lshrrev_b32 v8, 4, v1
    v_and_b32 v9, 15, v1
    v_lshrrev_b32 v10, 2, v9
    v_and_b32 v9, 3, v9
    v_lshlrev_b32 v9, 3, v9
    v_lshl_add_u32 v9, v10, 5, v9
    v_add_u32 v9, 153600, v9
    v_lshl_add_u32 v76, v8, 7, v9
    v_add_u32 v77, 512, v76
    v_and_b32 v10, 1, v8
    v_lshl_add_u32 v78, v10, 7, v9
    v_lshrrev_b32 v10, 1, v8
    v_lshl_add_u32 v78, v10, 9, v78
    v_add_u32 v79, 256, v78
    s_waitcnt vmcnt(14)
    s_add_u32 s64, s72, 0
    s_cmp_lt_u32 s64, 1792
    s_cselect_b64 vcc, -1, 0
    v_cndmask_b32 v80, v78, v76, vcc
    v_cndmask_b32 v81, v79, v77, vcc
    ds_read_b64_tr_b16 v[32:33], v80 offset:0
    ds_read_b64_tr_b16 v[34:35], v81 offset:0
    s_add_u32 s64, s72, 1
    s_cmp_lt_u32 s64, 1792
    s_cselect_b64 vcc, -1, 0
    v_cndmask_b32 v80, v78, v76, vcc
    v_cndmask_b32 v81, v79, v77, vcc
    ds_read_b64_tr_b16 v[36:37], v80 offset:1024
    ds_read_b64_tr_b16 v[38:39], v81 offset:1024
    s_add_u32 s64, s72, 2
    s_cmp_lt_u32 s64, 1792
    s_cselect_b64 vcc, -1, 0
    v_cndmask_b32 v80, v78, v76, vcc
    v_cndmask_b32 v81, v79, v77, vcc
    ds_read_b64_tr_b16 v[40:41], v80 offset:2048
    ds_read_b64_tr_b16 v[42:43], v81 offset:2048
    s_add_u32 s64, s72, 3
    s_cmp_lt_u32 s64, 1792
    s_cselect_b64 vcc, -1, 0
    v_cndmask_b32 v80, v78, v76, vcc
    v_cndmask_b32 v81, v79, v77, vcc
    ds_read_b64_tr_b16 v[44:45], v80 offset:3072
    ds_read_b64_tr_b16 v[46:47], v81 offset:3072
    s_add_u32 s64, s72, 4
    s_cmp_lt_u32 s64, 1792
    s_cselect_b64 vcc, -1, 0
    v_cndmask_b32 v80, v78, v76, vcc
    v_cndmask_b32 v81, v79, v77, vcc
    ds_read_b64_tr_b16 v[48:49], v80 offset:4096
    ds_read_b64_tr_b16 v[50:51], v81 offset:4096
    s_add_u32 s64, s72, 5
    s_cmp_lt_u32 s64, 1792
    s_cselect_b64 vcc, -1, 0
    v_cndmask_b32 v80, v78, v76, vcc
    v_cndmask_b32 v81, v79, v77, vcc
    ds_read_b64_tr_b16 v[52:53], v80 offset:5120
    ds_read_b64_tr_b16 v[54:55], v81 offset:5120
    s_add_u32 s64, s72, 6
    s_cmp_lt_u32 s64, 1792
    s_cselect_b64 vcc, -1, 0
    v_cndmask_b32 v80, v78, v76, vcc
    v_cndmask_b32 v81, v79, v77, vcc
    ds_read_b64_tr_b16 v[56:57], v80 offset:6144
    ds_read_b64_tr_b16 v[58:59], v81 offset:6144
    s_add_u32 s64, s72, 7
    s_cmp_lt_u32 s64, 1792
    s_cselect_b64 vcc, -1, 0
    v_cndmask_b32 v80, v78, v76, vcc
    v_cndmask_b32 v81, v79, v77, vcc
    ds_read_b64_tr_b16 v[60:61], v80 offset:7168
    ds_read_b64_tr_b16 v[62:63], v81 offset:7168
    s_add_u32 s64, s72, 8
    s_cmp_lt_u32 s64, 1792
    s_cselect_b64 vcc, -1, 0
    v_cndmask_b32 v80, v78, v76, vcc
    v_cndmask_b32 v81, v79, v77, vcc
    ds_read_b64_tr_b16 v[64:65], v80 offset:8192
    ds_read_b64_tr_b16 v[66:67], v81 offset:8192
    s_lshl_b32 s56, s72, 10
    s_add_u32 s56, s56, 12582912
    s_waitcnt lgkmcnt(0)
    buffer_store_dwordx4 v[32:35], v2, s[4:7], s56 offen sc1
    s_add_u32 s56, s56, 1024
    buffer_store_dwordx4 v[36:39], v2, s[4:7], s56 offen sc1
    s_add_u32 s56, s56, 1024
    buffer_store_dwordx4 v[40:43], v2, s[4:7], s56 offen sc1
    s_add_u32 s56, s56, 1024
    buffer_store_dwordx4 v[44:47], v2, s[4:7], s56 offen sc1
    s_add_u32 s56, s56, 1024
    buffer_store_dwordx4 v[48:51], v2, s[4:7], s56 offen sc1
    s_add_u32 s56, s56, 1024
    buffer_store_dwordx4 v[52:55], v2, s[4:7], s56 offen sc1
    s_add_u32 s56, s56, 1024
    buffer_store_dwordx4 v[56:59], v2, s[4:7], s56 offen sc1
    s_add_u32 s56, s56, 1024
    buffer_store_dwordx4 v[60:63], v2, s[4:7], s56 offen sc1
    s_add_u32 s56, s56, 1024
    buffer_store_dwordx4 v[64:67], v2, s[4:7], s56 offen sc1
L_mega_kernel_nowd_273:
    s_cmp_lg_u32 s27, 1
    s_cbranch_scc1 L_mega_kernel_nokv_274
    s_cmp_ge_u32 s30, 8
    s_cbranch_scc1 L_mega_kernel_nokv_274
    ds_read_b32 v4, v29
    s_add_u32 s65, s30, 7
    s_waitcnt lgkmcnt(0)
    v_cmp_gt_u32 vcc, s65, v4
    s_nop 0
    s_cmp_lg_u64 vcc, 0
    s_cbranch_scc1 L_mega_kernel_nokv_274
    s_sub_u32 s56, s33, s30
    s_and_b32 s56, s56, 7
    s_mul_i32 s57, s56, 17408
    s_add_u32 s57, s57, 2097152
    s_add_u32 m0, s34, 0
    s_add_u32 s60, s57, 0
    buffer_load_dwordx4 v2, s[4:7], s60 offen sc1 lds
    ds_read_b32 v4, v3
    s_waitcnt lgkmcnt(0)
    s_add_u32 m0, s34, 1024
    s_add_u32 s60, s57, 1024
    buffer_load_dwordx4 v2, s[4:7], s60 offen sc1 lds
    s_add_u32 m0, s34, 2048
    s_add_u32 s60, s57, 2048
    buffer_load_dwordx4 v2, s[4:7], s60 offen sc1 lds
    ds_read_b32 v4, v3
    s_waitcnt lgkmcnt(0)
    s_add_u32 m0, s34, 3072
    s_add_u32 s60, s57, 3072
    buffer_load_dwordx4 v2, s[4:7], s60 offen sc1 lds
    s_add_u32 m0, s34, 4096
    s_add_u32 s60, s57, 4096
    buffer_load_dwordx4 v2, s[4:7], s60 offen sc1 lds
    ds_read_b32 v4, v3
    s_waitcnt lgkmcnt(0)
    s_add_u32 m0, s34, 5120
    s_add_u32 s60, s57, 5120
    buffer_load_dwordx4 v2, s[4:7], s60 offen sc1 lds
    s_add_u32 m0, s34, 6144
    s_add_u32 s60, s57, 6144
    buffer_load_dwordx4 v2, s[4:7], s60 offen sc1 lds
    ds_read_b32 v4, v3
    s_waitcnt lgkmcnt(0)
    s_add_u32 m0, s34, 7168
    s_add_u32 s60, s57, 7168
    buffer_load_dwordx4 v2, s[4:7], s60 offen sc1 lds
    s_add_u32 m0, s34, 8192
    s_add_u32 s60, s57, 8192
    buffer_load_dwordx4 v2, s[4:7], s60 offen sc1 lds
    ds_read_b32 v4, v3
    s_waitcnt lgkmcnt(0)
    s_add_u32 m0, s34, 9216
    s_add_u32 s60, s57, 9216
    buffer_load_dwordx4 v2, s[4:7], s60 offen sc1 lds
    s_add_u32 m0, s34, 10240
    s_add_u32 s60, s57, 10240
    buffer_load_dwordx4 v2, s[4:7], s60 offen sc1 lds
    ds_read_b32 v4, v3
    s_waitcnt lgkmcnt(0)
    s_add_u32 m0, s34, 11264
    s_add_u32 s60, s57, 11264
    buffer_load_dwordx4 v2, s[4:7], s60 offen sc1 lds
    s_add_u32 m0, s34, 12288
    s_add_u32 s60, s57, 12288
    buffer_load_dwordx4 v2, s[4:7], s60 offen sc1 lds
    ds_read_b32 v4, v3
    s_waitcnt lgkmcnt(0)
    s_add_u32 m0, s34, 13312
    s_add_u32 s60, s57, 13312
    buffer_load_dwordx4 v2, s[4:7], s60 offen sc1 lds
    s_add_u32 m0, s34, 14336
    s_add_u32 s60, s57, 14336
    buffer_load_dwordx4 v2, s[4:7], s60 offen sc1 lds
    ds_read_b32 v4, v3
    s_waitcnt lgkmcnt(0)
    s_add_u32 m0, s34, 15360
    s_add_u32 s60, s57, 15360
    buffer_load_dwordx4 v2, s[4:7], s60 offen sc1 lds
    s_add_u32 m0, s34, 16384
    s_add_u32 s60, s57, 16384
    buffer_load_dwordx4 v2, s[4:7], s60 offen sc1 lds
    ds_read_b32 v4, v3
    s_waitcnt lgkmcnt(0)
    s_add_u32 s65, s30, 1
    s_mov_b32 m0, 149664
    s_lshl_b32 s82, s65, 2
    s_add_u32 s82, s82, s3
    s_mov_b64 exec, 1
    v_mov_b32 v14, s82
    global_load_lds_dword v[14:15], off
    s_mov_b64 exec, -1
    s_add_u32 s34, s34, 17408
    s_cmp_eq_u32 s34, 149504
    s_cselect_b32 s34, 114688, s34
    s_add_u32 s30, s30, 1
L_mega_kernel_nokv_274:
    s_add_u32 s65, s27, 5
    s_mov_b32 s57, 400000
L_mega_kernel_lp4_275:
    ds_read_b32 v4, v5
    s_waitcnt lgkmcnt(0)
    v_cmp_gt_u32 vcc, s65, v4
    s_sub_u32 s57, s57, 1
    s_cmp_eq_u64 vcc, 0
    s_cbranch_scc1 L_mega_kernel_ok4_276
    s_sleep 4
    s_cmp_lg_u32 s57, 0
    s_cbranch_scc1 L_mega_kernel_lp4_275
L_mega_kernel_ok4_276:
    s_add_u32 s59, s28, 3
    s_and_b32 s59, s59, 7
    s_lshl_b32 s60, s59, 7
    s_add_u32 s60, s60, s29
    s_lshl_b32 s61, s59, 2
    s_add_u32 s61, s61, s27
    s_mul_i32 s61, s61, 57344
    s_lshl_b32 s62, s27, 13
    s_lshl_b32 s63, s27, 12
    s_add_u32 m0, s62, 32768
    s_add_u32 s56, s61, 0
    buffer_load_dwordx4 v25, s[12:15], s56 offen lds
    s_add_u32 m0, s62, 33792
    s_add_u32 s56, s61, 14336
    buffer_load_dwordx4 v25, s[12:15], s56 offen lds
    ds_read_b32 v4, v3
    s_waitcnt lgkmcnt(0)
    s_add_u32 m0, s62, 34816
    s_add_u32 s56, s61, 28672
    buffer_load_dwordx4 v26, s[12:15], s56 offen lds
    s_add_u32 m0, s62, 35840
    s_add_u32 s56, s61, 43008
    buffer_load_dwordx4 v26, s[12:15], s56 offen lds
    ds_read_b32 v4, v3
    s_waitcnt lgkmcnt(0)
    s_add_u32 m0, s62, 36864
    s_add_u32 s56, s61, 0
    buffer_load_dwordx4 v25, s[16:19], s56 offen lds
    s_add_u32 m0, s62, 37888
    s_add_u32 s56, s61, 14336
    buffer_load_dwordx4 v25, s[16:19], s56 offen lds
    ds_read_b32 v4, v3
    s_waitcnt lgkmcnt(0)
    s_add_u32 m0, s62, 38912
    s_add_u32 s56, s61, 28672
    buffer_load_dwordx4 v26, s[16:19], s56 offen lds
    s_add_u32 m0, s62, 39936
    s_add_u32 s56, s61, 43008
    buffer_load_dwordx4 v26, s[16:19], s56 offen lds
    ds_read_b32 v4, v3
    s_waitcnt lgkmcnt(0)
    s_add_u32 m0, s39, 112
    s_add_u32 s82, s3, 16
    s_mov_b64 exec, 1
    v_mov_b32 v14, s82
    global_load_lds_dword v[14:15], off
    s_mov_b64 exec, -1
    s_mov_b32 s57, 400000
L_mega_kernel_lp4_277:
    ds_read_b32 v4, v5
    s_waitcnt lgkmcnt(0)
    v_cmp_gt_u32 vcc, 8, v4
    s_sub_u32 s57, s57, 1
    s_cmp_eq_u64 vcc, 0
    s_cbranch_scc1 L_mega_kernel_ok4_278
    s_sleep 4
    s_cmp_lg_u32 s57, 0
    s_cbranch_scc1 L_mega_kernel_lp4_277
L_mega_kernel_ok4_278:
    s_add_u32 s59, s28, 4
    s_and_b32 s59, s59, 7
    s_lshl_b32 s60, s59, 7
    s_add_u32 s60, s60, s29
    s_lshl_b32 s63, s27, 12
    s_add_u32 m0, s63, 65536
    s_add_u32 s56, s60, 0
    buffer_load_dwordx4 v6, s[8:11], s56 offen lds
    s_add_u32 m0, s63, 66560
    s_add_u32 s56, s60, 8192
    buffer_load_dwordx4 v7, s[8:11], s56 offen lds
    ds_read_b32 v4, v3
    s_waitcnt lgkmcnt(0)
    s_add_u32 m0, s63, 67584
    s_add_u32 s56, s60, 16384
    buffer_load_dwordx4 v6, s[8:11], s56 offen lds
    s_add_u32 m0, s63, 68608
    s_add_u32 s56, s60, 24576
    buffer_load_dwordx4 v7, s[8:11], s56 offen lds
    ds_read_b32 v4, v3
    s_waitcnt lgkmcnt(0)
    s_add_u32 m0, s39, 128
    s_add_u32 s82, s3, 20
    s_mov_b64 exec, 1
    v_mov_b32 v14, s82
    global_load_lds_dword v[14:15], off
    s_mov_b64 exec, -1
    s_cmp_lg_u32 s27, 2
    s_cbranch_scc1 L_mega_kernel_nowd_279
    s_waitcnt vmcnt(14)
    s_mov_b64 exec, 2
    ds_add_u32 v3, v1 offset:44
    s_mov_b64 exec, -1
    s_mov_b32 s57, 400000
L_mega_kernel_lp_280:
    ds_read_b32 v4, v3 offset:16
    s_waitcnt lgkmcnt(0)
    v_readfirstlane_b32 s56, v4
    s_sub_u32 s57, s57, 1
    s_cmp_ge_u32 s56, 4
    s_cbranch_scc1 L_mega_kernel_ok_281
    s_sleep 1
    s_cmp_lg_u32 s57, 0
    s_cbranch_scc1 L_mega_kernel_lp_280
L_mega_kernel_ok_281:
    ds_read_b32 v10, v3 offset:60
    s_waitcnt lgkmcnt(0)
    v_readfirstlane_b32 s56, v10
    s_add_u32 s56, s56, 1
    v_mov_b32 v10, s56
    v_lshlrev_b32 v8, 10, v1
    s_lshl_b32 s56, s26, 2
    s_add_u32 s56, s56, 2686976
    s_mov_b64 exec, 0xff
    buffer_store_dword v10, v8, s[4:7], s56 offen sc1
    s_mov_b64 exec, -1
L_mega_kernel_nowd_279:
    s_cmp_lg_u32 s27, 1
    s_cbranch_scc1 L_mega_kernel_nokv_282
    s_cmp_ge_u32 s30, 8
    s_cbranch_scc1 L_mega_kernel_nokv_282
    ds_read_b32 v4, v29
    s_add_u32 s65, s30, 7
    s_waitcnt lgkmcnt(0)
    v_cmp_gt_u32 vcc, s65, v4
    s_nop 0
    s_cmp_lg_u64 vcc, 0
    s_cbranch_scc1 L_mega_kernel_nokv_282
    s_sub_u32 s56, s33, s30
    s_and_b32 s56, s56, 7
    s_mul_i32 s57, s56, 17408
    s_add_u32 s57, s57, 2097152
    s_add_u32 m0, s34, 0
    s_add_u32 s60, s57, 0
    buffer_load_dwordx4 v2, s[4:7], s60 offen sc1 lds
    s_add_u32 m0, s34, 1024
    s_add_u32 s60, s57, 1024
    buffer_load_dwordx4 v2, s[4:7], s60 offen sc1 lds
    ds_read_b32 v4, v3
    s_waitcnt lgkmcnt(0)
    s_add_u32 m0, s34, 2048
    s_add_u32 s60, s57, 2048
    buffer_load_dwordx4 v2, s[4:7], s60 offen sc1 lds
    s_add_u32 m0, s34, 3072
    s_add_u32 s60, s57, 3072
    buffer_load_dwordx4 v2, s[4:7], s60 offen sc1 lds
    ds_read_b32 v4, v3
    s_waitcnt lgkmcnt(0)
    s_add_u32 m0, s34, 4096
    s_add_u32 s60, s57, 4096
    buffer_load_dwordx4 v2, s[4:7], s60 offen sc1 lds
    s_add_u32 m0, s34, 5120
    s_add_u32 s60, s57, 5120
    buffer_load_dwordx4 v2, s[4:7], s60 offen sc1 lds
    ds_read_b32 v4, v3
    s_waitcnt lgkmcnt(0)
    s_add_u32 m0, s34, 6144
    s_add_u32 s60, s57, 6144
    buffer_load_dwordx4 v2, s[4:7], s60 offen sc1 lds
    s_add_u32 m0, s34, 7168
    s_add_u32 s60, s57, 7168
    buffer_load_dwordx4 v2, s[4:7], s60 offen sc1 lds
    ds_read_b32 v4, v3
    s_waitcnt lgkmcnt(0)
    s_add_u32 m0, s34, 8192
    s_add_u32 s60, s57, 8192
    buffer_load_dwordx4 v2, s[4:7], s60 offen sc1 lds
    s_add_u32 m0, s34, 9216
    s_add_u32 s60, s57, 9216
    buffer_load_dwordx4 v2, s[4:7], s60 offen sc1 lds
    ds_read_b32 v4, v3
    s_waitcnt lgkmcnt(0)
    s_add_u32 m0, s34, 10240
    s_add_u32 s60, s57, 10240
    buffer_load_dwordx4 v2, s[4:7], s60 offen sc1 lds
    s_add_u32 m0, s34, 11264
    s_add_u32 s60, s57, 11264
    buffer_load_dwordx4 v2, s[4:7], s60 offen sc1 lds
    ds_read_b32 v4, v3
    s_waitcnt lgkmcnt(0)
    s_add_u32 m0, s34, 12288
    s_add_u32 s60, s57, 12288
    buffer_load_dwordx4 v2, s[4:7], s60 offen sc1 lds
    s_add_u32 m0, s34, 13312
    s_add_u32 s60, s57, 13312
    buffer_load_dwordx4 v2, s[4:7], s60 offen sc1 lds
    ds_read_b32 v4, v3
    s_waitcnt lgkmcnt(0)
    s_add_u32 m0, s34, 14336
    s_add_u32 s60, s57, 14336
    buffer_load_dwordx4 v2, s[4:7], s60 offen sc1 lds
    s_add_u32 m0, s34, 15360
    s_add_u32 s60, s57, 15360
    buffer_load_dwordx4 v2, s[4:7], s60 offen sc1 lds
    ds_read_b32 v4, v3
    s_waitcnt lgkmcnt(0)
    s_add_u32 m0, s34, 16384
    s_add_u32 s60, s57, 16384
    buffer_load_dwordx4 v2, s[4:7], s60 offen sc1 lds
    s_add_u32 s65, s30, 1
    s_mov_b32 m0, 149664
    s_lshl_b32 s82, s65, 2
    s_add_u32 s82, s82, s3
    s_mov_b64 exec, 1
    v_mov_b32 v14, s82
    global_load_lds_dword v[14:15], off
    s_mov_b64 exec, -1
    s_add_u32 s34, s34, 17408
    s_cmp_eq_u32 s34, 149504
    s_cselect_b32 s34, 114688, s34
    s_add_u32 s30, s30, 1
L_mega_kernel_nokv_282:
    s_add_u32 s65, s27, 9
    s_mov_b32 s57, 400000
L_mega_kernel_lp4_283:
    ds_read_b32 v4, v5
    s_waitcnt lgkmcnt(0)
    v_cmp_gt_u32 vcc, s65, v4
    s_sub_u32 s57, s57, 1
    s_cmp_eq_u64 vcc, 0
    s_cbranch_scc1 L_mega_kernel_ok4_284
    s_sleep 4
    s_cmp_lg_u32 s57, 0
    s_cbranch_scc1 L_mega_kernel_lp4_283
L_mega_kernel_ok4_284:
    s_add_u32 s59, s28, 4
    s_and_b32 s59, s59, 7
    s_lshl_b32 s60, s59, 7
    s_add_u32 s60, s60, s29
    s_lshl_b32 s61, s59, 2
    s_add_u32 s61, s61, s27
    s_mul_i32 s61, s61, 57344
    s_lshl_b32 s62, s27, 13
    s_lshl_b32 s63, s27, 12
    s_add_u32 m0, s62, 0
    s_add_u32 s56, s61, 0
    buffer_load_dwordx4 v25, s[12:15], s56 offen lds
    ds_read_b32 v4, v3
    s_waitcnt lgkmcnt(0)
    s_add_u32 m0, s62, 1024
    s_add_u32 s56, s61, 14336
    buffer_load_dwordx4 v25, s[12:15], s56 offen lds
    s_add_u32 m0, s62, 2048
    s_add_u32 s56, s61, 28672
    buffer_load_dwordx4 v26, s[12:15], s56 offen lds
    ds_read_b32 v4, v3
    s_waitcnt lgkmcnt(0)
    s_add_u32 m0, s62, 3072
    s_add_u32 s56, s61, 43008
    buffer_load_dwordx4 v26, s[12:15], s56 offen lds
    s_add_u32 m0, s62, 4096
    s_add_u32 s56, s61, 0
    buffer_load_dwordx4 v25, s[16:19], s56 offen lds
    ds_read_b32 v4, v3
    s_waitcnt lgkmcnt(0)
    s_add_u32 m0, s62, 5120
    s_add_u32 s56, s61, 14336
    buffer_load_dwordx4 v25, s[16:19], s56 offen lds
    s_add_u32 m0, s62, 6144
    s_add_u32 s56, s61, 28672
    buffer_load_dwordx4 v26, s[16:19], s56 offen lds
    ds_read_b32 v4, v3
    s_waitcnt lgkmcnt(0)
    s_add_u32 m0, s62, 7168
    s_add_u32 s56, s61, 43008
    buffer_load_dwordx4 v26, s[16:19], s56 offen lds
    s_add_u32 m0, s39, 112
    s_add_u32 s82, s3, 20
    s_mov_b64 exec, 1
    v_mov_b32 v14, s82
    global_load_lds_dword v[14:15], off
    s_mov_b64 exec, -1
    s_mov_b32 s57, 400000
L_mega_kernel_lp4_285:
    ds_read_b32 v4, v5
    s_waitcnt lgkmcnt(0)
    v_cmp_gt_u32 vcc, 12, v4
    s_sub_u32 s57, s57, 1
    s_cmp_eq_u64 vcc, 0
    s_cbranch_scc1 L_mega_kernel_ok4_286
    s_sleep 4
    s_cmp_lg_u32 s57, 0
    s_cbranch_scc1 L_mega_kernel_lp4_285
L_mega_kernel_ok4_286:
    s_add_u32 s59, s28, 5
    s_and_b32 s59, s59, 7
    s_lshl_b32 s60, s59, 7
    s_add_u32 s60, s60, s29
    s_lshl_b32 s63, s27, 12
    s_add_u32 m0, s63, 81920
    s_add_u32 s56, s60, 0
    buffer_load_dwordx4 v6, s[8:11], s56 offen lds
    ds_read_b32 v4, v3
    s_waitcnt lgkmcnt(0)
    s_add_u32 m0, s63, 82944
    s_add_u32 s56, s60, 8192
    buffer_load_dwordx4 v7, s[8:11], s56 offen lds
    s_add_u32 m0, s63, 83968
    s_add_u32 s56, s60, 16384
    buffer_load_dwordx4 v6, s[8:11], s56 offen lds
    ds_read_b32 v4, v3
    s_waitcnt lgkmcnt(0)
    s_add_u32 m0, s63, 84992
    s_add_u32 s56, s60, 24576
    buffer_load_dwordx4 v7, s[8:11], s56 offen lds
    s_add_u32 m0, s39, 128
    s_add_u32 s82, s3, 24
    s_mov_b64 exec, 1
    v_mov_b32 v14, s82
    global_load_lds_dword v[14:15], off
    s_mov_b64 exec, -1
    s_cmp_lg_u32 s27, 1
    s_cbranch_scc1 L_mega_kernel_nokv_287
    s_cmp_ge_u32 s30, 8
    s_cbranch_scc1 L_mega_kernel_nokv_287
    ds_read_b32 v4, v29
    s_add_u32 s65, s30, 7
    s_waitcnt lgkmcnt(0)
    v_cmp_gt_u32 vcc, s65, v4
    s_nop 0
    s_cmp_lg_u64 vcc, 0
    s_cbranch_scc1 L_mega_kernel_nokv_287
    s_sub_u32 s56, s33, s30
    s_and_b32 s56, s56, 7
    s_mul_i32 s57, s56, 17408
    s_add_u32 s57, s57, 2097152
    s_add_u32 m0, s34, 0
    s_add_u32 s60, s57, 0
    buffer_load_dwordx4 v2, s[4:7], s60 offen sc1 lds
    ds_read_b32 v4, v3
    s_waitcnt lgkmcnt(0)
    s_add_u32 m0, s34, 1024
    s_add_u32 s60, s57, 1024
    buffer_load_dwordx4 v2, s[4:7], s60 offen sc1 lds
    s_add_u32 m0, s34, 2048
    s_add_u32 s60, s57, 2048
    buffer_load_dwordx4 v2, s[4:7], s60 offen sc1 lds
    ds_read_b32 v4, v3
    s_waitcnt lgkmcnt(0)
    s_add_u32 m0, s34, 3072
    s_add_u32 s60, s57, 3072
    buffer_load_dwordx4 v2, s[4:7], s60 offen sc1 lds
    s_add_u32 m0, s34, 4096
    s_add_u32 s60, s57, 4096
    buffer_load_dwordx4 v2, s[4:7], s60 offen sc1 lds
    ds_read_b32 v4, v3
    s_waitcnt lgkmcnt(0)
    s_add_u32 m0, s34, 5120
    s_add_u32 s60, s57, 5120
    buffer_load_dwordx4 v2, s[4:7], s60 offen sc1 lds
    s_add_u32 m0, s34, 6144
    s_add_u32 s60, s57, 6144
    buffer_load_dwordx4 v2, s[4:7], s60 offen sc1 lds
    ds_read_b32 v4, v3
    s_waitcnt lgkmcnt(0)
    s_add_u32 m0, s34, 7168
    s_add_u32 s60, s57, 7168
    buffer_load_dwordx4 v2, s[4:7], s60 offen sc1 lds
    s_add_u32 m0, s34, 8192
    s_add_u32 s60, s57, 8192
    buffer_load_dwordx4 v2, s[4:7], s60 offen sc1 lds
    ds_read_b32 v4, v3
    s_waitcnt lgkmcnt(0)
    s_add_u32 m0, s34, 9216
    s_add_u32 s60, s57, 9216
    buffer_load_dwordx4 v2, s[4:7], s60 offen sc1 lds
    s_add_u32 m0, s34, 10240
    s_add_u32 s60, s57, 10240
    buffer_load_dwordx4 v2, s[4:7], s60 offen sc1 lds
    ds_read_b32 v4, v3
    s_waitcnt lgkmcnt(0)
    s_add_u32 m0, s34, 11264
    s_add_u32 s60, s57, 11264
    buffer_load_dwordx4 v2, s[4:7], s60 offen sc1 lds
    s_add_u32 m0, s34, 12288
    s_add_u32 s60, s57, 12288
    buffer_load_dwordx4 v2, s[4:7], s60 offen sc1 lds
    ds_read_b32 v4, v3
    s_waitcnt lgkmcnt(0)
    s_add_u32 m0, s34, 13312
    s_add_u32 s60, s57, 13312
    buffer_load_dwordx4 v2, s[4:7], s60 offen sc1 lds
    s_add_u32 m0, s34, 14336
    s_add_u32 s60, s57, 14336
    buffer_load_dwordx4 v2, s[4:7], s60 offen sc1 lds
    ds_read_b32 v4, v3
    s_waitcnt lgkmcnt(0)
    s_add_u32 m0, s34, 15360
    s_add_u32 s60, s57, 15360
    buffer_load_dwordx4 v2, s[4:7], s60 offen sc1 lds
    s_add_u32 m0, s34, 16384
    s_add_u32 s60, s57, 16384
    buffer_load_dwordx4 v2, s[4:7], s60 offen sc1 lds
    ds_read_b32 v4, v3
    s_waitcnt lgkmcnt(0)
    s_add_u32 s65, s30, 1
    s_mov_b32 m0, 149664
    s_lshl_b32 s82, s65, 2
    s_add_u32 s82, s82, s3
    s_mov_b64 exec, 1
    v_mov_b32 v14, s82
    global_load_lds_dword v[14:15], off
    s_mov_b64 exec, -1
    s_add_u32 s34, s34, 17408
    s_cmp_eq_u32 s34, 149504
    s_cselect_b32 s34, 114688, s34
    s_add_u32 s30, s30, 1
L_mega_kernel_nokv_287:
    s_add_u32 s65, s27, 13
    s_mov_b32 s57, 400000
L_mega_kernel_lp4_288:
    ds_read_b32 v4, v5
    s_waitcnt lgkmcnt(0)
    v_cmp_gt_u32 vcc, s65, v4
    s_sub_u32 s57, s57, 1
    s_cmp_eq_u64 vcc, 0
    s_cbranch_scc1 L_mega_kernel_ok4_289
    s_sleep 4
    s_cmp_lg_u32 s57, 0
    s_cbranch_scc1 L_mega_kernel_lp4_288
L_mega_kernel_ok4_289:
    s_add_u32 s59, s28, 5
    s_and_b32 s59, s59, 7
    s_lshl_b32 s60, s59, 7
    s_add_u32 s60, s60, s29
    s_lshl_b32 s61, s59, 2
    s_add_u32 s61, s61, s27
    s_mul_i32 s61, s61, 57344
    s_lshl_b32 s62, s27, 13
    s_lshl_b32 s63, s27, 12
    s_add_u32 m0, s62, 32768
    s_add_u32 s56, s61, 0
    buffer_load_dwordx4 v25, s[12:15], s56 offen lds
    s_add_u32 m0, s62, 33792
    s_add_u32 s56, s61, 14336
    buffer_load_dwordx4 v25, s[12:15], s56 offen lds
    ds_read_b32 v4, v3
    s_waitcnt lgkmcnt(0)
    s_add_u32 m0, s62, 34816
    s_add_u32 s56, s61, 28672
    buffer_load_dwordx4 v26, s[12:15], s56 offen lds
    s_add_u32 m0, s62, 35840
    s_add_u32 s56, s61, 43008
    buffer_load_dwordx4 v26, s[12:15], s56 offen lds
    ds_read_b32 v4, v3
    s_waitcnt lgkmcnt(0)
    s_add_u32 m0, s62, 36864
    s_add_u32 s56, s61, 0
    buffer_load_dwordx4 v25, s[16:19], s56 offen lds
    s_add_u32 m0, s62, 37888
    s_add_u32 s56, s61, 14336
    buffer_load_dwordx4 v25, s[16:19], s56 offen lds
    ds_read_b32 v4, v3
    s_waitcnt lgkmcnt(0)
    s_add_u32 m0, s62, 38912
    s_add_u32 s56, s61, 28672
    buffer_load_dwordx4 v26, s[16:19], s56 offen lds
    s_add_u32 m0, s62, 39936
    s_add_u32 s56, s61, 43008
    buffer_load_dwordx4 v26, s[16:19], s56 offen lds
    ds_read_b32 v4, v3
    s_waitcnt lgkmcnt(0)
    s_add_u32 m0, s39, 112
    s_add_u32 s82, s3, 24
    s_mov_b64 exec, 1
    v_mov_b32 v14, s82
    global_load_lds_dword v[14:15], off
    s_mov_b64 exec, -1
    s_mov_b32 s57, 400000
L_mega_kernel_lp4_290:
    ds_read_b32 v4, v5
    s_waitcnt lgkmcnt(0)
    v_cmp_gt_u32 vcc, 16, v4
    s_sub_u32 s57, s57, 1
    s_cmp_eq_u64 vcc, 0
    s_cbranch_scc1 L_mega_kernel_ok4_291
    s_sleep 4
    s_cmp_lg_u32 s57, 0
    s_cbranch_scc1 L_mega_kernel_lp4_290
L_mega_kernel_ok4_291:
    s_add_u32 s59, s28, 6
    s_and_b32 s59, s59, 7
    s_lshl_b32 s60, s59, 7
    s_add_u32 s60, s60, s29
    s_lshl_b32 s63, s27, 12
    s_add_u32 m0, s63, 98304
    s_add_u32 s56, s60, 0
    buffer_load_dwordx4 v6, s[8:11], s56 offen lds
    s_add_u32 m0, s63, 99328
    s_add_u32 s56, s60, 8192
    buffer_load_dwordx4 v7, s[8:11], s56 offen lds
    ds_read_b32 v4, v3
    s_waitcnt lgkmcnt(0)
    s_add_u32 m0, s63, 100352
    s_add_u32 s56, s60, 16384
    buffer_load_dwordx4 v6, s[8:11], s56 offen lds
    s_add_u32 m0, s63, 101376
    s_add_u32 s56, s60, 24576
    buffer_load_dwordx4 v7, s[8:11], s56 offen lds
    ds_read_b32 v4, v3
    s_waitcnt lgkmcnt(0)
    s_add_u32 m0, s39, 128
    s_add_u32 s82, s3, 28
    s_mov_b64 exec, 1
    v_mov_b32 v14, s82
    global_load_lds_dword v[14:15], off
    s_mov_b64 exec, -1
    s_cmp_lg_u32 s27, 1
    s_cbranch_scc1 L_mega_kernel_nokv_292
    s_cmp_ge_u32 s30, 8
    s_cbranch_scc1 L_mega_kernel_nokv_292
    ds_read_b32 v4, v29
    s_add_u32 s65, s30, 7
    s_waitcnt lgkmcnt(0)
    v_cmp_gt_u32 vcc, s65, v4
    s_nop 0
    s_cmp_lg_u64 vcc, 0
    s_cbranch_scc1 L_mega_kernel_nokv_292
    s_sub_u32 s56, s33, s30
    s_and_b32 s56, s56, 7
    s_mul_i32 s57, s56, 17408
    s_add_u32 s57, s57, 2097152
    s_add_u32 m0, s34, 0
    s_add_u32 s60, s57, 0
    buffer_load_dwordx4 v2, s[4:7], s60 offen sc1 lds
    s_add_u32 m0, s34, 1024
    s_add_u32 s60, s57, 1024
    buffer_load_dwordx4 v2, s[4:7], s60 offen sc1 lds
    ds_read_b32 v4, v3
    s_waitcnt lgkmcnt(0)
    s_add_u32 m0, s34, 2048
    s_add_u32 s60, s57, 2048
    buffer_load_dwordx4 v2, s[4:7], s60 offen sc1 lds
    s_add_u32 m0, s34, 3072
    s_add_u32 s60, s57, 3072
    buffer_load_dwordx4 v2, s[4:7], s60 offen sc1 lds
    ds_read_b32 v4, v3
    s_waitcnt lgkmcnt(0)
    s_add_u32 m0, s34, 4096
    s_add_u32 s60, s57, 4096
    buffer_load_dwordx4 v2, s[4:7], s60 offen sc1 lds
    s_add_u32 m0, s34, 5120
    s_add_u32 s60, s57, 5120
    buffer_load_dwordx4 v2, s[4:7], s60 offen sc1 lds
    ds_read_b32 v4, v3
    s_waitcnt lgkmcnt(0)
    s_add_u32 m0, s34, 6144
    s_add_u32 s60, s57, 6144
    buffer_load_dwordx4 v2, s[4:7], s60 offen sc1 lds
    s_add_u32 m0, s34, 7168
    s_add_u32 s60, s57, 7168
    buffer_load_dwordx4 v2, s[4:7], s60 offen sc1 lds
    ds_read_b32 v4, v3
    s_waitcnt lgkmcnt(0)
    s_add_u32 m0, s34, 8192
    s_add_u32 s60, s57, 8192
    buffer_load_dwordx4 v2, s[4:7], s60 offen sc1 lds
    s_add_u32 m0, s34, 9216
    s_add_u32 s60, s57, 9216
    buffer_load_dwordx4 v2, s[4:7], s60 offen sc1 lds
    ds_read_b32 v4, v3
    s_waitcnt lgkmcnt(0)
    s_add_u32 m0, s34, 10240
    s_add_u32 s60, s57, 10240
    buffer_load_dwordx4 v2, s[4:7], s60 offen sc1 lds
    s_add_u32 m0, s34, 11264
    s_add_u32 s60, s57, 11264
    buffer_load_dwordx4 v2, s[4:7], s60 offen sc1 lds
    ds_read_b32 v4, v3
    s_waitcnt lgkmcnt(0)
    s_add_u32 m0, s34, 12288
    s_add_u32 s60, s57, 12288
    buffer_load_dwordx4 v2, s[4:7], s60 offen sc1 lds
    s_add_u32 m0, s34, 13312
    s_add_u32 s60, s57, 13312
    buffer_load_dwordx4 v2, s[4:7], s60 offen sc1 lds
    ds_read_b32 v4, v3
    s_waitcnt lgkmcnt(0)
    s_add_u32 m0, s34, 14336
    s_add_u32 s60, s57, 14336
    buffer_load_dwordx4 v2, s[4:7], s60 offen sc1 lds
    s_add_u32 m0, s34, 15360
    s_add_u32 s60, s57, 15360
    buffer_load_dwordx4 v2, s[4:7], s60 offen sc1 lds
    ds_read_b32 v4, v3
    s_waitcnt lgkmcnt(0)
    s_add_u32 m0, s34, 16384
    s_add_u32 s60, s57, 16384
    buffer_load_dwordx4 v2, s[4:7], s60 offen sc1 lds
    s_add_u32 s65, s30, 1
    s_mov_b32 m0, 149664
    s_lshl_b32 s82, s65, 2
    s_add_u32 s82, s82, s3
    s_mov_b64 exec, 1
    v_mov_b32 v14, s82
    global_load_lds_dword v[14:15], off
    s_mov_b64 exec, -1
    s_add_u32 s34, s34, 17408
    s_cmp_eq_u32 s34, 149504
    s_cselect_b32 s34, 114688, s34
    s_add_u32 s30, s30, 1
L_mega_kernel_nokv_292:
    s_add_u32 s65, s27, 17
    s_mov_b32 s57, 400000
L_mega_kernel_lp4_293:
    ds_read_b32 v4, v5
    s_waitcnt lgkmcnt(0)
    v_cmp_gt_u32 vcc, s65, v4
    s_sub_u32 s57, s57, 1
    s_cmp_eq_u64 vcc, 0
    s_cbranch_scc1 L_mega_kernel_ok4_294
    s_sleep 4
    s_cmp_lg_u32 s57, 0
    s_cbranch_scc1 L_mega_kernel_lp4_293
L_mega_kernel_ok4_294:
    s_add_u32 s59, s28, 6
    s_and_b32 s59, s59, 7
    s_lshl_b32 s60, s59, 7
    s_add_u32 s60, s60, s29
    s_lshl_b32 s61, s59, 2
    s_add_u32 s61, s61, s27
    s_mul_i32 s61, s61, 57344
    s_lshl_b32 s62, s27, 13
    s_lshl_b32 s63, s27, 12
    s_add_u32 m0, s62, 0
    s_add_u32 s56, s61, 0
    buffer_load_dwordx4 v25, s[12:15], s56 offen lds
    ds_read_b32 v4, v3
    s_waitcnt lgkmcnt(0)
    s_add_u32 m0, s62, 1024
    s_add_u32 s56, s61, 14336
    buffer_load_dwordx4 v25, s[12:15], s56 offen lds
    s_add_u32 m0, s62, 2048
    s_add_u32 s56, s61, 28672
    buffer_load_dwordx4 v26, s[12:15], s56 offen lds
    ds_read_b32 v4, v3
    s_waitcnt lgkmcnt(0)
    s_add_u32 m0, s62, 3072
    s_add_u32 s56, s61, 43008
    buffer_load_dwordx4 v26, s[12:15], s56 offen lds
    s_add_u32 m0, s62, 4096
    s_add_u32 s56, s61, 0
    buffer_load_dwordx4 v25, s[16:19], s56 offen lds
    ds_read_b32 v4, v3
    s_waitcnt lgkmcnt(0)
    s_add_u32 m0, s62, 5120
    s_add_u32 s56, s61, 14336
    buffer_load_dwordx4 v25, s[16:19], s56 offen lds
    s_add_u32 m0, s62, 6144
    s_add_u32 s56, s61, 28672
    buffer_load_dwordx4 v26, s[16:19], s56 offen lds
    ds_read_b32 v4, v3
    s_waitcnt lgkmcnt(0)
    s_add_u32 m0, s62, 7168
    s_add_u32 s56, s61, 43008
    buffer_load_dwordx4 v26, s[16:19], s56 offen lds
    s_add_u32 m0, s39, 112
    s_add_u32 s82, s3, 28
    s_mov_b64 exec, 1
    v_mov_b32 v14, s82
    global_load_lds_dword v[14:15], off
    s_mov_b64 exec, -1
    s_mov_b32 s57, 400000
L_mega_kernel_lp4_295:
    ds_read_b32 v4, v5
    s_waitcnt lgkmcnt(0)
    v_cmp_gt_u32 vcc, 20, v4
    s_sub_u32 s57, s57, 1
    s_cmp_eq_u64 vcc, 0
    s_cbranch_scc1 L_mega_kernel_ok4_296
    s_sleep 4
    s_cmp_lg_u32 s57, 0
    s_cbranch_scc1 L_mega_kernel_lp4_295
L_mega_kernel_ok4_296:
    s_add_u32 s59, s28, 7
    s_and_b32 s59, s59, 7
    s_lshl_b32 s60, s59, 7
    s_add_u32 s60, s60, s29
    s_lshl_b32 s63, s27, 12
    s_add_u32 m0, s63, 65536
    s_add_u32 s56, s60, 0
    buffer_load_dwordx4 v6, s[8:11], s56 offen lds
    ds_read_b32 v4, v3
    s_waitcnt lgkmcnt(0)
    s_add_u32 m0, s63, 66560
    s_add_u32 s56, s60, 8192
    buffer_load_dwordx4 v7, s[8:11], s56 offen lds
    s_add_u32 m0, s63, 67584
    s_add_u32 s56, s60, 16384
    buffer_load_dwordx4 v6, s[8:11], s56 offen lds
    ds_read_b32 v4, v3
    s_waitcnt lgkmcnt(0)
    s_add_u32 m0, s63, 68608
    s_add_u32 s56, s60, 24576
    buffer_load_dwordx4 v7, s[8:11], s56 offen lds
    s_add_u32 m0, s39, 128
    s_add_u32 s82, s3, 32
    s_mov_b64 exec, 1
    v_mov_b32 v14, s82
    global_load_lds_dword v[14:15], off
    s_mov_b64 exec, -1
    s_cmp_lg_u32 s27, 3
    s_cbranch_scc1 L_mega_kernel_noxa_297
    s_and_b32 s35, s2, 7
    s_lshl_b32 s35, s35, 10
    s_add_u32 s35, s35, 2686976
    buffer_load_dwordx4 v[60:63], v2, s[4:7], s35 offen sc1
    v_and_b32 v8, 15, v1
    v_and_b32 v9, 16, v1
    v_mul_u32_u24 v9, 112, v9
    v_add_u32 v8, v8, v9
    v_lshlrev_b32 v8, 4, v8
    s_mul_i32 s56, s22, 112
    s_lshl_b32 s56, s56, 4
    s_add_u32 s56, s56, 2326528
    s_add_u32 s57, s56, 1024
    buffer_load_dwordx4 v[32:35], v8, s[4:7], s56 offen offset:0 sc1
    buffer_load_dwordx4 v[36:39], v8, s[4:7], s56 offen offset:256 sc1
    buffer_load_dwordx4 v[40:43], v8, s[4:7], s56 offen offset:512 sc1
    buffer_load_dwordx4 v[44:47], v8, s[4:7], s56 offen offset:768 sc1
    buffer_load_dwordx4 v[48:51], v8, s[4:7], s57 offen offset:0 sc1
    buffer_load_dwordx4 v[52:55], v8, s[4:7], s57 offen offset:256 sc1
    buffer_load_dwordx4 v[56:59], v8, s[4:7], s57 offen offset:512 sc1
L_mega_kernel_noxa_297:
    s_cmp_lg_u32 s27, 1
    s_cbranch_scc1 L_mega_kernel_nokv_298
    s_cmp_ge_u32 s30, 8
    s_cbranch_scc1 L_mega_kernel_nokv_298
    ds_read_b32 v4, v29
    s_add_u32 s65, s30, 7
    s_waitcnt lgkmcnt(0)
    v_cmp_gt_u32 vcc, s65, v4
    s_nop 0
    s_cmp_lg_u64 vcc, 0
    s_cbranch_scc1 L_mega_kernel_nokv_298
    s_sub_u32 s56, s33, s30
    s_and_b32 s56, s56, 7
    s_mul_i32 s57, s56, 17408
    s_add_u32 s57, s57, 2097152
    s_add_u32 m0, s34, 0
    s_add_u32 s60, s57, 0
    buffer_load_dwordx4 v2, s[4:7], s60 offen sc1 lds
    ds_read_b32 v4, v3
    s_waitcnt lgkmcnt(0)
    s_add_u32 m0, s34, 1024
    s_add_u32 s60, s57, 1024
    buffer_load_dwordx4 v2, s[4:7], s60 offen sc1 lds
    s_add_u32 m0, s34, 2048
    s_add_u32 s60, s57, 2048
    buffer_load_dwordx4 v2, s[4:7], s60 offen sc1 lds
    ds_read_b32 v4, v3
    s_waitcnt lgkmcnt(0)
    s_add_u32 m0, s34, 3072
    s_add_u32 s60, s57, 3072
    buffer_load_dwordx4 v2, s[4:7], s60 offen sc1 lds
    s_add_u32 m0, s34, 4096
    s_add_u32 s60, s57, 4096
    buffer_load_dwordx4 v2, s[4:7], s60 offen sc1 lds
    ds_read_b32 v4, v3
    s_waitcnt lgkmcnt(0)
    s_add_u32 m0, s34, 5120
    s_add_u32 s60, s57, 5120
    buffer_load_dwordx4 v2, s[4:7], s60 offen sc1 lds
    s_add_u32 m0, s34, 6144
    s_add_u32 s60, s57, 6144
    buffer_load_dwordx4 v2, s[4:7], s60 offen sc1 lds
    ds_read_b32 v4, v3
    s_waitcnt lgkmcnt(0)
    s_add_u32 m0, s34, 7168
    s_add_u32 s60, s57, 7168
    buffer_load_dwordx4 v2, s[4:7], s60 offen sc1 lds
    s_add_u32 m0, s34, 8192
    s_add_u32 s60, s57, 8192
    buffer_load_dwordx4 v2, s[4:7], s60 offen sc1 lds
    ds_read_b32 v4, v3
    s_waitcnt lgkmcnt(0)
    s_add_u32 m0, s34, 9216
    s_add_u32 s60, s57, 9216
    buffer_load_dwordx4 v2, s[4:7], s60 offen sc1 lds
    s_add_u32 m0, s34, 10240
    s_add_u32 s60, s57, 10240
    buffer_load_dwordx4 v2, s[4:7], s60 offen sc1 lds
    ds_read_b32 v4, v3
    s_waitcnt lgkmcnt(0)
    s_add_u32 m0, s34, 11264
    s_add_u32 s60, s57, 11264
    buffer_load_dwordx4 v2, s[4:7], s60 offen sc1 lds
    s_add_u32 m0, s34, 12288
    s_add_u32 s60, s57, 12288
    buffer_load_dwordx4 v2, s[4:7], s60 offen sc1 lds
    ds_read_b32 v4, v3
    s_waitcnt lgkmcnt(0)
    s_add_u32 m0, s34, 13312
    s_add_u32 s60, s57, 13312
    buffer_load_dwordx4 v2, s[4:7], s60 offen sc1 lds
    s_add_u32 m0, s34, 14336
    s_add_u32 s60, s57, 14336
    buffer_load_dwordx4 v2, s[4:7], s60 offen sc1 lds
    ds_read_b32 v4, v3
    s_waitcnt lgkmcnt(0)
    s_add_u32 m0, s34, 15360
    s_add_u32 s60, s57, 15360
    buffer_load_dwordx4 v2, s[4:7], s60 offen sc1 lds
    s_add_u32 m0, s34, 16384
    s_add_u32 s60, s57, 16384
    buffer_load_dwordx4 v2, s[4:7], s60 offen sc1 lds
    ds_read_b32 v4, v3
    s_waitcnt lgkmcnt(0)
    s_add_u32 s65, s30, 1
    s_mov_b32 m0, 149664
    s_lshl_b32 s82, s65, 2
    s_add_u32 s82, s82, s3
    s_mov_b64 exec, 1
    v_mov_b32 v14, s82
    global_load_lds_dword v[14:15], off
    s_mov_b64 exec, -1
    s_add_u32 s34, s34, 17408
    s_cmp_eq_u32 s34, 149504
    s_cselect_b32 s34, 114688, s34
    s_add_u32 s30, s30, 1
L_mega_kernel_nokv_298:
    s_add_u32 s65, s27, 21
    s_mov_b32 s57, 400000
L_mega_kernel_lp4_299:
    ds_read_b32 v4, v5
    s_waitcnt lgkmcnt(0)
    v_cmp_gt_u32 vcc, s65, v4
    s_sub_u32 s57, s57, 1
    s_cmp_eq_u64 vcc, 0
    s_cbranch_scc1 L_mega_kernel_ok4_300
    s_sleep 4
    s_cmp_lg_u32 s57, 0
    s_cbranch_scc1 L_mega_kernel_lp4_299
L_mega_kernel_ok4_300:
    s_add_u32 s59, s28, 7
    s_and_b32 s59, s59, 7
    s_lshl_b32 s60, s59, 7
    s_add_u32 s60, s60, s29
    s_lshl_b32 s61, s59, 2
    s_add_u32 s61, s61, s27
    s_mul_i32 s61, s61, 57344
    s_lshl_b32 s62, s27, 13
    s_lshl_b32 s63, s27, 12
    s_add_u32 m0, s62, 32768
    s_add_u32 s56, s61, 0
    buffer_load_dwordx4 v25, s[12:15], s56 offen lds
    s_add_u32 m0, s62, 33792
    s_add_u32 s56, s61, 14336
    buffer_load_dwordx4 v25, s[12:15], s56 offen lds
    ds_read_b32 v4, v3
    s_waitcnt lgkmcnt(0)
    s_add_u32 m0, s62, 34816
    s_add_u32 s56, s61, 28672
    buffer_load_dwordx4 v26, s[12:15], s56 offen lds
    s_add_u32 m0, s62, 35840
    s_add_u32 s56, s61, 43008
    buffer_load_dwordx4 v26, s[12:15], s56 offen lds
    ds_read_b32 v4, v3
    s_waitcnt lgkmcnt(0)
    s_add_u32 m0, s62, 36864
    s_add_u32 s56, s61, 0
    buffer_load_dwordx4 v25, s[16:19], s56 offen lds
    s_add_u32 m0, s62, 37888
    s_add_u32 s56, s61, 14336
    buffer_load_dwordx4 v25, s[16:19], s56 offen lds
    ds_read_b32 v4, v3
    s_waitcnt lgkmcnt(0)
    s_add_u32 m0, s62, 38912
    s_add_u32 s56, s61, 28672
    buffer_load_dwordx4 v26, s[16:19], s56 offen lds
    s_add_u32 m0, s62, 39936
    s_add_u32 s56, s61, 43008
    buffer_load_dwordx4 v26, s[16:19], s56 offen lds
    ds_read_b32 v4, v3
    s_waitcnt lgkmcnt(0)
    s_add_u32 m0, s39, 112
    s_add_u32 s82, s3, 32
    s_mov_b64 exec, 1
    v_mov_b32 v14, s82
    global_load_lds_dword v[14:15], off
    s_mov_b64 exec, -1
    s_cmp_lg_u32 s27, 3
    s_cbranch_scc1 L_mega_kernel_noxb_301
    s_waitcnt vmcnt(9)
    ds_read_b32 v10, v3 offset:60
    s_waitcnt lgkmcnt(0)
    v_readfirstlane_b32 s36, v10
    s_add_u32 s36, s36, 1
    s_mov_b32 s37, 100000
L_mega_kernel_xaretry_302:
    v_xor_b32 v60, s36, v60
    v_xor_b32 v61, s36, v61
    v_xor_b32 v62, s36, v62
    v_xor_b32 v63, s36, v63
    v_or3_b32 v60, v60, v61, v62
    v_or_b32 v60, v60, v63
    v_cmp_ne_u32 vcc, 0, v60
    s_sub_u32 s37, s37, 1
    s_cmp_eq_u64 vcc, 0
    s_cbranch_scc1 L_mega_kernel_xaok_303
    s_cmp_eq_u32 s37, 0
    s_cbranch_scc1 L_mega_kernel_xaok_303
    s_sleep 8
    s_and_b32 s35, s2, 7
    s_lshl_b32 s35, s35, 10
    s_add_u32 s35, s35, 2686976
    buffer_load_dwordx4 v[60:63], v2, s[4:7], s35 offen sc1
    v_and_b32 v8, 15, v1
    v_and_b32 v9, 16, v1
    v_mul_u32_u24 v9, 112, v9
    v_add_u32 v8, v8, v9
    v_lshlrev_b32 v8, 4, v8
    s_mul_i32 s56, s22, 112
    s_lshl_b32 s56, s56, 4
    s_add_u32 s56, s56, 2326528
    s_add_u32 s57, s56, 1024
    buffer_load_dwordx4 v[32:35], v8, s[4:7], s56 offen offset:0 sc1
    buffer_load_dwordx4 v[36:39], v8, s[4:7], s56 offen offset:256 sc1
    buffer_load_dwordx4 v[40:43], v8, s[4:7], s56 offen offset:512 sc1
    buffer_load_dwordx4 v[44:47], v8, s[4:7], s56 offen offset:768 sc1
    buffer_load_dwordx4 v[48:51], v8, s[4:7], s57 offen offset:0 sc1
    buffer_load_dwordx4 v[52:55], v8, s[4:7], s57 offen offset:256 sc1
    buffer_load_dwordx4 v[56:59], v8, s[4:7], s57 offen offset:512 sc1
    s_waitcnt vmcnt(0)
    s_branch L_mega_kernel_xaretry_302
L_mega_kernel_xaok_303:
    v_cmp_gt_u32 vcc, 32, v1
    v_lshlrev_b32 v9, 2, v1
    v_add_u32 v9, 150784, v9
    v_add_f32 v32, v32, v33
    v_add_f32 v34, v34, v35
    v_add_f32 v32, v32, v34
    v_cndmask_b32 v32, 0, v32, vcc
    v_cvt_pk_bf16_f32 v10, v32, v32
    v_lshlrev_b32 v10, 16, v10
    v_sub_f32 v10, v32, v10
    v_cvt_pk_bf16_f32 v32, v32, v10
    ds_write_b32 v9, v32 offset:0
    v_add_f32 v36, v36, v37
    v_add_f32 v38, v38, v39
    v_add_f32 v36, v36, v38
    v_cndmask_b32 v36, 0, v36, vcc
    v_cvt_pk_bf16_f32 v10, v36, v36
    v_lshlrev_b32 v10, 16, v10
    v_sub_f32 v10, v36, v10
    v_cvt_pk_bf16_f32 v36, v36, v10
    ds_write_b32 v9, v36 offset:256
    v_add_f32 v40, v40, v41
    v_add_f32 v42, v42, v43
    v_add_f32 v40, v40, v42
    v_cndmask_b32 v40, 0, v40, vcc
    v_cvt_pk_bf16_f32 v10, v40, v40
    v_lshlrev_b32 v10, 16, v10
    v_sub_f32 v10, v40, v10
    v_cvt_pk_bf16_f32 v40, v40, v10
    ds_write_b32 v9, v40 offset:512
    v_add_f32 v44, v44, v45
    v_add_f32 v46, v46, v47
    v_add_f32 v44, v44, v46
    v_cndmask_b32 v44, 0, v44, vcc
    v_cvt_pk_bf16_f32 v10, v44, v44
    v_lshlrev_b32 v10, 16, v10
    v_sub_f32 v10, v44, v10
    v_cvt_pk_bf16_f32 v44, v44, v10
    ds_write_b32 v9, v44 offset:768
    v_add_f32 v48, v48, v49
    v_add_f32 v50, v50, v51
    v_add_f32 v48, v48, v50
    v_cndmask_b32 v48, 0, v48, vcc
    v_cvt_pk_bf16_f32 v10, v48, v48
    v_lshlrev_b32 v10, 16, v10
    v_sub_f32 v10, v48, v10
    v_cvt_pk_bf16_f32 v48, v48, v10
    ds_write_b32 v9, v48 offset:1024
    v_add_f32 v52, v52, v53
    v_add_f32 v54, v54, v55
    v_add_f32 v52, v52, v54
    v_cndmask_b32 v52, 0, v52, vcc
    v_cvt_pk_bf16_f32 v10, v52, v52
    v_lshlrev_b32 v10, 16, v10
    v_sub_f32 v10, v52, v10
    v_cvt_pk_bf16_f32 v52, v52, v10
    ds_write_b32 v9, v52 offset:1280
    v_add_f32 v56, v56, v57
    v_add_f32 v58, v58, v59
    v_add_f32 v56, v56, v58
    v_cndmask_b32 v56, 0, v56, vcc
    v_cvt_pk_bf16_f32 v10, v56, v56
    v_lshlrev_b32 v10, 16, v10
    v_sub_f32 v10, v56, v10
    v_cvt_pk_bf16_f32 v56, v56, v10
    ds_write_b32 v9, v56 offset:1536
    s_mov_b64 exec, 2
    ds_add_u32 v3, v1 offset:20
    s_mov_b64 exec, -1
L_mega_kernel_noxb_301:
    s_cmp_lg_u32 s27, 1
    s_cbranch_scc1 L_mega_kernel_nokv_304
    s_cmp_ge_u32 s30, 8
    s_cbranch_scc1 L_mega_kernel_nokv_304
    ds_read_b32 v4, v29
    s_add_u32 s65, s30, 7
    s_waitcnt lgkmcnt(0)
    v_cmp_gt_u32 vcc, s65, v4
    s_nop 0
    s_cmp_lg_u64 vcc, 0
    s_cbranch_scc1 L_mega_kernel_nokv_304
    s_sub_u32 s56, s33, s30
    s_and_b32 s56, s56, 7
    s_mul_i32 s57, s56, 17408
    s_add_u32 s57, s57, 2097152
    s_add_u32 m0, s34, 0
    s_add_u32 s60, s57, 0
    buffer_load_dwordx4 v2, s[4:7], s60 offen sc1 lds
    s_add_u32 m0, s34, 1024
    s_add_u32 s60, s57, 1024
    buffer_load_dwordx4 v2, s[4:7], s60 offen sc1 lds
    ds_read_b32 v4, v3
    s_waitcnt lgkmcnt(0)
    s_add_u32 m0, s34, 2048
    s_add_u32 s60, s57, 2048
    buffer_load_dwordx4 v2, s[4:7], s60 offen sc1 lds
    s_add_u32 m0, s34, 3072
    s_add_u32 s60, s57, 3072
    buffer_load_dwordx4 v2, s[4:7], s60 offen sc1 lds
    ds_read_b32 v4, v3
    s_waitcnt lgkmcnt(0)
    s_add_u32 m0, s34, 4096
    s_add_u32 s60, s57, 4096
    buffer_load_dwordx4 v2, s[4:7], s60 offen sc1 lds
    s_add_u32 m0, s34, 5120
    s_add_u32 s60, s57, 5120
    buffer_load_dwordx4 v2, s[4:7], s60 offen sc1 lds
    ds_read_b32 v4, v3
    s_waitcnt lgkmcnt(0)
    s_add_u32 m0, s34, 6144
    s_add_u32 s60, s57, 6144
    buffer_load_dwordx4 v2, s[4:7], s60 offen sc1 lds
    s_add_u32 m0, s34, 7168
    s_add_u32 s60, s57, 7168
    buffer_load_dwordx4 v2, s[4:7], s60 offen sc1 lds
    ds_read_b32 v4, v3
    s_waitcnt lgkmcnt(0)
    s_add_u32 m0, s34, 8192
    s_add_u32 s60, s57, 8192
    buffer_load_dwordx4 v2, s[4:7], s60 offen sc1 lds
    s_add_u32 m0, s34, 9216
    s_add_u32 s60, s57, 9216
    buffer_load_dwordx4 v2, s[4:7], s60 offen sc1 lds
    ds_read_b32 v4, v3
    s_waitcnt lgkmcnt(0)
    s_add_u32 m0, s34, 10240
    s_add_u32 s60, s57, 10240
    buffer_load_dwordx4 v2, s[4:7], s60 offen sc1 lds
    s_add_u32 m0, s34, 11264
    s_add_u32 s60, s57, 11264
    buffer_load_dwordx4 v2, s[4:7], s60 offen sc1 lds
    ds_read_b32 v4, v3
    s_waitcnt lgkmcnt(0)
    s_add_u32 m0, s34, 12288
    s_add_u32 s60, s57, 12288
    buffer_load_dwordx4 v2, s[4:7], s60 offen sc1 lds
    s_add_u32 m0, s34, 13312
    s_add_u32 s60, s57, 13312
    buffer_load_dwordx4 v2, s[4:7], s60 offen sc1 lds
    ds_read_b32 v4, v3
    s_waitcnt lgkmcnt(0)
    s_add_u32 m0, s34, 14336
    s_add_u32 s60, s57, 14336
    buffer_load_dwordx4 v2, s[4:7], s60 offen sc1 lds
    s_add_u32 m0, s34, 15360
    s_add_u32 s60, s57, 15360
    buffer_load_dwordx4 v2, s[4:7], s60 offen sc1 lds
    ds_read_b32 v4, v3
    s_waitcnt lgkmcnt(0)
    s_add_u32 m0, s34, 16384
    s_add_u32 s60, s57, 16384
    buffer_load_dwordx4 v2, s[4:7], s60 offen sc1 lds
    s_add_u32 s65, s30, 1
    s_mov_b32 m0, 149664
    s_lshl_b32 s82, s65, 2
    s_add_u32 s82, s82, s3
    s_mov_b64 exec, 1
    v_mov_b32 v14, s82
    global_load_lds_dword v[14:15], off
    s_mov_b64 exec, -1
    s_add_u32 s34, s34, 17408
    s_cmp_eq_u32 s34, 149504
    s_cselect_b32 s34, 114688, s34
    s_add_u32 s30, s30, 1
L_mega_kernel_nokv_304:
    s_cmp_eq_u32 s27, 0
    s_cbranch_scc1 L_mega_kernel_P0_306
    s_cmp_eq_u32 s27, 1
    s_cbranch_scc1 L_mega_kernel_P1_307
    s_cmp_eq_u32 s27, 2
    s_cbranch_scc1 L_mega_kernel_P2_308
    s_endpgm
L_mega_kernel_P2_308:
    s_mov_b32 s57, 400000
L_mega_kernel_lp_309:
    ds_read_b32 v4, v3 offset:20
    s_waitcnt lgkmcnt(0)
    v_readfirstlane_b32 s56, v4
    s_sub_u32 s57, s57, 1
    s_cmp_ge_u32 s56, 1
    s_cbranch_scc1 L_mega_kernel_ok_310
    s_sleep 4
    s_cmp_lg_u32 s57, 0
    s_cbranch_scc1 L_mega_kernel_lp_309
L_mega_kernel_ok_310:
    s_mov_b32 s57, 400000
L_mega_kernel_lp4_311:
    ds_read_b32 v4, v5
    s_waitcnt lgkmcnt(0)
    v_cmp_gt_u32 vcc, 32, v4
    s_sub_u32 s57, s57, 1
    s_cmp_eq_u64 vcc, 0
    s_cbranch_scc1 L_mega_kernel_ok4_312
    s_sleep 4
    s_cmp_lg_u32 s57, 0
    s_cbranch_scc1 L_mega_kernel_lp4_311
L_mega_kernel_ok4_312:
    s_lshl_b32 s56, s25, 2
    s_add_u32 s56, s56, 1792
    s_lshl_b32 s56, s56, 10
    s_add_u32 s60, s56, 12582912
    s_mov_b32 s61, 49152
    s_mov_b32 s31, 16
L_mega_kernel_woloop_313:
    s_mov_b32 m0, s61
    s_nop 0
    buffer_load_dwordx4 v2, s[4:7], s60 offen offset:0 sc1 lds
    buffer_load_dwordx4 v2, s[4:7], s60 offen offset:1024 sc1 lds
    ds_read_b32 v4, v3
    s_waitcnt lgkmcnt(0)
    buffer_load_dwordx4 v2, s[4:7], s60 offen offset:2048 sc1 lds
    buffer_load_dwordx4 v2, s[4:7], s60 offen offset:3072 sc1 lds
    ds_read_b32 v4, v3
    s_waitcnt lgkmcnt(0)
    s_add_u32 s61, s61, 4096
    s_add_u32 s60, s60, 32768
    s_sub_u32 s31, s31, 1
    s_cmp_lg_u32 s31, 0
    s_cbranch_scc1 L_mega_kernel_woloop_313
    s_mov_b32 m0, 149668
    s_add_u32 s82, s3, 4
    s_mov_b64 exec, 1
    v_mov_b32 v14, s82
    global_load_lds_dword v[14:15], off
    s_mov_b64 exec, -1
    s_waitcnt vmcnt(0)
    s_endpgm
L_mega_kernel_P0_306:
    ds_read_b32 v10, v3 offset:60
    s_waitcnt lgkmcnt(0)
    v_readfirstlane_b32 s23, v10
    s_mov_b32 s57, 400000
L_mega_kernel_lp_314:
    ds_read_b32 v4, v3 offset:32
    s_waitcnt lgkmcnt(0)
    v_readfirstlane_b32 s56, v4
    s_sub_u32 s57, s57, 1
    s_cmp_ge_u32 s56, 4
    s_cbranch_scc1 L_mega_kernel_ok_315
    s_sleep 4
    s_cmp_lg_u32 s57, 0
    s_cbranch_scc1 L_mega_kernel_lp_314
L_mega_kernel_ok_315:
    s_add_u32 s34, s23, 2
    s_and_b32 s35, s2, 7
    s_lshl_b32 s35, s35, 12
    s_lshl_b32 s56, s21, 8
    s_add_u32 s35, s35, s56
    s_add_u32 s35, s35, 2703360
    v_lshlrev_b32 v8, 2, v1
    s_mov_b32 s62, 100000
L_mega_kernel_gp_316:
    buffer_load_dword v32, v8, s[4:7], s35 offen sc1
    s_waitcnt vmcnt(0)
    v_xor_b32 v32, s34, v32
    v_cmp_ne_u32 vcc, 0, v32
    s_sub_u32 s62, s62, 1
    s_cmp_eq_u64 vcc, 0
    s_cbranch_scc1 L_mega_kernel_gpok_317
    s_sleep 4
    s_cmp_lg_u32 s62, 0
    s_cbranch_scc1 L_mega_kernel_gp_316
L_mega_kernel_gpok_317:
    s_mov_b64 exec, 2
    ds_add_u32 v3, v1 offset:32
    s_mov_b64 exec, -1
    s_endpgm
L_mega_kernel_P1_307:
L_mega_kernel_kvloop_318:
    s_cmp_ge_u32 s30, 8
    s_cbranch_scc1 L_mega_kernel_kvend_319
    s_add_u32 s65, s30, 7
    s_mov_b32 s57, 400000
L_mega_kernel_lp4_320:
    ds_read_b32 v4, v29
    s_waitcnt lgkmcnt(0)
    v_cmp_gt_u32 vcc, s65, v4
    s_sub_u32 s57, s57, 1
    s_cmp_eq_u64 vcc, 0
    s_cbranch_scc1 L_mega_kernel_ok4_321
    s_sleep 4
    s_cmp_lg_u32 s57, 0
    s_cbranch_scc1 L_mega_kernel_lp4_320
L_mega_kernel_ok4_321:
    s_sub_u32 s56, s33, s30
    s_and_b32 s56, s56, 7
    s_mul_i32 s57, s56, 17408
    s_add_u32 s57, s57, 2097152
    s_add_u32 m0, s34, 0
    s_add_u32 s60, s57, 0
    buffer_load_dwordx4 v2, s[4:7], s60 offen sc1 lds
    ds_read_b32 v4, v3
    s_waitcnt lgkmcnt(0)
    s_add_u32 m0, s34, 1024
    s_add_u32 s60, s57, 1024
    buffer_load_dwordx4 v2, s[4:7], s60 offen sc1 lds
    s_add_u32 m0, s34, 2048
    s_add_u32 s60, s57, 2048
    buffer_load_dwordx4 v2, s[4:7], s60 offen sc1 lds
    ds_read_b32 v4, v3
    s_waitcnt lgkmcnt(0)
    s_add_u32 m0, s34, 3072
    s_add_u32 s60, s57, 3072
    buffer_load_dwordx4 v2, s[4:7], s60 offen sc1 lds
    s_add_u32 m0, s34, 4096
    s_add_u32 s60, s57, 4096
    buffer_load_dwordx4 v2, s[4:7], s60 offen sc1 lds
    ds_read_b32 v4, v3
    s_waitcnt lgkmcnt(0)
    s_add_u32 m0, s34, 5120
    s_add_u32 s60, s57, 5120
    buffer_load_dwordx4 v2, s[4:7], s60 offen sc1 lds
    s_add_u32 m0, s34, 6144
    s_add_u32 s60, s57, 6144
    buffer_load_dwordx4 v2, s[4:7], s60 offen sc1 lds
    ds_read_b32 v4, v3
    s_waitcnt lgkmcnt(0)
    s_add_u32 m0, s34, 7168
    s_add_u32 s60, s57, 7168
    buffer_load_dwordx4 v2, s[4:7], s60 offen sc1 lds
    s_add_u32 m0, s34, 8192
    s_add_u32 s60, s57, 8192
    buffer_load_dwordx4 v2, s[4:7], s60 offen sc1 lds
    ds_read_b32 v4, v3
    s_waitcnt lgkmcnt(0)
    s_add_u32 m0, s34, 9216
    s_add_u32 s60, s57, 9216
    buffer_load_dwordx4 v2, s[4:7], s60 offen sc1 lds
    s_add_u32 m0, s34, 10240
    s_add_u32 s60, s57, 10240
    buffer_load_dwordx4 v2, s[4:7], s60 offen sc1 lds
    ds_read_b32 v4, v3
    s_waitcnt lgkmcnt(0)
    s_add_u32 m0, s34, 11264
    s_add_u32 s60, s57, 11264
    buffer_load_dwordx4 v2, s[4:7], s60 offen sc1 lds
    s_add_u32 m0, s34, 12288
    s_add_u32 s60, s57, 12288
    buffer_load_dwordx4 v2, s[4:7], s60 offen sc1 lds
    ds_read_b32 v4, v3
    s_waitcnt lgkmcnt(0)
    s_add_u32 m0, s34, 13312
    s_add_u32 s60, s57, 13312
    buffer_load_dwordx4 v2, s[4:7], s60 offen sc1 lds
    s_add_u32 m0, s34, 14336
    s_add_u32 s60, s57, 14336
    buffer_load_dwordx4 v2, s[4:7], s60 offen sc1 lds
    ds_read_b32 v4, v3
    s_waitcnt lgkmcnt(0)
    s_add_u32 m0, s34, 15360
    s_add_u32 s60, s57, 15360
    buffer_load_dwordx4 v2, s[4:7], s60 offen sc1 lds
    s_add_u32 m0, s34, 16384
    s_add_u32 s60, s57, 16384
    buffer_load_dwordx4 v2, s[4:7], s60 offen sc1 lds
    ds_read_b32 v4, v3
    s_waitcnt lgkmcnt(0)
    s_add_u32 s65, s30, 1
    s_mov_b32 m0, 149664
    s_lshl_b32 s82, s65, 2
    s_add_u32 s82, s82, s3
    s_mov_b64 exec, 1
    v_mov_b32 v14, s82
    global_load_lds_dword v[14:15], off
    s_mov_b64 exec, -1
    s_add_u32 s34, s34, 17408
    s_cmp_eq_u32 s34, 149504
    s_cselect_b32 s34, 114688, s34
    s_add_u32 s30, s30, 1
    s_branch L_mega_kernel_kvloop_318
L_mega_kernel_kvend_319:
    s_endpgm
L_mega_kernel_done_1:
    s_endpgm
.p2align 8
L_mega_kernel_tab_2:
.long 0, 1, 2, 3, 4, 5, 6, 7, 8, 9, 10, 11, 12, 13, 14, 15, 16, 17, 18, 19, 20, 21, 22, 23, 24, 25, 26, 27, 28, 29, 30, 31, 32, 33, 34, 35, 36, 37, 38, 39, 40, 41, 42, 43, 44, 45, 46, 47, 48, 49, 50, 51, 52, 53, 54, 55, 56, 57, 58, 59, 60, 61, 62, 63
L_mega_kernel_ones_3:
.fill 272, 4, 0x3f803f80

.section .rodata,"a"
.p2align 6
.amdhsa_kernel mega_kernel
  .amdhsa_next_free_vgpr 168
  .amdhsa_next_free_sgpr 102
  .amdhsa_accum_offset 168
  .amdhsa_group_segment_fixed_size 0
  .amdhsa_kernarg_size 96
  .amdhsa_user_sgpr_count 2
  .amdhsa_user_sgpr_kernarg_segment_ptr 1
  .amdhsa_system_sgpr_workgroup_id_x 1
  .amdhsa_float_denorm_mode_32 3
  .amdhsa_float_denorm_mode_16_64 3
.end_amdhsa_kernel
```
